```python
import torch

def _softmax(x, axis=-1):
    return torch.softmax(x, dim=axis)
def _gelu(x):
    return torch.nn.functional.gelu(x, approximate="tanh")
def _silu(x):
    return torch.nn.functional.silu(x)
def _sigmoid(x):
    return torch.sigmoid(x)
def _layernorm(x, axis=-1, eps=1e-5):
    m = x.mean(dim=axis, keepdim=True)
    v = x.var(dim=axis, keepdim=True, unbiased=False)
    return (x - m) / torch.sqrt(v + eps)
def _scatter_add(tgt, idx, src, axis=0):
    return tgt.clone().index_add_(axis, idx, src)
def _segment_sum(src, seg, n):
    out = torch.zeros((n,) + src.shape[1:], dtype=src.dtype)
    return out.index_add_(0, seg, src)
def _pad(x, pw):
    flat = tuple(v for pair in reversed(pw) for v in pair)
    return torch.nn.functional.pad(x, flat)

kernel_name = 'parallel_sum__sliding_local_dilated__dense_activation_relu__prompt'

def setup_inputs():

    _w = (lambda a: (lambda t: t.to(torch.bfloat16) if t.is_floating_point() else t)(torch.as_tensor(a)))
    def _A_setup():
        B, S, D = 1, 2048, 640
        return {
            "x": _w((lambda *s: torch.randn(*s, dtype=torch.bfloat16) * 0.05)(B, S, D)),
            "wqkv": _w((lambda *s: torch.randn(*s, dtype=torch.bfloat16) * 0.05)(D, 3 * D)),
            "wo": _w((lambda *s: torch.randn(*s, dtype=torch.bfloat16) * 0.05)(D, D)),
        }
    _A_in = _A_setup()

    def _B_setup():
        B, S, D, Dff = 1, 2048, 640, 1728
        return {
            "x": _w((lambda *s: torch.randn(*s, dtype=torch.bfloat16) * 0.05)(B, S, D)),
            "w1": _w((lambda *s: torch.randn(*s, dtype=torch.bfloat16) * 0.05)(D, Dff)),
            "w2": _w((lambda *s: torch.randn(*s, dtype=torch.bfloat16) * 0.05)(Dff, D)),
        }
    _B_in = _B_setup()

    return {
        "A_x": _A_in["x"],
        "A_wqkv": _A_in["wqkv"],
        "A_wo": _A_in["wo"],
        "B_x": _B_in["x"],
        "B_w1": _B_in["w1"],
        "B_w2": _B_in["w2"],
    }

def reference(A_x, A_wqkv, A_wo, B_x, B_w1, B_w2):
    def _A_ref(x, wqkv, wo):
        B, S, D = x.shape
        H = 32; Dh = D // H
        W, dil = 8, 2
        qkv = (lambda x, *d: x.permute(*d))((x @ wqkv).reshape(B, S, 3, H, Dh), 2, 0, 3, 1, 4)
        q, k, v = qkv[0], qkv[1], qkv[2]
        scale = Dh ** -0.5
        pos = torch.arange(S)
        off = torch.arange(W) * dil
        idx = pos[:, None] - off[None, :]
        mask = idx >= 0
        idx_c = torch.where(mask, idx, 0).reshape(-1)
        kg = k[:, :, idx_c, :].reshape(B, H, S, W, Dh)
        vg = v[:, :, idx_c, :].reshape(B, H, S, W, Dh)
        logits = torch.einsum("bhsd,bhswd->bhsw", q, kg) * scale
        logits = torch.where(mask[None, None, :, :], logits, -1e9)
        attn = _softmax(logits, axis=-1)
        o = torch.einsum("bhsw,bhswd->bhsd", attn, vg)
        return (lambda x, *d: x.permute(*d))(o, 0, 2, 1, 3).reshape(B, S, D) @ wo

    def _B_ref(x, w1, w2):
        h = torch.einsum("bsd,df->bsf", x, w1)
        zero = torch.zeros_like(h)
        h = torch.maximum(h, zero)
        return torch.einsum("bsf,fd->bsd", h, w2)

    x = A_x
    xn = _layernorm(x, axis=-1)
    return x + _A_ref(xn, A_wqkv, A_wo) + _B_ref(xn, B_w1, B_w2)
```

```asm
; @launch grid=(256,1,1) block=(512,1,1) lds=163840
.amdgcn_target "amdgcn-amd-amdhsa--gfx950"
.text
.globl parallel_sum__sliding_local_dilated__dense_activation_relu__prompt_kernel
.p2align 8
.type parallel_sum__sliding_local_dilated__dense_activation_relu__prompt_kernel,@function
parallel_sum__sliding_local_dilated__dense_activation_relu__prompt_kernel:
L_text_begin:
  s_getpc_b64 s[60:61]
  s_cmp_ge_u32 s2, 256
  s_cbranch_scc1 L1_exit
  s_load_dwordx4 s[4:7], s[0:1], 0
  s_load_dwordx2 s[62:63], s[0:1], 16
  s_load_dwordx4 s[20:23], s[0:1], 32
  s_load_dwordx4 s[68:71], s[0:1], 56
  s_load_dwordx2 s[84:85], s[0:1], 48
  v_lshrrev_b32 v1, 6, v0
  v_and_b32 v0, 63, v0
  s_and_b32 s27, s2, 7
  s_lshr_b32 s45, s2, 3
  v_readfirstlane_b32 s24, v1
  s_lshr_b32 s3, s45, 4
  s_xor_b32 s3, s3, 1
  s_bfe_u32 s86, s45, 0x30000
  s_bfe_u32 s28, s45, 0x10003
  s_lshl_b32 s87, s28, 1
  s_xor_b32 s29, s86, s3
  s_and_b32 s29, s29, 1
  s_add_u32 s87, s87, s29
  s_lshr_b32 s29, s27, 1
  s_lshl_b32 s29, s29, 3
  s_add_u32 s86, s86, s29
  s_and_b32 s29, s27, 1
  s_lshl_b32 s29, s29, 2
  s_add_u32 s87, s87, s29
  s_and_b32 s47, s27, 1
  s_lshr_b32 s46, s27, 1
  s_bfe_u32 s25, s45, 0x30000
  s_lshl_b32 s27, s46, 1
  s_add_u32 s26, s28, s27
  s_lshl_b32 s50, s3, 3
  s_add_u32 s50, s50, s26
  s_lshl_b32 s29, s3, 1
  s_add_u32 s29, s29, s28
  s_lshl_b32 s29, s29, 2
  s_lshr_b32 s29, 12816, s29
  s_and_b32 s29, s29, 15
  s_add_u32 s36, s25, s29
  s_mov_b32 s41, s36
  s_mul_i32 s29, s36, 13108
  s_lshr_b32 s29, s29, 16
  s_mul_i32 s29, s29, 5
  s_sub_u32 s36, s36, s29
  s_lshl_b32 s29, s47, 3
  s_add_u32 s25, s25, s29
  s_and_b32 s27, s26, 3
  s_lshl_b32 s27, s27, 2
  s_lshr_b32 s35, 0x2a6a, s27
  s_and_b32 s35, s35, 15
  s_cmp_ge_u32 s24, 7
  s_cbranch_scc1 L_util
  s_cmp_ge_u32 s24, 4
  s_cbranch_scc1 L_prod
  s_cmp_eq_u32 s3, 0
  s_cbranch_scc0 L_cH
  s_branch L_cQ
L_prod:
  s_sub_u32 s55, s24, 4
  s_mul_i32 s27, s55, 48
  s_lshl_b32 s28, s25, 7
  s_cmp_eq_u32 s3, 0
  s_cselect_b32 s29, 16, 0
  s_sub_u32 s28, s28, s29
  s_add_u32 s28, s28, s27
  s_movk_i32 s48, 1280
  v_lshrrev_b32 v74, 3, v0
  v_add_u32 v74, s28, v74
  v_lshrrev_b32 v72, 4, v0
  v_xor_b32 v72, v72, v0
  v_and_b32 v72, 7, v72
  v_lshlrev_b32 v72, 4, v72
  v_xor_b32 v73, 64, v72
  v_add_u32 v75, 0, v74
  v_max_i32 v75, 0, v75
  v_mad_u32_u24 v16, v75, s48, v72
  v_add_u32 v75, 8, v74
  v_max_i32 v75, 0, v75
  v_mad_u32_u24 v17, v75, s48, v73
  v_add_u32 v75, 16, v74
  v_max_i32 v75, 0, v75
  v_mad_u32_u24 v18, v75, s48, v72
  v_add_u32 v75, 24, v74
  v_max_i32 v75, 0, v75
  v_mad_u32_u24 v19, v75, s48, v73
  v_add_u32 v75, 32, v74
  v_max_i32 v75, 0, v75
  v_mad_u32_u24 v20, v75, s48, v72
  v_add_u32 v75, 40, v74
  v_max_i32 v75, 0, v75
  v_mad_u32_u24 v21, v75, s48, v73
  s_cmp_eq_u32 s55, 2
  s_cselect_b32 s27, 1073741824, 0
  s_cmp_eq_u32 s3, 0
  s_cselect_b32 s27, 0, s27
  v_add_u32 v20, s27, v20
  v_add_u32 v21, s27, v21
  s_cmp_eq_u32 s3, 0
  s_cbranch_scc0 L_prodH
  s_mul_i32 s27, s55, 384
  v_add_u32 v79, s27, v0
  v_mov_b32 v77, 1073741824
  s_mul_i32 s48, s55, 6144
  s_mul_i32 s49, s55, 6144
  s_add_u32 s49, s49, 92160
  s_mov_b32 s72, s36
  s_mul_i32 s29, s26, 160
  s_waitcnt lgkmcnt(0)
  s_mov_b32 s8, s4
  s_and_b32 s9, s5, 0xffff
  s_mov_b32 s10, 2621440
  s_mov_b32 s11, 0x20000
  s_cmp_eq_u32 s3, 0
  s_cselect_b32 s12, s6, s20
  s_cselect_b32 s13, s7, s21
  s_mov_b32 s27, 2211840
  s_cselect_b32 s14, 2457600, s27
  s_and_b32 s13, s13, 0xffff
  s_mov_b32 s15, 0x20000
  s_lshl_b32 s38, s72, 7
  s_add_u32 m0, s49, 0
  s_nop 0
  buffer_load_dwordx4 v16, s[8:11], s38 offen lds
  s_add_u32 m0, s49, 1024
  s_nop 0
  buffer_load_dwordx4 v17, s[8:11], s38 offen lds
  s_add_u32 m0, s49, 2048
  s_nop 0
  buffer_load_dwordx4 v18, s[8:11], s38 offen lds
  s_lshl_b32 s38, s72, 7
  s_add_u32 m0, s49, 3072
  s_nop 0
  buffer_load_dwordx4 v19, s[8:11], s38 offen lds
  s_add_u32 m0, s49, 4096
  s_nop 0
  buffer_load_dwordx4 v20, s[8:11], s38 offen lds
  s_add_u32 m0, s49, 5120
  s_nop 0
  buffer_load_dwordx4 v21, s[8:11], s38 offen lds
  s_mul_i32 s37, s72, 245760
  v_add_u32 v72, 0, v79
  v_mul_u32_u24 v73, 1821, v72
  v_lshrrev_b32 v73, 16, v73
  v_mul_u32_u24 v74, 36, v73
  v_sub_u32 v74, v72, v74
  v_lshrrev_b32 v75, 2, v73
  v_and_b32 v75, 2, v75
  v_mul_u32_u24 v76, 43, v74
  v_lshrrev_b32 v76, 9, v76
  v_mul_u32_u24 v78, 12, v76
  v_sub_u32 v78, v74, v78
  v_xor_b32 v78, v78, v75
  v_cmp_le_u32 vcc, s35, v78
  v_mul_u32_u24 v73, 3840, v73
  s_nop 0
  v_cndmask_b32 v75, 0, 2, vcc
  v_sub_u32 v78, v78, v75
  v_mul_u32_u24 v76, 1280, v76
  v_lshl_add_u32 v73, v78, 4, v73
  v_add3_u32 v8, v73, v76, s29
  s_add_u32 m0, s48, 0
  s_nop 0
  buffer_load_dwordx4 v8, s[12:15], s37 offen lds
  v_add_u32 v72, 64, v79
  v_mul_u32_u24 v73, 1821, v72
  v_lshrrev_b32 v73, 16, v73
  v_mul_u32_u24 v74, 36, v73
  v_sub_u32 v74, v72, v74
  v_lshrrev_b32 v75, 2, v73
  v_and_b32 v75, 2, v75
  v_mul_u32_u24 v76, 43, v74
  v_lshrrev_b32 v76, 9, v76
  v_mul_u32_u24 v78, 12, v76
  v_sub_u32 v78, v74, v78
  v_xor_b32 v78, v78, v75
  v_cmp_le_u32 vcc, s35, v78
  v_mul_u32_u24 v73, 3840, v73
  s_nop 0
  v_cndmask_b32 v75, 0, 2, vcc
  v_sub_u32 v78, v78, v75
  v_mul_u32_u24 v76, 1280, v76
  v_lshl_add_u32 v73, v78, 4, v73
  v_add3_u32 v9, v73, v76, s29
  s_add_u32 m0, s48, 1024
  s_nop 0
  buffer_load_dwordx4 v9, s[12:15], s37 offen lds
  v_add_u32 v72, 128, v79
  v_mul_u32_u24 v73, 1821, v72
  v_lshrrev_b32 v73, 16, v73
  v_mul_u32_u24 v74, 36, v73
  v_sub_u32 v74, v72, v74
  v_lshrrev_b32 v75, 2, v73
  v_and_b32 v75, 2, v75
  v_mul_u32_u24 v76, 43, v74
  v_lshrrev_b32 v76, 9, v76
  v_mul_u32_u24 v78, 12, v76
  v_sub_u32 v78, v74, v78
  v_xor_b32 v78, v78, v75
  v_cmp_le_u32 vcc, s35, v78
  v_mul_u32_u24 v73, 3840, v73
  s_nop 0
  v_cndmask_b32 v75, 0, 2, vcc
  v_sub_u32 v78, v78, v75
  v_mul_u32_u24 v76, 1280, v76
  v_lshl_add_u32 v73, v78, 4, v73
  v_add3_u32 v10, v73, v76, s29
  s_add_u32 m0, s48, 2048
  s_nop 0
  buffer_load_dwordx4 v10, s[12:15], s37 offen lds
  v_add_u32 v72, 192, v79
  v_mul_u32_u24 v73, 1821, v72
  v_lshrrev_b32 v73, 16, v73
  v_mul_u32_u24 v74, 36, v73
  v_sub_u32 v74, v72, v74
  v_lshrrev_b32 v75, 2, v73
  v_and_b32 v75, 2, v75
  v_mul_u32_u24 v76, 43, v74
  v_lshrrev_b32 v76, 9, v76
  v_mul_u32_u24 v78, 12, v76
  v_sub_u32 v78, v74, v78
  v_xor_b32 v78, v78, v75
  v_cmp_le_u32 vcc, s35, v78
  v_mul_u32_u24 v73, 3840, v73
  s_nop 0
  v_cndmask_b32 v75, 0, 2, vcc
  v_sub_u32 v78, v78, v75
  v_mul_u32_u24 v76, 1280, v76
  v_lshl_add_u32 v73, v78, 4, v73
  v_add3_u32 v11, v73, v76, s29
  s_add_u32 m0, s48, 3072
  s_nop 0
  buffer_load_dwordx4 v11, s[12:15], s37 offen lds
  v_add_u32 v72, 256, v79
  v_mul_u32_u24 v73, 1821, v72
  v_lshrrev_b32 v73, 16, v73
  v_mul_u32_u24 v74, 36, v73
  v_sub_u32 v74, v72, v74
  v_lshrrev_b32 v75, 2, v73
  v_and_b32 v75, 2, v75
  v_mul_u32_u24 v76, 43, v74
  v_lshrrev_b32 v76, 9, v76
  v_mul_u32_u24 v78, 12, v76
  v_sub_u32 v78, v74, v78
  v_xor_b32 v78, v78, v75
  v_cmp_le_u32 vcc, s35, v78
  v_mul_u32_u24 v73, 3840, v73
  s_nop 0
  v_cndmask_b32 v75, 0, 2, vcc
  v_sub_u32 v78, v78, v75
  v_mul_u32_u24 v76, 1280, v76
  v_lshl_add_u32 v73, v78, 4, v73
  v_add3_u32 v12, v73, v76, s29
  s_add_u32 m0, s48, 4096
  s_nop 0
  buffer_load_dwordx4 v12, s[12:15], s37 offen lds
  v_add_u32 v72, 320, v79
  v_mul_u32_u24 v73, 1821, v72
  v_lshrrev_b32 v73, 16, v73
  v_mul_u32_u24 v74, 36, v73
  v_sub_u32 v74, v72, v74
  v_lshrrev_b32 v75, 2, v73
  v_and_b32 v75, 2, v75
  v_mul_u32_u24 v76, 43, v74
  v_lshrrev_b32 v76, 9, v76
  v_mul_u32_u24 v78, 12, v76
  v_sub_u32 v78, v74, v78
  v_xor_b32 v78, v78, v75
  v_cmp_le_u32 vcc, s35, v78
  v_mul_u32_u24 v73, 3840, v73
  s_nop 0
  v_cndmask_b32 v75, 0, 2, vcc
  v_sub_u32 v78, v78, v75
  v_mul_u32_u24 v76, 1280, v76
  v_lshl_add_u32 v73, v78, 4, v73
  v_add3_u32 v13, v73, v76, s29
  s_add_u32 m0, s48, 5120
  s_nop 0
  buffer_load_dwordx4 v13, s[12:15], s37 offen lds
  s_mul_i32 s37, s72, 245760
  s_add_u32 s37, s37, 122880
  s_add_u32 m0, s48, 18432
  s_nop 0
  buffer_load_dwordx4 v8, s[12:15], s37 offen lds
  s_add_u32 m0, s48, 19456
  s_nop 0
  buffer_load_dwordx4 v9, s[12:15], s37 offen lds
  s_add_u32 m0, s48, 20480
  s_nop 0
  buffer_load_dwordx4 v10, s[12:15], s37 offen lds
  s_add_u32 m0, s48, 21504
  s_nop 0
  buffer_load_dwordx4 v11, s[12:15], s37 offen lds
  s_add_u32 m0, s48, 22528
  s_nop 0
  buffer_load_dwordx4 v12, s[12:15], s37 offen lds
  s_add_u32 m0, s48, 23552
  s_nop 0
  buffer_load_dwordx4 v13, s[12:15], s37 offen lds
  s_mov_b32 s28, s36
  s_add_u32 s73, s28, 1
  s_cmp_ge_u32 s73, 5
  s_cselect_b32 s27, 5, 0
  s_sub_u32 s73, s73, s27
  s_add_u32 s74, s28, 2
  s_cmp_ge_u32 s74, 5
  s_cselect_b32 s27, 5, 0
  s_sub_u32 s74, s74, s27
  s_add_u32 s75, s28, 3
  s_cmp_ge_u32 s75, 5
  s_cselect_b32 s27, 5, 0
  s_sub_u32 s75, s75, s27
  s_add_u32 s76, s28, 4
  s_cmp_ge_u32 s76, 5
  s_cselect_b32 s27, 5, 0
  s_sub_u32 s76, s76, s27
  s_mul_i32 s27, s41, 13108
  s_lshr_b32 s27, s27, 16
  s_mul_i32 s27, s27, 5
  s_sub_u32 s28, s41, s27
  s_add_u32 s77, s28, 0
  s_cmp_ge_u32 s77, 5
  s_cselect_b32 s27, 5, 0
  s_sub_u32 s77, s77, s27
  s_add_u32 s77, s77, 5
  s_add_u32 s78, s28, 1
  s_cmp_ge_u32 s78, 5
  s_cselect_b32 s27, 5, 0
  s_sub_u32 s78, s78, s27
  s_add_u32 s78, s78, 5
  s_add_u32 s79, s28, 2
  s_cmp_ge_u32 s79, 5
  s_cselect_b32 s27, 5, 0
  s_sub_u32 s79, s79, s27
  s_add_u32 s79, s79, 5
  s_add_u32 s80, s28, 3
  s_cmp_ge_u32 s80, 5
  s_cselect_b32 s27, 5, 0
  s_sub_u32 s80, s80, s27
  s_add_u32 s80, s80, 5
  s_add_u32 s81, s28, 4
  s_cmp_ge_u32 s81, 5
  s_cselect_b32 s27, 5, 0
  s_sub_u32 s81, s81, s27
  s_add_u32 s81, s81, 5
  s_mul_i32 s37, s73, 245760
  s_add_u32 m0, s48, 36864
  s_nop 0
  buffer_load_dwordx4 v8, s[12:15], s37 offen lds
  s_add_u32 m0, s48, 37888
  s_nop 0
  buffer_load_dwordx4 v9, s[12:15], s37 offen lds
  s_add_u32 m0, s48, 38912
  s_nop 0
  buffer_load_dwordx4 v10, s[12:15], s37 offen lds
  s_add_u32 m0, s48, 39936
  s_nop 0
  buffer_load_dwordx4 v11, s[12:15], s37 offen lds
  s_add_u32 m0, s48, 40960
  s_nop 0
  buffer_load_dwordx4 v12, s[12:15], s37 offen lds
  s_add_u32 m0, s48, 41984
  s_nop 0
  buffer_load_dwordx4 v13, s[12:15], s37 offen lds
  s_lshl_b32 s38, s73, 7
  s_add_u32 m0, s49, 18432
  s_nop 0
  buffer_load_dwordx4 v16, s[8:11], s38 offen lds
  s_add_u32 m0, s49, 19456
  s_nop 0
  buffer_load_dwordx4 v17, s[8:11], s38 offen lds
  s_add_u32 m0, s49, 20480
  s_nop 0
  buffer_load_dwordx4 v18, s[8:11], s38 offen lds
  s_lshl_b32 s38, s73, 7
  s_add_u32 m0, s49, 21504
  s_nop 0
  buffer_load_dwordx4 v19, s[8:11], s38 offen lds
  s_add_u32 m0, s49, 22528
  s_nop 0
  buffer_load_dwordx4 v20, s[8:11], s38 offen lds
  s_add_u32 m0, s49, 23552
  s_nop 0
  buffer_load_dwordx4 v21, s[8:11], s38 offen lds
  s_waitcnt vmcnt(12)
  s_barrier
  s_mul_i32 s37, s73, 245760
  s_add_u32 s37, s37, 122880
  s_add_u32 m0, s48, 55296
  s_nop 0
  buffer_load_dwordx4 v8, s[12:15], s37 offen lds
  s_add_u32 m0, s48, 56320
  s_nop 0
  buffer_load_dwordx4 v9, s[12:15], s37 offen lds
  s_add_u32 m0, s48, 57344
  s_nop 0
  buffer_load_dwordx4 v10, s[12:15], s37 offen lds
  s_add_u32 m0, s48, 58368
  s_nop 0
  buffer_load_dwordx4 v11, s[12:15], s37 offen lds
  s_add_u32 m0, s48, 59392
  s_nop 0
  buffer_load_dwordx4 v12, s[12:15], s37 offen lds
  s_add_u32 m0, s48, 60416
  s_nop 0
  buffer_load_dwordx4 v13, s[12:15], s37 offen lds
  s_mul_i32 s37, s74, 245760
  s_add_u32 m0, s48, 73728
  s_nop 0
  buffer_load_dwordx4 v8, s[12:15], s37 offen lds
  s_add_u32 m0, s48, 74752
  s_nop 0
  buffer_load_dwordx4 v9, s[12:15], s37 offen lds
  s_add_u32 m0, s48, 75776
  s_nop 0
  buffer_load_dwordx4 v10, s[12:15], s37 offen lds
  s_add_u32 m0, s48, 76800
  s_nop 0
  buffer_load_dwordx4 v11, s[12:15], s37 offen lds
  s_add_u32 m0, s48, 77824
  s_nop 0
  buffer_load_dwordx4 v12, s[12:15], s37 offen lds
  s_add_u32 m0, s48, 78848
  s_nop 0
  buffer_load_dwordx4 v13, s[12:15], s37 offen lds
  s_lshl_b32 s38, s74, 7
  s_add_u32 m0, s49, 36864
  s_nop 0
  buffer_load_dwordx4 v16, s[8:11], s38 offen lds
  s_add_u32 m0, s49, 37888
  s_nop 0
  buffer_load_dwordx4 v17, s[8:11], s38 offen lds
  s_add_u32 m0, s49, 38912
  s_nop 0
  buffer_load_dwordx4 v18, s[8:11], s38 offen lds
  s_lshl_b32 s38, s74, 7
  s_add_u32 m0, s49, 39936
  s_nop 0
  buffer_load_dwordx4 v19, s[8:11], s38 offen lds
  s_add_u32 m0, s49, 40960
  s_nop 0
  buffer_load_dwordx4 v20, s[8:11], s38 offen lds
  s_add_u32 m0, s49, 41984
  s_nop 0
  buffer_load_dwordx4 v21, s[8:11], s38 offen lds
  s_waitcnt vmcnt(18)
  s_barrier
  s_mul_i32 s37, s74, 245760
  s_add_u32 s37, s37, 122880
  s_add_u32 m0, s48, 0
  s_nop 0
  buffer_load_dwordx4 v8, s[12:15], s37 offen lds
  s_add_u32 m0, s48, 1024
  s_nop 0
  buffer_load_dwordx4 v9, s[12:15], s37 offen lds
  s_add_u32 m0, s48, 2048
  s_nop 0
  buffer_load_dwordx4 v10, s[12:15], s37 offen lds
  s_add_u32 m0, s48, 3072
  s_nop 0
  buffer_load_dwordx4 v11, s[12:15], s37 offen lds
  s_add_u32 m0, s48, 4096
  s_nop 0
  buffer_load_dwordx4 v12, s[12:15], s37 offen lds
  s_add_u32 m0, s48, 5120
  s_nop 0
  buffer_load_dwordx4 v13, s[12:15], s37 offen lds
  s_lshl_b32 s38, s75, 7
  s_add_u32 m0, s49, 0
  s_nop 0
  buffer_load_dwordx4 v16, s[8:11], s38 offen lds
  s_add_u32 m0, s49, 1024
  s_nop 0
  buffer_load_dwordx4 v17, s[8:11], s38 offen lds
  s_add_u32 m0, s49, 2048
  s_nop 0
  buffer_load_dwordx4 v18, s[8:11], s38 offen lds
  s_lshl_b32 s38, s75, 7
  s_add_u32 m0, s49, 3072
  s_nop 0
  buffer_load_dwordx4 v19, s[8:11], s38 offen lds
  s_add_u32 m0, s49, 4096
  s_nop 0
  buffer_load_dwordx4 v20, s[8:11], s38 offen lds
  s_add_u32 m0, s49, 5120
  s_nop 0
  buffer_load_dwordx4 v21, s[8:11], s38 offen lds
  s_waitcnt vmcnt(24)
  s_barrier
  s_mul_i32 s37, s75, 245760
  s_add_u32 m0, s48, 18432
  s_nop 0
  buffer_load_dwordx4 v8, s[12:15], s37 offen lds
  s_add_u32 m0, s48, 19456
  s_nop 0
  buffer_load_dwordx4 v9, s[12:15], s37 offen lds
  s_add_u32 m0, s48, 20480
  s_nop 0
  buffer_load_dwordx4 v10, s[12:15], s37 offen lds
  s_add_u32 m0, s48, 21504
  s_nop 0
  buffer_load_dwordx4 v11, s[12:15], s37 offen lds
  s_add_u32 m0, s48, 22528
  s_nop 0
  buffer_load_dwordx4 v12, s[12:15], s37 offen lds
  s_add_u32 m0, s48, 23552
  s_nop 0
  buffer_load_dwordx4 v13, s[12:15], s37 offen lds
  s_waitcnt vmcnt(18)
  s_barrier
  s_mul_i32 s37, s75, 245760
  s_add_u32 s37, s37, 122880
  s_add_u32 m0, s48, 36864
  s_nop 0
  buffer_load_dwordx4 v8, s[12:15], s37 offen lds
  s_add_u32 m0, s48, 37888
  s_nop 0
  buffer_load_dwordx4 v9, s[12:15], s37 offen lds
  s_add_u32 m0, s48, 38912
  s_nop 0
  buffer_load_dwordx4 v10, s[12:15], s37 offen lds
  s_add_u32 m0, s48, 39936
  s_nop 0
  buffer_load_dwordx4 v11, s[12:15], s37 offen lds
  s_add_u32 m0, s48, 40960
  s_nop 0
  buffer_load_dwordx4 v12, s[12:15], s37 offen lds
  s_add_u32 m0, s48, 41984
  s_nop 0
  buffer_load_dwordx4 v13, s[12:15], s37 offen lds
  s_lshl_b32 s38, s76, 7
  s_add_u32 m0, s49, 18432
  s_nop 0
  buffer_load_dwordx4 v16, s[8:11], s38 offen lds
  s_add_u32 m0, s49, 19456
  s_nop 0
  buffer_load_dwordx4 v17, s[8:11], s38 offen lds
  s_add_u32 m0, s49, 20480
  s_nop 0
  buffer_load_dwordx4 v18, s[8:11], s38 offen lds
  s_lshl_b32 s38, s76, 7
  s_add_u32 m0, s49, 21504
  s_nop 0
  buffer_load_dwordx4 v19, s[8:11], s38 offen lds
  s_add_u32 m0, s49, 22528
  s_nop 0
  buffer_load_dwordx4 v20, s[8:11], s38 offen lds
  s_add_u32 m0, s49, 23552
  s_nop 0
  buffer_load_dwordx4 v21, s[8:11], s38 offen lds
  s_waitcnt vmcnt(24)
  s_barrier
  s_mul_i32 s37, s76, 245760
  s_add_u32 m0, s48, 55296
  s_nop 0
  buffer_load_dwordx4 v8, s[12:15], s37 offen lds
  s_add_u32 m0, s48, 56320
  s_nop 0
  buffer_load_dwordx4 v9, s[12:15], s37 offen lds
  s_add_u32 m0, s48, 57344
  s_nop 0
  buffer_load_dwordx4 v10, s[12:15], s37 offen lds
  s_add_u32 m0, s48, 58368
  s_nop 0
  buffer_load_dwordx4 v11, s[12:15], s37 offen lds
  s_add_u32 m0, s48, 59392
  s_nop 0
  buffer_load_dwordx4 v12, s[12:15], s37 offen lds
  s_add_u32 m0, s48, 60416
  s_nop 0
  buffer_load_dwordx4 v13, s[12:15], s37 offen lds
  s_waitcnt vmcnt(18)
  s_barrier
  s_mul_i32 s37, s76, 245760
  s_add_u32 s37, s37, 122880
  s_add_u32 m0, s48, 73728
  s_nop 0
  buffer_load_dwordx4 v8, s[12:15], s37 offen lds
  s_add_u32 m0, s48, 74752
  s_nop 0
  buffer_load_dwordx4 v9, s[12:15], s37 offen lds
  s_add_u32 m0, s48, 75776
  s_nop 0
  buffer_load_dwordx4 v10, s[12:15], s37 offen lds
  s_add_u32 m0, s48, 76800
  s_nop 0
  buffer_load_dwordx4 v11, s[12:15], s37 offen lds
  s_add_u32 m0, s48, 77824
  s_nop 0
  buffer_load_dwordx4 v12, s[12:15], s37 offen lds
  s_add_u32 m0, s48, 78848
  s_nop 0
  buffer_load_dwordx4 v13, s[12:15], s37 offen lds
  s_lshl_b32 s38, s77, 7
  s_add_u32 m0, s49, 36864
  s_nop 0
  buffer_load_dwordx4 v16, s[8:11], s38 offen lds
  s_add_u32 m0, s49, 37888
  s_nop 0
  buffer_load_dwordx4 v17, s[8:11], s38 offen lds
  s_add_u32 m0, s49, 38912
  s_nop 0
  buffer_load_dwordx4 v18, s[8:11], s38 offen lds
  s_lshl_b32 s38, s77, 7
  s_add_u32 m0, s49, 39936
  s_nop 0
  buffer_load_dwordx4 v19, s[8:11], s38 offen lds
  s_add_u32 m0, s49, 40960
  s_nop 0
  buffer_load_dwordx4 v20, s[8:11], s38 offen lds
  s_add_u32 m0, s49, 41984
  s_nop 0
  buffer_load_dwordx4 v21, s[8:11], s38 offen lds
  s_waitcnt vmcnt(24)
  s_barrier
  s_mul_i32 s37, s77, 245760
  s_add_u32 m0, s48, 0
  s_nop 0
  buffer_load_dwordx4 v8, s[12:15], s37 offen lds
  s_add_u32 m0, s48, 1024
  s_nop 0
  buffer_load_dwordx4 v9, s[12:15], s37 offen lds
  s_add_u32 m0, s48, 2048
  s_nop 0
  buffer_load_dwordx4 v10, s[12:15], s37 offen lds
  s_add_u32 m0, s48, 3072
  s_nop 0
  buffer_load_dwordx4 v11, s[12:15], s37 offen lds
  s_add_u32 m0, s48, 4096
  s_nop 0
  buffer_load_dwordx4 v12, s[12:15], s37 offen lds
  s_add_u32 m0, s48, 5120
  s_nop 0
  buffer_load_dwordx4 v13, s[12:15], s37 offen lds
  s_waitcnt vmcnt(18)
  s_barrier
  s_mul_i32 s37, s77, 245760
  s_add_u32 s37, s37, 122880
  s_add_u32 m0, s48, 18432
  s_nop 0
  buffer_load_dwordx4 v8, s[12:15], s37 offen lds
  s_add_u32 m0, s48, 19456
  s_nop 0
  buffer_load_dwordx4 v9, s[12:15], s37 offen lds
  s_add_u32 m0, s48, 20480
  s_nop 0
  buffer_load_dwordx4 v10, s[12:15], s37 offen lds
  s_add_u32 m0, s48, 21504
  s_nop 0
  buffer_load_dwordx4 v11, s[12:15], s37 offen lds
  s_add_u32 m0, s48, 22528
  s_nop 0
  buffer_load_dwordx4 v12, s[12:15], s37 offen lds
  s_add_u32 m0, s48, 23552
  s_nop 0
  buffer_load_dwordx4 v13, s[12:15], s37 offen lds
  s_lshl_b32 s38, s78, 7
  s_add_u32 m0, s49, 0
  s_nop 0
  buffer_load_dwordx4 v16, s[8:11], s38 offen lds
  s_add_u32 m0, s49, 1024
  s_nop 0
  buffer_load_dwordx4 v17, s[8:11], s38 offen lds
  s_add_u32 m0, s49, 2048
  s_nop 0
  buffer_load_dwordx4 v18, s[8:11], s38 offen lds
  s_lshl_b32 s38, s78, 7
  s_add_u32 m0, s49, 3072
  s_nop 0
  buffer_load_dwordx4 v19, s[8:11], s38 offen lds
  s_add_u32 m0, s49, 4096
  s_nop 0
  buffer_load_dwordx4 v20, s[8:11], s38 offen lds
  s_add_u32 m0, s49, 5120
  s_nop 0
  buffer_load_dwordx4 v21, s[8:11], s38 offen lds
  s_waitcnt vmcnt(24)
  s_barrier
  s_mul_i32 s37, s78, 245760
  s_add_u32 m0, s48, 36864
  s_nop 0
  buffer_load_dwordx4 v8, s[12:15], s37 offen lds
  s_add_u32 m0, s48, 37888
  s_nop 0
  buffer_load_dwordx4 v9, s[12:15], s37 offen lds
  s_add_u32 m0, s48, 38912
  s_nop 0
  buffer_load_dwordx4 v10, s[12:15], s37 offen lds
  s_add_u32 m0, s48, 39936
  s_nop 0
  buffer_load_dwordx4 v11, s[12:15], s37 offen lds
  s_add_u32 m0, s48, 40960
  s_nop 0
  buffer_load_dwordx4 v12, s[12:15], s37 offen lds
  s_add_u32 m0, s48, 41984
  s_nop 0
  buffer_load_dwordx4 v13, s[12:15], s37 offen lds
  s_waitcnt vmcnt(18)
  s_barrier
  s_mul_i32 s37, s78, 245760
  s_add_u32 s37, s37, 122880
  s_add_u32 m0, s48, 55296
  s_nop 0
  buffer_load_dwordx4 v8, s[12:15], s37 offen lds
  s_add_u32 m0, s48, 56320
  s_nop 0
  buffer_load_dwordx4 v9, s[12:15], s37 offen lds
  s_add_u32 m0, s48, 57344
  s_nop 0
  buffer_load_dwordx4 v10, s[12:15], s37 offen lds
  s_add_u32 m0, s48, 58368
  s_nop 0
  buffer_load_dwordx4 v11, s[12:15], s37 offen lds
  s_add_u32 m0, s48, 59392
  s_nop 0
  buffer_load_dwordx4 v12, s[12:15], s37 offen lds
  s_add_u32 m0, s48, 60416
  s_nop 0
  buffer_load_dwordx4 v13, s[12:15], s37 offen lds
  s_lshl_b32 s38, s79, 7
  s_add_u32 m0, s49, 18432
  s_nop 0
  buffer_load_dwordx4 v16, s[8:11], s38 offen lds
  s_add_u32 m0, s49, 19456
  s_nop 0
  buffer_load_dwordx4 v17, s[8:11], s38 offen lds
  s_add_u32 m0, s49, 20480
  s_nop 0
  buffer_load_dwordx4 v18, s[8:11], s38 offen lds
  s_lshl_b32 s38, s79, 7
  s_add_u32 m0, s49, 21504
  s_nop 0
  buffer_load_dwordx4 v19, s[8:11], s38 offen lds
  s_add_u32 m0, s49, 22528
  s_nop 0
  buffer_load_dwordx4 v20, s[8:11], s38 offen lds
  s_add_u32 m0, s49, 23552
  s_nop 0
  buffer_load_dwordx4 v21, s[8:11], s38 offen lds
  s_waitcnt vmcnt(24)
  s_barrier
  s_mul_i32 s37, s79, 245760
  s_add_u32 m0, s48, 73728
  s_nop 0
  buffer_load_dwordx4 v8, s[12:15], s37 offen lds
  s_add_u32 m0, s48, 74752
  s_nop 0
  buffer_load_dwordx4 v9, s[12:15], s37 offen lds
  s_add_u32 m0, s48, 75776
  s_nop 0
  buffer_load_dwordx4 v10, s[12:15], s37 offen lds
  s_add_u32 m0, s48, 76800
  s_nop 0
  buffer_load_dwordx4 v11, s[12:15], s37 offen lds
  s_add_u32 m0, s48, 77824
  s_nop 0
  buffer_load_dwordx4 v12, s[12:15], s37 offen lds
  s_add_u32 m0, s48, 78848
  s_nop 0
  buffer_load_dwordx4 v13, s[12:15], s37 offen lds
  s_waitcnt vmcnt(18)
  s_barrier
  s_mul_i32 s37, s79, 245760
  s_add_u32 s37, s37, 122880
  s_add_u32 m0, s48, 0
  s_nop 0
  buffer_load_dwordx4 v8, s[12:15], s37 offen lds
  s_add_u32 m0, s48, 1024
  s_nop 0
  buffer_load_dwordx4 v9, s[12:15], s37 offen lds
  s_add_u32 m0, s48, 2048
  s_nop 0
  buffer_load_dwordx4 v10, s[12:15], s37 offen lds
  s_add_u32 m0, s48, 3072
  s_nop 0
  buffer_load_dwordx4 v11, s[12:15], s37 offen lds
  s_add_u32 m0, s48, 4096
  s_nop 0
  buffer_load_dwordx4 v12, s[12:15], s37 offen lds
  s_add_u32 m0, s48, 5120
  s_nop 0
  buffer_load_dwordx4 v13, s[12:15], s37 offen lds
  s_lshl_b32 s38, s80, 7
  s_add_u32 m0, s49, 36864
  s_nop 0
  buffer_load_dwordx4 v16, s[8:11], s38 offen lds
  s_add_u32 m0, s49, 37888
  s_nop 0
  buffer_load_dwordx4 v17, s[8:11], s38 offen lds
  s_add_u32 m0, s49, 38912
  s_nop 0
  buffer_load_dwordx4 v18, s[8:11], s38 offen lds
  s_lshl_b32 s38, s80, 7
  s_add_u32 m0, s49, 39936
  s_nop 0
  buffer_load_dwordx4 v19, s[8:11], s38 offen lds
  s_add_u32 m0, s49, 40960
  s_nop 0
  buffer_load_dwordx4 v20, s[8:11], s38 offen lds
  s_add_u32 m0, s49, 41984
  s_nop 0
  buffer_load_dwordx4 v21, s[8:11], s38 offen lds
  s_waitcnt vmcnt(24)
  s_barrier
  s_mul_i32 s37, s80, 245760
  s_add_u32 m0, s48, 18432
  s_nop 0
  buffer_load_dwordx4 v8, s[12:15], s37 offen lds
  s_add_u32 m0, s48, 19456
  s_nop 0
  buffer_load_dwordx4 v9, s[12:15], s37 offen lds
  s_add_u32 m0, s48, 20480
  s_nop 0
  buffer_load_dwordx4 v10, s[12:15], s37 offen lds
  s_add_u32 m0, s48, 21504
  s_nop 0
  buffer_load_dwordx4 v11, s[12:15], s37 offen lds
  s_add_u32 m0, s48, 22528
  s_nop 0
  buffer_load_dwordx4 v12, s[12:15], s37 offen lds
  s_add_u32 m0, s48, 23552
  s_nop 0
  buffer_load_dwordx4 v13, s[12:15], s37 offen lds
  s_waitcnt vmcnt(18)
  s_barrier
  s_mul_i32 s37, s80, 245760
  s_add_u32 s37, s37, 122880
  s_add_u32 m0, s48, 36864
  s_nop 0
  buffer_load_dwordx4 v8, s[12:15], s37 offen lds
  s_add_u32 m0, s48, 37888
  s_nop 0
  buffer_load_dwordx4 v9, s[12:15], s37 offen lds
  s_add_u32 m0, s48, 38912
  s_nop 0
  buffer_load_dwordx4 v10, s[12:15], s37 offen lds
  s_add_u32 m0, s48, 39936
  s_nop 0
  buffer_load_dwordx4 v11, s[12:15], s37 offen lds
  s_add_u32 m0, s48, 40960
  s_nop 0
  buffer_load_dwordx4 v12, s[12:15], s37 offen lds
  s_add_u32 m0, s48, 41984
  s_nop 0
  buffer_load_dwordx4 v13, s[12:15], s37 offen lds
  s_lshl_b32 s38, s81, 7
  s_add_u32 m0, s49, 0
  s_nop 0
  buffer_load_dwordx4 v16, s[8:11], s38 offen lds
  s_add_u32 m0, s49, 1024
  s_nop 0
  buffer_load_dwordx4 v17, s[8:11], s38 offen lds
  s_add_u32 m0, s49, 2048
  s_nop 0
  buffer_load_dwordx4 v18, s[8:11], s38 offen lds
  s_lshl_b32 s38, s81, 7
  s_add_u32 m0, s49, 3072
  s_nop 0
  buffer_load_dwordx4 v19, s[8:11], s38 offen lds
  s_add_u32 m0, s49, 4096
  s_nop 0
  buffer_load_dwordx4 v20, s[8:11], s38 offen lds
  s_add_u32 m0, s49, 5120
  s_nop 0
  buffer_load_dwordx4 v21, s[8:11], s38 offen lds
  s_waitcnt vmcnt(24)
  s_barrier
  s_mul_i32 s37, s81, 245760
  s_add_u32 m0, s48, 55296
  s_nop 0
  buffer_load_dwordx4 v8, s[12:15], s37 offen lds
  s_add_u32 m0, s48, 56320
  s_nop 0
  buffer_load_dwordx4 v9, s[12:15], s37 offen lds
  s_add_u32 m0, s48, 57344
  s_nop 0
  buffer_load_dwordx4 v10, s[12:15], s37 offen lds
  s_add_u32 m0, s48, 58368
  s_nop 0
  buffer_load_dwordx4 v11, s[12:15], s37 offen lds
  s_add_u32 m0, s48, 59392
  s_nop 0
  buffer_load_dwordx4 v12, s[12:15], s37 offen lds
  s_add_u32 m0, s48, 60416
  s_nop 0
  buffer_load_dwordx4 v13, s[12:15], s37 offen lds
  s_waitcnt vmcnt(18)
  s_barrier
  s_mul_i32 s37, s81, 245760
  s_add_u32 s37, s37, 122880
  s_add_u32 m0, s48, 73728
  s_nop 0
  buffer_load_dwordx4 v8, s[12:15], s37 offen lds
  s_add_u32 m0, s48, 74752
  s_nop 0
  buffer_load_dwordx4 v9, s[12:15], s37 offen lds
  s_add_u32 m0, s48, 75776
  s_nop 0
  buffer_load_dwordx4 v10, s[12:15], s37 offen lds
  s_add_u32 m0, s48, 76800
  s_nop 0
  buffer_load_dwordx4 v11, s[12:15], s37 offen lds
  s_add_u32 m0, s48, 77824
  s_nop 0
  buffer_load_dwordx4 v12, s[12:15], s37 offen lds
  s_add_u32 m0, s48, 78848
  s_nop 0
  buffer_load_dwordx4 v13, s[12:15], s37 offen lds
  s_waitcnt vmcnt(18)
  s_barrier
  s_waitcnt vmcnt(6)
  s_barrier
  s_waitcnt vmcnt(0)
  s_barrier
  s_barrier
  s_barrier
  s_mov_b32 s44, 159488
  s_branch L2_p
L_prodH:
  s_mul_i32 s27, s55, 320
  v_add_u32 v79, s27, v0
  v_mov_b32 v77, 1073741824
  s_mul_i32 s48, s55, 5120
  s_mul_i32 s49, s55, 6144
  s_add_u32 s49, s49, 76800
  s_mov_b32 s72, s36
  s_mul_i32 s29, s26, 448
  s_waitcnt lgkmcnt(0)
  s_mov_b32 s8, s4
  s_and_b32 s9, s5, 0xffff
  s_mov_b32 s10, 2621440
  s_mov_b32 s11, 0x20000
  s_cmp_eq_u32 s3, 0
  s_cselect_b32 s12, s6, s20
  s_cselect_b32 s13, s7, s21
  s_mov_b32 s27, 2211840
  s_cselect_b32 s14, 2457600, s27
  s_and_b32 s13, s13, 0xffff
  s_mov_b32 s15, 0x20000
  s_lshl_b32 s38, s72, 7
  s_add_u32 m0, s49, 0
  s_nop 0
  buffer_load_dwordx4 v16, s[8:11], s38 offen lds
  s_add_u32 m0, s49, 1024
  s_nop 0
  buffer_load_dwordx4 v17, s[8:11], s38 offen lds
  s_add_u32 m0, s49, 2048
  s_nop 0
  buffer_load_dwordx4 v18, s[8:11], s38 offen lds
  s_lshl_b32 s38, s72, 7
  s_add_u32 m0, s49, 3072
  s_nop 0
  buffer_load_dwordx4 v19, s[8:11], s38 offen lds
  s_add_u32 m0, s49, 4096
  s_nop 0
  buffer_load_dwordx4 v20, s[8:11], s38 offen lds
  s_add_u32 m0, s49, 5120
  s_nop 0
  buffer_load_dwordx4 v21, s[8:11], s38 offen lds
  s_mul_i32 s37, s72, 221184
  v_add_u32 v72, 0, v79
  v_mul_u32_u24 v73, 2341, v72
  v_lshrrev_b32 v73, 16, v73
  v_mul_u32_u24 v74, 28, v73
  v_sub_u32 v74, v72, v74
  v_lshrrev_b32 v75, 2, v73
  v_and_b32 v75, 2, v75
  v_xor_b32 v74, v74, v75
  v_cmp_gt_u32 vcc, 32, v73
  v_mul_u32_u24 v73, 3456, v73
  v_lshl_add_u32 v73, v74, 4, v73
  v_add_u32 v73, s29, v73
  v_cndmask_b32 v8, v77, v73, vcc
  s_add_u32 m0, s48, 0
  s_nop 0
  buffer_load_dwordx4 v8, s[12:15], s37 offen lds
  v_add_u32 v72, 64, v79
  v_mul_u32_u24 v73, 2341, v72
  v_lshrrev_b32 v73, 16, v73
  v_mul_u32_u24 v74, 28, v73
  v_sub_u32 v74, v72, v74
  v_lshrrev_b32 v75, 2, v73
  v_and_b32 v75, 2, v75
  v_xor_b32 v74, v74, v75
  v_cmp_gt_u32 vcc, 32, v73
  v_mul_u32_u24 v73, 3456, v73
  v_lshl_add_u32 v73, v74, 4, v73
  v_add_u32 v73, s29, v73
  v_cndmask_b32 v9, v77, v73, vcc
  s_add_u32 m0, s48, 1024
  s_nop 0
  buffer_load_dwordx4 v9, s[12:15], s37 offen lds
  v_add_u32 v72, 128, v79
  v_mul_u32_u24 v73, 2341, v72
  v_lshrrev_b32 v73, 16, v73
  v_mul_u32_u24 v74, 28, v73
  v_sub_u32 v74, v72, v74
  v_lshrrev_b32 v75, 2, v73
  v_and_b32 v75, 2, v75
  v_xor_b32 v74, v74, v75
  v_cmp_gt_u32 vcc, 32, v73
  v_mul_u32_u24 v73, 3456, v73
  v_lshl_add_u32 v73, v74, 4, v73
  v_add_u32 v73, s29, v73
  v_cndmask_b32 v10, v77, v73, vcc
  s_add_u32 m0, s48, 2048
  s_nop 0
  buffer_load_dwordx4 v10, s[12:15], s37 offen lds
  v_add_u32 v72, 192, v79
  v_mul_u32_u24 v73, 2341, v72
  v_lshrrev_b32 v73, 16, v73
  v_mul_u32_u24 v74, 28, v73
  v_sub_u32 v74, v72, v74
  v_lshrrev_b32 v75, 2, v73
  v_and_b32 v75, 2, v75
  v_xor_b32 v74, v74, v75
  v_cmp_gt_u32 vcc, 32, v73
  v_mul_u32_u24 v73, 3456, v73
  v_lshl_add_u32 v73, v74, 4, v73
  v_add_u32 v73, s29, v73
  v_cndmask_b32 v11, v77, v73, vcc
  s_add_u32 m0, s48, 3072
  s_nop 0
  buffer_load_dwordx4 v11, s[12:15], s37 offen lds
  v_add_u32 v72, 256, v79
  v_mul_u32_u24 v73, 2341, v72
  v_lshrrev_b32 v73, 16, v73
  v_mul_u32_u24 v74, 28, v73
  v_sub_u32 v74, v72, v74
  v_lshrrev_b32 v75, 2, v73
  v_and_b32 v75, 2, v75
  v_xor_b32 v74, v74, v75
  v_cmp_gt_u32 vcc, 32, v73
  v_mul_u32_u24 v73, 3456, v73
  v_lshl_add_u32 v73, v74, 4, v73
  v_add_u32 v73, s29, v73
  v_cndmask_b32 v12, v77, v73, vcc
  s_add_u32 m0, s48, 4096
  s_nop 0
  buffer_load_dwordx4 v12, s[12:15], s37 offen lds
  s_mul_i32 s37, s72, 221184
  s_add_u32 s37, s37, 110592
  s_add_u32 m0, s48, 15360
  s_nop 0
  buffer_load_dwordx4 v8, s[12:15], s37 offen lds
  s_add_u32 m0, s48, 16384
  s_nop 0
  buffer_load_dwordx4 v9, s[12:15], s37 offen lds
  s_add_u32 m0, s48, 17408
  s_nop 0
  buffer_load_dwordx4 v10, s[12:15], s37 offen lds
  s_add_u32 m0, s48, 18432
  s_nop 0
  buffer_load_dwordx4 v11, s[12:15], s37 offen lds
  s_add_u32 m0, s48, 19456
  s_nop 0
  buffer_load_dwordx4 v12, s[12:15], s37 offen lds
  s_mov_b32 s28, s36
  s_add_u32 s73, s28, 1
  s_cmp_ge_u32 s73, 5
  s_cselect_b32 s27, 5, 0
  s_sub_u32 s73, s73, s27
  s_add_u32 s74, s28, 2
  s_cmp_ge_u32 s74, 5
  s_cselect_b32 s27, 5, 0
  s_sub_u32 s74, s74, s27
  s_add_u32 s75, s28, 3
  s_cmp_ge_u32 s75, 5
  s_cselect_b32 s27, 5, 0
  s_sub_u32 s75, s75, s27
  s_add_u32 s76, s28, 4
  s_cmp_ge_u32 s76, 5
  s_cselect_b32 s27, 5, 0
  s_sub_u32 s76, s76, s27
  s_mul_i32 s27, s41, 13108
  s_lshr_b32 s27, s27, 16
  s_mul_i32 s27, s27, 5
  s_sub_u32 s28, s41, s27
  s_add_u32 s77, s28, 0
  s_cmp_ge_u32 s77, 5
  s_cselect_b32 s27, 5, 0
  s_sub_u32 s77, s77, s27
  s_add_u32 s77, s77, 5
  s_add_u32 s78, s28, 1
  s_cmp_ge_u32 s78, 5
  s_cselect_b32 s27, 5, 0
  s_sub_u32 s78, s78, s27
  s_add_u32 s78, s78, 5
  s_add_u32 s79, s28, 2
  s_cmp_ge_u32 s79, 5
  s_cselect_b32 s27, 5, 0
  s_sub_u32 s79, s79, s27
  s_add_u32 s79, s79, 5
  s_add_u32 s80, s28, 3
  s_cmp_ge_u32 s80, 5
  s_cselect_b32 s27, 5, 0
  s_sub_u32 s80, s80, s27
  s_add_u32 s80, s80, 5
  s_add_u32 s81, s28, 4
  s_cmp_ge_u32 s81, 5
  s_cselect_b32 s27, 5, 0
  s_sub_u32 s81, s81, s27
  s_add_u32 s81, s81, 5
  s_mul_i32 s37, s73, 221184
  s_add_u32 m0, s48, 30720
  s_nop 0
  buffer_load_dwordx4 v8, s[12:15], s37 offen lds
  s_add_u32 m0, s48, 31744
  s_nop 0
  buffer_load_dwordx4 v9, s[12:15], s37 offen lds
  s_add_u32 m0, s48, 32768
  s_nop 0
  buffer_load_dwordx4 v10, s[12:15], s37 offen lds
  s_add_u32 m0, s48, 33792
  s_nop 0
  buffer_load_dwordx4 v11, s[12:15], s37 offen lds
  s_add_u32 m0, s48, 34816
  s_nop 0
  buffer_load_dwordx4 v12, s[12:15], s37 offen lds
  s_lshl_b32 s38, s73, 7
  s_add_u32 m0, s49, 18432
  s_nop 0
  buffer_load_dwordx4 v16, s[8:11], s38 offen lds
  s_add_u32 m0, s49, 19456
  s_nop 0
  buffer_load_dwordx4 v17, s[8:11], s38 offen lds
  s_add_u32 m0, s49, 20480
  s_nop 0
  buffer_load_dwordx4 v18, s[8:11], s38 offen lds
  s_lshl_b32 s38, s73, 7
  s_add_u32 m0, s49, 21504
  s_nop 0
  buffer_load_dwordx4 v19, s[8:11], s38 offen lds
  s_add_u32 m0, s49, 22528
  s_nop 0
  buffer_load_dwordx4 v20, s[8:11], s38 offen lds
  s_add_u32 m0, s49, 23552
  s_nop 0
  buffer_load_dwordx4 v21, s[8:11], s38 offen lds
  s_waitcnt vmcnt(11)
  s_barrier
  s_mul_i32 s37, s73, 221184
  s_add_u32 s37, s37, 110592
  s_add_u32 m0, s48, 46080
  s_nop 0
  buffer_load_dwordx4 v8, s[12:15], s37 offen lds
  s_add_u32 m0, s48, 47104
  s_nop 0
  buffer_load_dwordx4 v9, s[12:15], s37 offen lds
  s_add_u32 m0, s48, 48128
  s_nop 0
  buffer_load_dwordx4 v10, s[12:15], s37 offen lds
  s_add_u32 m0, s48, 49152
  s_nop 0
  buffer_load_dwordx4 v11, s[12:15], s37 offen lds
  s_add_u32 m0, s48, 50176
  s_nop 0
  buffer_load_dwordx4 v12, s[12:15], s37 offen lds
  s_mul_i32 s37, s74, 221184
  s_add_u32 m0, s48, 61440
  s_nop 0
  buffer_load_dwordx4 v8, s[12:15], s37 offen lds
  s_add_u32 m0, s48, 62464
  s_nop 0
  buffer_load_dwordx4 v9, s[12:15], s37 offen lds
  s_add_u32 m0, s48, 63488
  s_nop 0
  buffer_load_dwordx4 v10, s[12:15], s37 offen lds
  s_add_u32 m0, s48, 64512
  s_nop 0
  buffer_load_dwordx4 v11, s[12:15], s37 offen lds
  s_add_u32 m0, s48, 65536
  s_nop 0
  buffer_load_dwordx4 v12, s[12:15], s37 offen lds
  s_lshl_b32 s38, s74, 7
  s_add_u32 m0, s49, 36864
  s_nop 0
  buffer_load_dwordx4 v16, s[8:11], s38 offen lds
  s_add_u32 m0, s49, 37888
  s_nop 0
  buffer_load_dwordx4 v17, s[8:11], s38 offen lds
  s_add_u32 m0, s49, 38912
  s_nop 0
  buffer_load_dwordx4 v18, s[8:11], s38 offen lds
  s_lshl_b32 s38, s74, 7
  s_add_u32 m0, s49, 39936
  s_nop 0
  buffer_load_dwordx4 v19, s[8:11], s38 offen lds
  s_add_u32 m0, s49, 40960
  s_nop 0
  buffer_load_dwordx4 v20, s[8:11], s38 offen lds
  s_add_u32 m0, s49, 41984
  s_nop 0
  buffer_load_dwordx4 v21, s[8:11], s38 offen lds
  s_waitcnt vmcnt(16)
  s_barrier
  s_mul_i32 s37, s74, 221184
  s_add_u32 s37, s37, 110592
  s_add_u32 m0, s48, 0
  s_nop 0
  buffer_load_dwordx4 v8, s[12:15], s37 offen lds
  s_add_u32 m0, s48, 1024
  s_nop 0
  buffer_load_dwordx4 v9, s[12:15], s37 offen lds
  s_add_u32 m0, s48, 2048
  s_nop 0
  buffer_load_dwordx4 v10, s[12:15], s37 offen lds
  s_add_u32 m0, s48, 3072
  s_nop 0
  buffer_load_dwordx4 v11, s[12:15], s37 offen lds
  s_add_u32 m0, s48, 4096
  s_nop 0
  buffer_load_dwordx4 v12, s[12:15], s37 offen lds
  s_lshl_b32 s38, s75, 7
  s_add_u32 m0, s49, 0
  s_nop 0
  buffer_load_dwordx4 v16, s[8:11], s38 offen lds
  s_add_u32 m0, s49, 1024
  s_nop 0
  buffer_load_dwordx4 v17, s[8:11], s38 offen lds
  s_add_u32 m0, s49, 2048
  s_nop 0
  buffer_load_dwordx4 v18, s[8:11], s38 offen lds
  s_lshl_b32 s38, s75, 7
  s_add_u32 m0, s49, 3072
  s_nop 0
  buffer_load_dwordx4 v19, s[8:11], s38 offen lds
  s_add_u32 m0, s49, 4096
  s_nop 0
  buffer_load_dwordx4 v20, s[8:11], s38 offen lds
  s_add_u32 m0, s49, 5120
  s_nop 0
  buffer_load_dwordx4 v21, s[8:11], s38 offen lds
  s_waitcnt vmcnt(22)
  s_barrier
  s_mul_i32 s37, s75, 221184
  s_add_u32 m0, s48, 15360
  s_nop 0
  buffer_load_dwordx4 v8, s[12:15], s37 offen lds
  s_add_u32 m0, s48, 16384
  s_nop 0
  buffer_load_dwordx4 v9, s[12:15], s37 offen lds
  s_add_u32 m0, s48, 17408
  s_nop 0
  buffer_load_dwordx4 v10, s[12:15], s37 offen lds
  s_add_u32 m0, s48, 18432
  s_nop 0
  buffer_load_dwordx4 v11, s[12:15], s37 offen lds
  s_add_u32 m0, s48, 19456
  s_nop 0
  buffer_load_dwordx4 v12, s[12:15], s37 offen lds
  s_waitcnt vmcnt(16)
  s_barrier
  s_mul_i32 s37, s75, 221184
  s_add_u32 s37, s37, 110592
  s_add_u32 m0, s48, 30720
  s_nop 0
  buffer_load_dwordx4 v8, s[12:15], s37 offen lds
  s_add_u32 m0, s48, 31744
  s_nop 0
  buffer_load_dwordx4 v9, s[12:15], s37 offen lds
  s_add_u32 m0, s48, 32768
  s_nop 0
  buffer_load_dwordx4 v10, s[12:15], s37 offen lds
  s_add_u32 m0, s48, 33792
  s_nop 0
  buffer_load_dwordx4 v11, s[12:15], s37 offen lds
  s_add_u32 m0, s48, 34816
  s_nop 0
  buffer_load_dwordx4 v12, s[12:15], s37 offen lds
  s_lshl_b32 s38, s76, 7
  s_add_u32 m0, s49, 18432
  s_nop 0
  buffer_load_dwordx4 v16, s[8:11], s38 offen lds
  s_add_u32 m0, s49, 19456
  s_nop 0
  buffer_load_dwordx4 v17, s[8:11], s38 offen lds
  s_add_u32 m0, s49, 20480
  s_nop 0
  buffer_load_dwordx4 v18, s[8:11], s38 offen lds
  s_lshl_b32 s38, s76, 7
  s_add_u32 m0, s49, 21504
  s_nop 0
  buffer_load_dwordx4 v19, s[8:11], s38 offen lds
  s_add_u32 m0, s49, 22528
  s_nop 0
  buffer_load_dwordx4 v20, s[8:11], s38 offen lds
  s_add_u32 m0, s49, 23552
  s_nop 0
  buffer_load_dwordx4 v21, s[8:11], s38 offen lds
  s_waitcnt vmcnt(22)
  s_barrier
  s_mul_i32 s37, s76, 221184
  s_add_u32 m0, s48, 46080
  s_nop 0
  buffer_load_dwordx4 v8, s[12:15], s37 offen lds
  s_add_u32 m0, s48, 47104
  s_nop 0
  buffer_load_dwordx4 v9, s[12:15], s37 offen lds
  s_add_u32 m0, s48, 48128
  s_nop 0
  buffer_load_dwordx4 v10, s[12:15], s37 offen lds
  s_add_u32 m0, s48, 49152
  s_nop 0
  buffer_load_dwordx4 v11, s[12:15], s37 offen lds
  s_add_u32 m0, s48, 50176
  s_nop 0
  buffer_load_dwordx4 v12, s[12:15], s37 offen lds
  s_waitcnt vmcnt(16)
  s_barrier
  s_mul_i32 s37, s76, 221184
  s_add_u32 s37, s37, 110592
  s_add_u32 m0, s48, 61440
  s_nop 0
  buffer_load_dwordx4 v8, s[12:15], s37 offen lds
  s_add_u32 m0, s48, 62464
  s_nop 0
  buffer_load_dwordx4 v9, s[12:15], s37 offen lds
  s_add_u32 m0, s48, 63488
  s_nop 0
  buffer_load_dwordx4 v10, s[12:15], s37 offen lds
  s_add_u32 m0, s48, 64512
  s_nop 0
  buffer_load_dwordx4 v11, s[12:15], s37 offen lds
  s_add_u32 m0, s48, 65536
  s_nop 0
  buffer_load_dwordx4 v12, s[12:15], s37 offen lds
  s_lshl_b32 s38, s77, 7
  s_add_u32 m0, s49, 36864
  s_nop 0
  buffer_load_dwordx4 v16, s[8:11], s38 offen lds
  s_add_u32 m0, s49, 37888
  s_nop 0
  buffer_load_dwordx4 v17, s[8:11], s38 offen lds
  s_add_u32 m0, s49, 38912
  s_nop 0
  buffer_load_dwordx4 v18, s[8:11], s38 offen lds
  s_lshl_b32 s38, s77, 7
  s_add_u32 m0, s49, 39936
  s_nop 0
  buffer_load_dwordx4 v19, s[8:11], s38 offen lds
  s_add_u32 m0, s49, 40960
  s_nop 0
  buffer_load_dwordx4 v20, s[8:11], s38 offen lds
  s_add_u32 m0, s49, 41984
  s_nop 0
  buffer_load_dwordx4 v21, s[8:11], s38 offen lds
  s_waitcnt vmcnt(22)
  s_barrier
  s_mul_i32 s37, s77, 221184
  s_add_u32 m0, s48, 0
  s_nop 0
  buffer_load_dwordx4 v8, s[12:15], s37 offen lds
  s_add_u32 m0, s48, 1024
  s_nop 0
  buffer_load_dwordx4 v9, s[12:15], s37 offen lds
  s_add_u32 m0, s48, 2048
  s_nop 0
  buffer_load_dwordx4 v10, s[12:15], s37 offen lds
  s_add_u32 m0, s48, 3072
  s_nop 0
  buffer_load_dwordx4 v11, s[12:15], s37 offen lds
  s_add_u32 m0, s48, 4096
  s_nop 0
  buffer_load_dwordx4 v12, s[12:15], s37 offen lds
  s_waitcnt vmcnt(16)
  s_barrier
  s_mul_i32 s37, s77, 221184
  s_add_u32 s37, s37, 110592
  s_add_u32 m0, s48, 15360
  s_nop 0
  buffer_load_dwordx4 v8, s[12:15], s37 offen lds
  s_add_u32 m0, s48, 16384
  s_nop 0
  buffer_load_dwordx4 v9, s[12:15], s37 offen lds
  s_add_u32 m0, s48, 17408
  s_nop 0
  buffer_load_dwordx4 v10, s[12:15], s37 offen lds
  s_add_u32 m0, s48, 18432
  s_nop 0
  buffer_load_dwordx4 v11, s[12:15], s37 offen lds
  s_add_u32 m0, s48, 19456
  s_nop 0
  buffer_load_dwordx4 v12, s[12:15], s37 offen lds
  s_lshl_b32 s38, s78, 7
  s_add_u32 m0, s49, 0
  s_nop 0
  buffer_load_dwordx4 v16, s[8:11], s38 offen lds
  s_add_u32 m0, s49, 1024
  s_nop 0
  buffer_load_dwordx4 v17, s[8:11], s38 offen lds
  s_add_u32 m0, s49, 2048
  s_nop 0
  buffer_load_dwordx4 v18, s[8:11], s38 offen lds
  s_lshl_b32 s38, s78, 7
  s_add_u32 m0, s49, 3072
  s_nop 0
  buffer_load_dwordx4 v19, s[8:11], s38 offen lds
  s_add_u32 m0, s49, 4096
  s_nop 0
  buffer_load_dwordx4 v20, s[8:11], s38 offen lds
  s_add_u32 m0, s49, 5120
  s_nop 0
  buffer_load_dwordx4 v21, s[8:11], s38 offen lds
  s_waitcnt vmcnt(22)
  s_barrier
  s_mul_i32 s37, s78, 221184
  s_add_u32 m0, s48, 30720
  s_nop 0
  buffer_load_dwordx4 v8, s[12:15], s37 offen lds
  s_add_u32 m0, s48, 31744
  s_nop 0
  buffer_load_dwordx4 v9, s[12:15], s37 offen lds
  s_add_u32 m0, s48, 32768
  s_nop 0
  buffer_load_dwordx4 v10, s[12:15], s37 offen lds
  s_add_u32 m0, s48, 33792
  s_nop 0
  buffer_load_dwordx4 v11, s[12:15], s37 offen lds
  s_add_u32 m0, s48, 34816
  s_nop 0
  buffer_load_dwordx4 v12, s[12:15], s37 offen lds
  s_waitcnt vmcnt(16)
  s_barrier
  s_mul_i32 s37, s78, 221184
  s_add_u32 s37, s37, 110592
  s_add_u32 m0, s48, 46080
  s_nop 0
  buffer_load_dwordx4 v8, s[12:15], s37 offen lds
  s_add_u32 m0, s48, 47104
  s_nop 0
  buffer_load_dwordx4 v9, s[12:15], s37 offen lds
  s_add_u32 m0, s48, 48128
  s_nop 0
  buffer_load_dwordx4 v10, s[12:15], s37 offen lds
  s_add_u32 m0, s48, 49152
  s_nop 0
  buffer_load_dwordx4 v11, s[12:15], s37 offen lds
  s_add_u32 m0, s48, 50176
  s_nop 0
  buffer_load_dwordx4 v12, s[12:15], s37 offen lds
  s_lshl_b32 s38, s79, 7
  s_add_u32 m0, s49, 18432
  s_nop 0
  buffer_load_dwordx4 v16, s[8:11], s38 offen lds
  s_add_u32 m0, s49, 19456
  s_nop 0
  buffer_load_dwordx4 v17, s[8:11], s38 offen lds
  s_add_u32 m0, s49, 20480
  s_nop 0
  buffer_load_dwordx4 v18, s[8:11], s38 offen lds
  s_lshl_b32 s38, s79, 7
  s_add_u32 m0, s49, 21504
  s_nop 0
  buffer_load_dwordx4 v19, s[8:11], s38 offen lds
  s_add_u32 m0, s49, 22528
  s_nop 0
  buffer_load_dwordx4 v20, s[8:11], s38 offen lds
  s_add_u32 m0, s49, 23552
  s_nop 0
  buffer_load_dwordx4 v21, s[8:11], s38 offen lds
  s_waitcnt vmcnt(22)
  s_barrier
  s_mul_i32 s37, s79, 221184
  s_add_u32 m0, s48, 61440
  s_nop 0
  buffer_load_dwordx4 v8, s[12:15], s37 offen lds
  s_add_u32 m0, s48, 62464
  s_nop 0
  buffer_load_dwordx4 v9, s[12:15], s37 offen lds
  s_add_u32 m0, s48, 63488
  s_nop 0
  buffer_load_dwordx4 v10, s[12:15], s37 offen lds
  s_add_u32 m0, s48, 64512
  s_nop 0
  buffer_load_dwordx4 v11, s[12:15], s37 offen lds
  s_add_u32 m0, s48, 65536
  s_nop 0
  buffer_load_dwordx4 v12, s[12:15], s37 offen lds
  s_waitcnt vmcnt(16)
  s_barrier
  s_mul_i32 s37, s79, 221184
  s_add_u32 s37, s37, 110592
  s_add_u32 m0, s48, 0
  s_nop 0
  buffer_load_dwordx4 v8, s[12:15], s37 offen lds
  s_add_u32 m0, s48, 1024
  s_nop 0
  buffer_load_dwordx4 v9, s[12:15], s37 offen lds
  s_add_u32 m0, s48, 2048
  s_nop 0
  buffer_load_dwordx4 v10, s[12:15], s37 offen lds
  s_add_u32 m0, s48, 3072
  s_nop 0
  buffer_load_dwordx4 v11, s[12:15], s37 offen lds
  s_add_u32 m0, s48, 4096
  s_nop 0
  buffer_load_dwordx4 v12, s[12:15], s37 offen lds
  s_lshl_b32 s38, s80, 7
  s_add_u32 m0, s49, 36864
  s_nop 0
  buffer_load_dwordx4 v16, s[8:11], s38 offen lds
  s_add_u32 m0, s49, 37888
  s_nop 0
  buffer_load_dwordx4 v17, s[8:11], s38 offen lds
  s_add_u32 m0, s49, 38912
  s_nop 0
  buffer_load_dwordx4 v18, s[8:11], s38 offen lds
  s_lshl_b32 s38, s80, 7
  s_add_u32 m0, s49, 39936
  s_nop 0
  buffer_load_dwordx4 v19, s[8:11], s38 offen lds
  s_add_u32 m0, s49, 40960
  s_nop 0
  buffer_load_dwordx4 v20, s[8:11], s38 offen lds
  s_add_u32 m0, s49, 41984
  s_nop 0
  buffer_load_dwordx4 v21, s[8:11], s38 offen lds
  s_waitcnt vmcnt(22)
  s_barrier
  s_mul_i32 s37, s80, 221184
  s_add_u32 m0, s48, 15360
  s_nop 0
  buffer_load_dwordx4 v8, s[12:15], s37 offen lds
  s_add_u32 m0, s48, 16384
  s_nop 0
  buffer_load_dwordx4 v9, s[12:15], s37 offen lds
  s_add_u32 m0, s48, 17408
  s_nop 0
  buffer_load_dwordx4 v10, s[12:15], s37 offen lds
  s_add_u32 m0, s48, 18432
  s_nop 0
  buffer_load_dwordx4 v11, s[12:15], s37 offen lds
  s_add_u32 m0, s48, 19456
  s_nop 0
  buffer_load_dwordx4 v12, s[12:15], s37 offen lds
  s_waitcnt vmcnt(16)
  s_barrier
  s_mul_i32 s37, s80, 221184
  s_add_u32 s37, s37, 110592
  s_add_u32 m0, s48, 30720
  s_nop 0
  buffer_load_dwordx4 v8, s[12:15], s37 offen lds
  s_add_u32 m0, s48, 31744
  s_nop 0
  buffer_load_dwordx4 v9, s[12:15], s37 offen lds
  s_add_u32 m0, s48, 32768
  s_nop 0
  buffer_load_dwordx4 v10, s[12:15], s37 offen lds
  s_add_u32 m0, s48, 33792
  s_nop 0
  buffer_load_dwordx4 v11, s[12:15], s37 offen lds
  s_add_u32 m0, s48, 34816
  s_nop 0
  buffer_load_dwordx4 v12, s[12:15], s37 offen lds
  s_lshl_b32 s38, s81, 7
  s_add_u32 m0, s49, 0
  s_nop 0
  buffer_load_dwordx4 v16, s[8:11], s38 offen lds
  s_add_u32 m0, s49, 1024
  s_nop 0
  buffer_load_dwordx4 v17, s[8:11], s38 offen lds
  s_add_u32 m0, s49, 2048
  s_nop 0
  buffer_load_dwordx4 v18, s[8:11], s38 offen lds
  s_lshl_b32 s38, s81, 7
  s_add_u32 m0, s49, 3072
  s_nop 0
  buffer_load_dwordx4 v19, s[8:11], s38 offen lds
  s_add_u32 m0, s49, 4096
  s_nop 0
  buffer_load_dwordx4 v20, s[8:11], s38 offen lds
  s_add_u32 m0, s49, 5120
  s_nop 0
  buffer_load_dwordx4 v21, s[8:11], s38 offen lds
  s_waitcnt vmcnt(22)
  s_barrier
  s_mul_i32 s37, s81, 221184
  s_add_u32 m0, s48, 46080
  s_nop 0
  buffer_load_dwordx4 v8, s[12:15], s37 offen lds
  s_add_u32 m0, s48, 47104
  s_nop 0
  buffer_load_dwordx4 v9, s[12:15], s37 offen lds
  s_add_u32 m0, s48, 48128
  s_nop 0
  buffer_load_dwordx4 v10, s[12:15], s37 offen lds
  s_add_u32 m0, s48, 49152
  s_nop 0
  buffer_load_dwordx4 v11, s[12:15], s37 offen lds
  s_add_u32 m0, s48, 50176
  s_nop 0
  buffer_load_dwordx4 v12, s[12:15], s37 offen lds
  s_waitcnt vmcnt(16)
  s_barrier
  s_mul_i32 s37, s81, 221184
  s_add_u32 s37, s37, 110592
  s_add_u32 m0, s48, 61440
  s_nop 0
  buffer_load_dwordx4 v8, s[12:15], s37 offen lds
  s_add_u32 m0, s48, 62464
  s_nop 0
  buffer_load_dwordx4 v9, s[12:15], s37 offen lds
  s_add_u32 m0, s48, 63488
  s_nop 0
  buffer_load_dwordx4 v10, s[12:15], s37 offen lds
  s_add_u32 m0, s48, 64512
  s_nop 0
  buffer_load_dwordx4 v11, s[12:15], s37 offen lds
  s_add_u32 m0, s48, 65536
  s_nop 0
  buffer_load_dwordx4 v12, s[12:15], s37 offen lds
  s_waitcnt vmcnt(16)
  s_barrier
  s_waitcnt vmcnt(5)
  s_barrier
  s_waitcnt vmcnt(0)
  s_barrier
  s_barrier
  s_barrier
  s_mov_b32 s44, 159488
  s_branch L2_p
L2_p:
  s_mov_b32 s16, s70
  s_and_b32 s17, s71, 0xffff
  s_mov_b32 s18, 268435456
  s_mov_b32 s19, 0x20000
  v_lshlrev_b32 v8, 4, v0
  s_sub_u32 s55, s24, 4
  s_mul_i32 s48, s86, 303104
  s_add_u32 s48, s48, 0
  s_mul_i32 s49, s87, 378880
  s_add_u32 s49, s49, 16769024
  s_mul_i32 s55, s55, 6
  s_add_u32 s27, s55, 0
  s_lshl_b32 s28, s27, 10
  s_cmp_lt_u32 s27, 8
  s_cselect_b32 s62, s48, s49
  s_movk_i32 s29, 0x2800
  s_cselect_b32 s68, 0x2000, s29
  s_cselect_b32 s74, 1, 0
  s_add_u32 s62, s62, s28
  s_add_u32 s27, s55, 1
  s_lshl_b32 s28, s27, 10
  s_cmp_lt_u32 s27, 8
  s_cselect_b32 s63, s48, s49
  s_movk_i32 s29, 0x2800
  s_cselect_b32 s69, 0x2000, s29
  s_cselect_b32 s75, 1, 0
  s_add_u32 s63, s63, s28
  s_add_u32 s27, s55, 2
  s_lshl_b32 s28, s27, 10
  s_cmp_lt_u32 s27, 8
  s_cselect_b32 s64, s48, s49
  s_movk_i32 s29, 0x2800
  s_cselect_b32 s70, 0x2000, s29
  s_cselect_b32 s76, 1, 0
  s_add_u32 s64, s64, s28
  s_add_u32 s27, s55, 3
  s_lshl_b32 s28, s27, 10
  s_cmp_lt_u32 s27, 8
  s_cselect_b32 s65, s48, s49
  s_movk_i32 s29, 0x2800
  s_cselect_b32 s71, 0x2000, s29
  s_cselect_b32 s77, 1, 0
  s_add_u32 s65, s65, s28
  s_add_u32 s27, s55, 4
  s_lshl_b32 s28, s27, 10
  s_cmp_lt_u32 s27, 8
  s_cselect_b32 s66, s48, s49
  s_movk_i32 s29, 0x2800
  s_cselect_b32 s72, 0x2000, s29
  s_cselect_b32 s78, 1, 0
  s_add_u32 s66, s66, s28
  s_add_u32 s27, s55, 5
  s_lshl_b32 s28, s27, 10
  s_cmp_lt_u32 s27, 8
  s_cselect_b32 s67, s48, s49
  s_movk_i32 s29, 0x2800
  s_cselect_b32 s73, 0x2000, s29
  s_cselect_b32 s79, 1, 0
  s_add_u32 s67, s67, s28
  s_lshl_b32 s55, s55, 10
  s_add_u32 s49, s55, 92160
  s_mov_b32 s61, -27
  s_cmp_eq_u32 s3, 0
  s_cselect_b32 s80, 10, 10
  s_cselect_b32 s81, 27, 27
  s_cselect_b32 s82, 10, 10
  s_cselect_b32 s83, s61, s61
  s_cselect_b32 s60, s61, s61
  s_barrier
  s_cmp_eq_u32 s3, 0
  s_cselect_b32 s27, 150272, s44
  v_mov_b32 v9, s27
  s_cmp_eq_u32 s3, 0
  s_cbranch_scc0 L2_q_1
  s_barrier
L2_q_1:
  s_mov_b32 s30, 0
L2_fl_3:
  ds_read_b32 v10, v9
  s_waitcnt lgkmcnt(0)
  v_readfirstlane_b32 s27, v10
  s_nop 2
  s_cmp_ge_u32 s27, 1
  s_cbranch_scc1 L2_flok_4
  s_add_u32 s30, s30, 1
  s_cmp_ge_u32 s30, 0x400000
  s_cbranch_scc1 L2_flok_4
  s_sleep 1
  s_branch L2_fl_3
L2_flok_4:
  s_cmp_eq_u32 s74, 0
  s_cbranch_scc0 L2_pk_5
  s_add_u32 s29, s80, 0
  s_mul_i32 s29, s29, s68
  s_add_u32 s29, s29, s62
  s_add_u32 m0, s55, 0
  s_nop 0
  buffer_load_dwordx4 v8, s[16:19], s29 offen sc1 lds
L2_pk_5:
  s_cmp_eq_u32 s75, 0
  s_cbranch_scc0 L2_pk_6
  s_add_u32 s29, s80, 0
  s_mul_i32 s29, s29, s69
  s_add_u32 s29, s29, s63
  s_add_u32 m0, s55, 1024
  s_nop 0
  buffer_load_dwordx4 v8, s[16:19], s29 offen sc1 lds
L2_pk_6:
  s_cmp_eq_u32 s76, 0
  s_cbranch_scc0 L2_pk_7
  s_add_u32 s29, s80, 0
  s_mul_i32 s29, s29, s70
  s_add_u32 s29, s29, s64
  s_add_u32 m0, s55, 2048
  s_nop 0
  buffer_load_dwordx4 v8, s[16:19], s29 offen sc1 lds
L2_pk_7:
  s_cmp_eq_u32 s77, 0
  s_cbranch_scc0 L2_pk_8
  s_add_u32 s29, s80, 0
  s_mul_i32 s29, s29, s71
  s_add_u32 s29, s29, s65
  s_add_u32 m0, s55, 3072
  s_nop 0
  buffer_load_dwordx4 v8, s[16:19], s29 offen sc1 lds
L2_pk_8:
  s_cmp_eq_u32 s78, 0
  s_cbranch_scc0 L2_pk_9
  s_add_u32 s29, s80, 0
  s_mul_i32 s29, s29, s72
  s_add_u32 s29, s29, s66
  s_add_u32 m0, s55, 4096
  s_nop 0
  buffer_load_dwordx4 v8, s[16:19], s29 offen sc1 lds
L2_pk_9:
  s_cmp_eq_u32 s79, 0
  s_cbranch_scc0 L2_pk_10
  s_add_u32 s29, s80, 0
  s_mul_i32 s29, s29, s73
  s_add_u32 s29, s29, s67
  s_add_u32 m0, s55, 5120
  s_nop 0
  buffer_load_dwordx4 v8, s[16:19], s29 offen sc1 lds
L2_pk_10:
  s_cmp_eq_u32 s74, 0
  s_cbranch_scc0 L2_pk_11
  s_add_u32 s29, s80, 1
  s_mul_i32 s29, s29, s68
  s_add_u32 s29, s29, s62
  s_add_u32 m0, s55, 18432
  s_nop 0
  buffer_load_dwordx4 v8, s[16:19], s29 offen sc1 lds
L2_pk_11:
  s_cmp_eq_u32 s75, 0
  s_cbranch_scc0 L2_pk_12
  s_add_u32 s29, s80, 1
  s_mul_i32 s29, s29, s69
  s_add_u32 s29, s29, s63
  s_add_u32 m0, s55, 19456
  s_nop 0
  buffer_load_dwordx4 v8, s[16:19], s29 offen sc1 lds
L2_pk_12:
  s_cmp_eq_u32 s76, 0
  s_cbranch_scc0 L2_pk_13
  s_add_u32 s29, s80, 1
  s_mul_i32 s29, s29, s70
  s_add_u32 s29, s29, s64
  s_add_u32 m0, s55, 20480
  s_nop 0
  buffer_load_dwordx4 v8, s[16:19], s29 offen sc1 lds
L2_pk_13:
  s_cmp_eq_u32 s77, 0
  s_cbranch_scc0 L2_pk_14
  s_add_u32 s29, s80, 1
  s_mul_i32 s29, s29, s71
  s_add_u32 s29, s29, s65
  s_add_u32 m0, s55, 21504
  s_nop 0
  buffer_load_dwordx4 v8, s[16:19], s29 offen sc1 lds
L2_pk_14:
  s_cmp_eq_u32 s78, 0
  s_cbranch_scc0 L2_pk_15
  s_add_u32 s29, s80, 1
  s_mul_i32 s29, s29, s72
  s_add_u32 s29, s29, s66
  s_add_u32 m0, s55, 22528
  s_nop 0
  buffer_load_dwordx4 v8, s[16:19], s29 offen sc1 lds
L2_pk_15:
  s_cmp_eq_u32 s79, 0
  s_cbranch_scc0 L2_pk_16
  s_add_u32 s29, s80, 1
  s_mul_i32 s29, s29, s73
  s_add_u32 s29, s29, s67
  s_add_u32 m0, s55, 23552
  s_nop 0
  buffer_load_dwordx4 v8, s[16:19], s29 offen sc1 lds
L2_pk_16:
  s_cmp_eq_u32 s74, 0
  s_cbranch_scc0 L2_pk_17
  s_add_u32 s29, s80, 2
  s_mul_i32 s29, s29, s68
  s_add_u32 s29, s29, s62
  s_add_u32 m0, s55, 36864
  s_nop 0
  buffer_load_dwordx4 v8, s[16:19], s29 offen sc1 lds
L2_pk_17:
  s_cmp_eq_u32 s75, 0
  s_cbranch_scc0 L2_pk_18
  s_add_u32 s29, s80, 2
  s_mul_i32 s29, s29, s69
  s_add_u32 s29, s29, s63
  s_add_u32 m0, s55, 37888
  s_nop 0
  buffer_load_dwordx4 v8, s[16:19], s29 offen sc1 lds
L2_pk_18:
  s_cmp_eq_u32 s76, 0
  s_cbranch_scc0 L2_pk_19
  s_add_u32 s29, s80, 2
  s_mul_i32 s29, s29, s70
  s_add_u32 s29, s29, s64
  s_add_u32 m0, s55, 38912
  s_nop 0
  buffer_load_dwordx4 v8, s[16:19], s29 offen sc1 lds
L2_pk_19:
  s_cmp_eq_u32 s77, 0
  s_cbranch_scc0 L2_pk_20
  s_add_u32 s29, s80, 2
  s_mul_i32 s29, s29, s71
  s_add_u32 s29, s29, s65
  s_add_u32 m0, s55, 39936
  s_nop 0
  buffer_load_dwordx4 v8, s[16:19], s29 offen sc1 lds
L2_pk_20:
  s_cmp_eq_u32 s78, 0
  s_cbranch_scc0 L2_pk_21
  s_add_u32 s29, s80, 2
  s_mul_i32 s29, s29, s72
  s_add_u32 s29, s29, s66
  s_add_u32 m0, s55, 40960
  s_nop 0
  buffer_load_dwordx4 v8, s[16:19], s29 offen sc1 lds
L2_pk_21:
  s_cmp_eq_u32 s79, 0
  s_cbranch_scc0 L2_pk_22
  s_add_u32 s29, s80, 2
  s_mul_i32 s29, s29, s73
  s_add_u32 s29, s29, s67
  s_add_u32 m0, s55, 41984
  s_nop 0
  buffer_load_dwordx4 v8, s[16:19], s29 offen sc1 lds
L2_pk_22:
  s_cmp_eq_u32 s74, 0
  s_cbranch_scc0 L2_pk_23
  s_add_u32 s29, s80, 3
  s_mul_i32 s29, s29, s68
  s_add_u32 s29, s29, s62
  s_add_u32 m0, s55, 55296
  s_nop 0
  buffer_load_dwordx4 v8, s[16:19], s29 offen sc1 lds
L2_pk_23:
  s_cmp_eq_u32 s75, 0
  s_cbranch_scc0 L2_pk_24
  s_add_u32 s29, s80, 3
  s_mul_i32 s29, s29, s69
  s_add_u32 s29, s29, s63
  s_add_u32 m0, s55, 56320
  s_nop 0
  buffer_load_dwordx4 v8, s[16:19], s29 offen sc1 lds
L2_pk_24:
  s_cmp_eq_u32 s76, 0
  s_cbranch_scc0 L2_pk_25
  s_add_u32 s29, s80, 3
  s_mul_i32 s29, s29, s70
  s_add_u32 s29, s29, s64
  s_add_u32 m0, s55, 57344
  s_nop 0
  buffer_load_dwordx4 v8, s[16:19], s29 offen sc1 lds
L2_pk_25:
  s_cmp_eq_u32 s77, 0
  s_cbranch_scc0 L2_pk_26
  s_add_u32 s29, s80, 3
  s_mul_i32 s29, s29, s71
  s_add_u32 s29, s29, s65
  s_add_u32 m0, s55, 58368
  s_nop 0
  buffer_load_dwordx4 v8, s[16:19], s29 offen sc1 lds
L2_pk_26:
  s_cmp_eq_u32 s78, 0
  s_cbranch_scc0 L2_pk_27
  s_add_u32 s29, s80, 3
  s_mul_i32 s29, s29, s72
  s_add_u32 s29, s29, s66
  s_add_u32 m0, s55, 59392
  s_nop 0
  buffer_load_dwordx4 v8, s[16:19], s29 offen sc1 lds
L2_pk_27:
  s_cmp_eq_u32 s79, 0
  s_cbranch_scc0 L2_pk_28
  s_add_u32 s29, s80, 3
  s_mul_i32 s29, s29, s73
  s_add_u32 s29, s29, s67
  s_add_u32 m0, s55, 60416
  s_nop 0
  buffer_load_dwordx4 v8, s[16:19], s29 offen sc1 lds
L2_pk_28:
  s_cmp_eq_u32 s3, 0
  s_cbranch_scc1 L2_j_2
  s_barrier
L2_j_2:
  s_mul_i32 s48, s86, 303104
  s_add_u32 s48, s48, 0
  s_lshl_b32 s28, s80, 13
  s_add_u32 s48, s48, s28
  s_mov_b32 s30, 0
L2_fl_29:
  ds_read_b32 v10, v9
  s_waitcnt lgkmcnt(0)
  v_readfirstlane_b32 s27, v10
  s_nop 2
  s_cmp_ge_u32 s27, 2
  s_cbranch_scc1 L2_flok_30
  s_add_u32 s30, s30, 1
  s_cmp_ge_u32 s30, 0x400000
  s_cbranch_scc1 L2_flok_30
  s_sleep 1
  s_branch L2_fl_29
L2_flok_30:
  s_cmp_eq_u32 s24, 4
  s_cbranch_scc0 L2_aw_32
  s_add_u32 s29, s48, 0
  s_mov_b32 m0, 0
  s_nop 0
  buffer_load_dwordx4 v8, s[16:19], s29 offen sc1 lds
  s_add_u32 s29, s48, 3072
  s_mov_b32 m0, 3072
  s_nop 0
  buffer_load_dwordx4 v8, s[16:19], s29 offen sc1 lds
  s_add_u32 s29, s48, 6144
  s_mov_b32 m0, 6144
  s_nop 0
  buffer_load_dwordx4 v8, s[16:19], s29 offen sc1 lds
  s_add_u32 s29, s48, 9216
  s_mov_b32 m0, 19456
  s_nop 0
  buffer_load_dwordx4 v8, s[16:19], s29 offen sc1 lds
  s_add_u32 s29, s48, 12288
  s_mov_b32 m0, 22528
  s_nop 0
  buffer_load_dwordx4 v8, s[16:19], s29 offen sc1 lds
  s_add_u32 s29, s48, 15360
  s_mov_b32 m0, 25600
  s_nop 0
  buffer_load_dwordx4 v8, s[16:19], s29 offen sc1 lds
  s_add_u32 s29, s48, 18432
  s_mov_b32 m0, 38912
  s_nop 0
  buffer_load_dwordx4 v8, s[16:19], s29 offen sc1 lds
  s_add_u32 s29, s48, 21504
  s_mov_b32 m0, 41984
  s_nop 0
  buffer_load_dwordx4 v8, s[16:19], s29 offen sc1 lds
  s_add_u32 s29, s48, 24576
  s_mov_b32 m0, 55296
  s_nop 0
  buffer_load_dwordx4 v8, s[16:19], s29 offen sc1 lds
  s_add_u32 s29, s48, 27648
  s_mov_b32 m0, 58368
  s_nop 0
  buffer_load_dwordx4 v8, s[16:19], s29 offen sc1 lds
  s_add_u32 s29, s48, 30720
  s_mov_b32 m0, 61440
  s_nop 0
  buffer_load_dwordx4 v8, s[16:19], s29 offen sc1 lds
  s_waitcnt vmcnt(5)
  s_branch L2_aend_31
L2_aw_32:
  s_cmp_eq_u32 s24, 5
  s_cbranch_scc0 L2_aw_33
  s_add_u32 s29, s48, 1024
  s_mov_b32 m0, 1024
  s_nop 0
  buffer_load_dwordx4 v8, s[16:19], s29 offen sc1 lds
  s_add_u32 s29, s48, 4096
  s_mov_b32 m0, 4096
  s_nop 0
  buffer_load_dwordx4 v8, s[16:19], s29 offen sc1 lds
  s_add_u32 s29, s48, 7168
  s_mov_b32 m0, 7168
  s_nop 0
  buffer_load_dwordx4 v8, s[16:19], s29 offen sc1 lds
  s_add_u32 s29, s48, 10240
  s_mov_b32 m0, 20480
  s_nop 0
  buffer_load_dwordx4 v8, s[16:19], s29 offen sc1 lds
  s_add_u32 s29, s48, 13312
  s_mov_b32 m0, 23552
  s_nop 0
  buffer_load_dwordx4 v8, s[16:19], s29 offen sc1 lds
  s_add_u32 s29, s48, 16384
  s_mov_b32 m0, 36864
  s_nop 0
  buffer_load_dwordx4 v8, s[16:19], s29 offen sc1 lds
  s_add_u32 s29, s48, 19456
  s_mov_b32 m0, 39936
  s_nop 0
  buffer_load_dwordx4 v8, s[16:19], s29 offen sc1 lds
  s_add_u32 s29, s48, 22528
  s_mov_b32 m0, 43008
  s_nop 0
  buffer_load_dwordx4 v8, s[16:19], s29 offen sc1 lds
  s_add_u32 s29, s48, 25600
  s_mov_b32 m0, 56320
  s_nop 0
  buffer_load_dwordx4 v8, s[16:19], s29 offen sc1 lds
  s_add_u32 s29, s48, 28672
  s_mov_b32 m0, 59392
  s_nop 0
  buffer_load_dwordx4 v8, s[16:19], s29 offen sc1 lds
  s_add_u32 s29, s48, 31744
  s_mov_b32 m0, 62464
  s_nop 0
  buffer_load_dwordx4 v8, s[16:19], s29 offen sc1 lds
  s_waitcnt vmcnt(6)
  s_branch L2_aend_31
L2_aw_33:
  s_add_u32 s29, s48, 2048
  s_mov_b32 m0, 2048
  s_nop 0
  buffer_load_dwordx4 v8, s[16:19], s29 offen sc1 lds
  s_add_u32 s29, s48, 5120
  s_mov_b32 m0, 5120
  s_nop 0
  buffer_load_dwordx4 v8, s[16:19], s29 offen sc1 lds
  s_add_u32 s29, s48, 8192
  s_mov_b32 m0, 18432
  s_nop 0
  buffer_load_dwordx4 v8, s[16:19], s29 offen sc1 lds
  s_add_u32 s29, s48, 11264
  s_mov_b32 m0, 21504
  s_nop 0
  buffer_load_dwordx4 v8, s[16:19], s29 offen sc1 lds
  s_add_u32 s29, s48, 14336
  s_mov_b32 m0, 24576
  s_nop 0
  buffer_load_dwordx4 v8, s[16:19], s29 offen sc1 lds
  s_add_u32 s29, s48, 17408
  s_mov_b32 m0, 37888
  s_nop 0
  buffer_load_dwordx4 v8, s[16:19], s29 offen sc1 lds
  s_add_u32 s29, s48, 20480
  s_mov_b32 m0, 40960
  s_nop 0
  buffer_load_dwordx4 v8, s[16:19], s29 offen sc1 lds
  s_add_u32 s29, s48, 23552
  s_mov_b32 m0, 44032
  s_nop 0
  buffer_load_dwordx4 v8, s[16:19], s29 offen sc1 lds
  s_add_u32 s29, s48, 26624
  s_mov_b32 m0, 57344
  s_nop 0
  buffer_load_dwordx4 v8, s[16:19], s29 offen sc1 lds
  s_add_u32 s29, s48, 29696
  s_mov_b32 m0, 60416
  s_nop 0
  buffer_load_dwordx4 v8, s[16:19], s29 offen sc1 lds
  s_waitcnt vmcnt(5)
L2_aend_31:
  s_barrier
  s_mov_b32 s41, 4
  s_add_u32 s39, s55, 73728
  s_mov_b32 s30, 0
  s_mov_b32 s48, 1073741824
L2_p_loop:
  s_cmp_lt_u32 s41, 32
  s_cselect_b32 s27, s83, s60
  s_cmp_lt_u32 s41, 27
  s_cselect_b32 s27, s82, s27
  s_cmp_lt_u32 s41, s81
  s_cselect_b32 s27, s80, s27
  s_add_u32 s27, s27, s41
  s_cmp_ge_u32 s41, 37
  s_cselect_b32 s28, s48, 0
  s_mul_i32 s29, s27, s68
  s_add_u32 s29, s29, s62
  s_add_u32 s29, s29, s28
  s_add_u32 m0, s39, 0
  s_nop 0
  buffer_load_dwordx4 v8, s[16:19], s29 offen sc1 lds
  s_mul_i32 s29, s27, s69
  s_add_u32 s29, s29, s63
  s_add_u32 s29, s29, s28
  s_add_u32 m0, s39, 1024
  s_nop 0
  buffer_load_dwordx4 v8, s[16:19], s29 offen sc1 lds
  s_mul_i32 s29, s27, s70
  s_add_u32 s29, s29, s64
  s_add_u32 s29, s29, s28
  s_add_u32 m0, s39, 2048
  s_nop 0
  buffer_load_dwordx4 v8, s[16:19], s29 offen sc1 lds
  s_mul_i32 s29, s27, s71
  s_add_u32 s29, s29, s65
  s_add_u32 s29, s29, s28
  s_add_u32 m0, s39, 3072
  s_nop 0
  buffer_load_dwordx4 v8, s[16:19], s29 offen sc1 lds
  s_mul_i32 s29, s27, s72
  s_add_u32 s29, s29, s66
  s_add_u32 s29, s29, s28
  s_add_u32 m0, s39, 4096
  s_nop 0
  buffer_load_dwordx4 v8, s[16:19], s29 offen sc1 lds
  s_mul_i32 s29, s27, s73
  s_add_u32 s29, s29, s67
  s_add_u32 s29, s29, s28
  s_add_u32 m0, s39, 5120
  s_nop 0
  buffer_load_dwordx4 v8, s[16:19], s29 offen sc1 lds
  s_add_u32 s41, s41, 1
  s_add_u32 s39, s39, 18432
  s_cmp_eq_u32 s39, s49
  s_cselect_b32 s39, s55, s39
  s_cmp_lt_u32 s30, 1
  s_cbranch_scc0 L2_p_w
  s_waitcnt vmcnt(6)
L2_p_w:
  s_waitcnt vmcnt(12)
  s_barrier
  s_add_u32 s30, s30, 1
  s_cmp_lt_u32 s30, 37
  s_cbranch_scc1 L2_p_loop
  s_endpgm
L_util:
  s_waitcnt lgkmcnt(0)
  s_mov_b32 s8, s4
  s_and_b32 s9, s5, 0xffff
  s_mov_b32 s10, 2621440
  s_mov_b32 s11, 0x20000
  s_mov_b32 s16, s70
  s_and_b32 s17, s71, 0xffff
  s_mov_b32 s18, 268435456
  s_mov_b32 s19, 0x20000
  s_mov_b32 s56, s68
  s_and_b32 s57, s69, 0xffff
  s_mov_b32 s58, 256
  s_mov_b32 s59, 0x20000
  s_mov_b32 s64, s22
  s_mov_b32 s65, s23
  s_lshl_b32 s27, s25, 7
  s_lshl_b32 s29, s50, 3
  s_add_u32 s27, s27, s29
  v_lshrrev_b32 v8, 3, v0
  v_add_u32 v8, s27, v8
  v_and_b32 v9, 7, v0
  v_mul_u32_u24 v10, 1280, v8
  v_lshl_add_u32 v10, v9, 4, v10
  buffer_load_dwordx4 v[32:35], v10, s[8:11], 0 offen offset:0
  buffer_load_dwordx4 v[36:39], v10, s[8:11], 0 offen offset:128
  buffer_load_dwordx4 v[40:43], v10, s[8:11], 0 offen offset:256
  buffer_load_dwordx4 v[44:47], v10, s[8:11], 0 offen offset:384
  buffer_load_dwordx4 v[48:51], v10, s[8:11], 0 offen offset:512
  buffer_load_dwordx4 v[52:55], v10, s[8:11], 0 offen offset:640
  buffer_load_dwordx4 v[56:59], v10, s[8:11], 0 offen offset:768
  buffer_load_dwordx4 v[60:63], v10, s[8:11], 0 offen offset:896
  buffer_load_dwordx4 v[64:67], v10, s[8:11], 0 offen offset:1024
  buffer_load_dwordx4 v[68:71], v10, s[8:11], 0 offen offset:1152
  v_lshlrev_b32 v11, 2, v8
  v_add_u32 v11, 25165824, v11
  s_and_b32 s27, s45, 7
  s_lshl_b32 s27, s27, 13
  v_lshlrev_b32 v15, 7, v0
  v_add_u32 v15, s27, v15
  s_mov_b32 s28, L_text_end-L_text_begin-4
  v_min_u32 v15, s28, v15
  v_and_b32 v15, 0xfffffffc, v15
  global_load_dword v29, v15, s[60:61]
  s_cmp_eq_u32 s3, 0
  s_cbranch_scc0 L_utilH
  v_mov_b32 v30, 150272
  v_mov_b32 v31, 0
  ds_write_b32 v30, v31
  s_lshl_b32 s27, s25, 4
  s_add_u32 s27, s27, s50
  s_lshl_b32 s27, s27, 7
  s_add_u32 s27, s27, 26214400
  v_mov_b32 v8, 0
  v_mov_b32 v9, 0
  s_mov_b64 exec, 1
  buffer_store_dword v8, v9, s[16:19], s27 offen sc0 sc1
  s_mov_b64 exec, -1
  s_waitcnt vmcnt(2)
  v_mov_b32 v28, 0x3f803f80
  v_mov_b32 v24, 0
  v_mov_b32 v25, 0
  v_mov_b32 v26, 0
  v_mov_b32 v27, 0
  v_dot2_f32_bf16 v24, v32, v28, v24
  v_dot2_f32_bf16 v26, v32, v32, v26
  v_dot2_f32_bf16 v25, v33, v28, v25
  v_dot2_f32_bf16 v27, v33, v33, v27
  v_dot2_f32_bf16 v24, v34, v28, v24
  v_dot2_f32_bf16 v26, v34, v34, v26
  v_dot2_f32_bf16 v25, v35, v28, v25
  v_dot2_f32_bf16 v27, v35, v35, v27
  v_dot2_f32_bf16 v24, v36, v28, v24
  v_dot2_f32_bf16 v26, v36, v36, v26
  v_dot2_f32_bf16 v25, v37, v28, v25
  v_dot2_f32_bf16 v27, v37, v37, v27
  v_dot2_f32_bf16 v24, v38, v28, v24
  v_dot2_f32_bf16 v26, v38, v38, v26
  v_dot2_f32_bf16 v25, v39, v28, v25
  v_dot2_f32_bf16 v27, v39, v39, v27
  v_dot2_f32_bf16 v24, v40, v28, v24
  v_dot2_f32_bf16 v26, v40, v40, v26
  v_dot2_f32_bf16 v25, v41, v28, v25
  v_dot2_f32_bf16 v27, v41, v41, v27
  v_dot2_f32_bf16 v24, v42, v28, v24
  v_dot2_f32_bf16 v26, v42, v42, v26
  v_dot2_f32_bf16 v25, v43, v28, v25
  v_dot2_f32_bf16 v27, v43, v43, v27
  v_dot2_f32_bf16 v24, v44, v28, v24
  v_dot2_f32_bf16 v26, v44, v44, v26
  v_dot2_f32_bf16 v25, v45, v28, v25
  v_dot2_f32_bf16 v27, v45, v45, v27
  v_dot2_f32_bf16 v24, v46, v28, v24
  v_dot2_f32_bf16 v26, v46, v46, v26
  v_dot2_f32_bf16 v25, v47, v28, v25
  v_dot2_f32_bf16 v27, v47, v47, v27
  v_dot2_f32_bf16 v24, v48, v28, v24
  v_dot2_f32_bf16 v26, v48, v48, v26
  v_dot2_f32_bf16 v25, v49, v28, v25
  v_dot2_f32_bf16 v27, v49, v49, v27
  v_dot2_f32_bf16 v24, v50, v28, v24
  v_dot2_f32_bf16 v26, v50, v50, v26
  v_dot2_f32_bf16 v25, v51, v28, v25
  v_dot2_f32_bf16 v27, v51, v51, v27
  v_dot2_f32_bf16 v24, v52, v28, v24
  v_dot2_f32_bf16 v26, v52, v52, v26
  v_dot2_f32_bf16 v25, v53, v28, v25
  v_dot2_f32_bf16 v27, v53, v53, v27
  v_dot2_f32_bf16 v24, v54, v28, v24
  v_dot2_f32_bf16 v26, v54, v54, v26
  v_dot2_f32_bf16 v25, v55, v28, v25
  v_dot2_f32_bf16 v27, v55, v55, v27
  v_dot2_f32_bf16 v24, v56, v28, v24
  v_dot2_f32_bf16 v26, v56, v56, v26
  v_dot2_f32_bf16 v25, v57, v28, v25
  v_dot2_f32_bf16 v27, v57, v57, v27
  v_dot2_f32_bf16 v24, v58, v28, v24
  v_dot2_f32_bf16 v26, v58, v58, v26
  v_dot2_f32_bf16 v25, v59, v28, v25
  v_dot2_f32_bf16 v27, v59, v59, v27
  v_dot2_f32_bf16 v24, v60, v28, v24
  v_dot2_f32_bf16 v26, v60, v60, v26
  v_dot2_f32_bf16 v25, v61, v28, v25
  v_dot2_f32_bf16 v27, v61, v61, v27
  v_dot2_f32_bf16 v24, v62, v28, v24
  v_dot2_f32_bf16 v26, v62, v62, v26
  v_dot2_f32_bf16 v25, v63, v28, v25
  v_dot2_f32_bf16 v27, v63, v63, v27
  v_dot2_f32_bf16 v24, v64, v28, v24
  v_dot2_f32_bf16 v26, v64, v64, v26
  v_dot2_f32_bf16 v25, v65, v28, v25
  v_dot2_f32_bf16 v27, v65, v65, v27
  v_dot2_f32_bf16 v24, v66, v28, v24
  v_dot2_f32_bf16 v26, v66, v66, v26
  v_dot2_f32_bf16 v25, v67, v28, v25
  v_dot2_f32_bf16 v27, v67, v67, v27
  v_dot2_f32_bf16 v24, v68, v28, v24
  v_dot2_f32_bf16 v26, v68, v68, v26
  v_dot2_f32_bf16 v25, v69, v28, v25
  v_dot2_f32_bf16 v27, v69, v69, v27
  v_dot2_f32_bf16 v24, v70, v28, v24
  v_dot2_f32_bf16 v26, v70, v70, v26
  v_dot2_f32_bf16 v25, v71, v28, v25
  v_dot2_f32_bf16 v27, v71, v71, v27
  s_nop 2
  v_add_f32 v24, v24, v25
  v_add_f32 v26, v26, v27
  s_nop 0
  v_add_f32_dpp v24, v24, v24 quad_perm:[1,0,3,2] row_mask:0xf bank_mask:0xf
  v_add_f32_dpp v26, v26, v26 quad_perm:[1,0,3,2] row_mask:0xf bank_mask:0xf
  s_nop 0
  v_add_f32_dpp v24, v24, v24 quad_perm:[2,3,0,1] row_mask:0xf bank_mask:0xf
  v_add_f32_dpp v26, v26, v26 quad_perm:[2,3,0,1] row_mask:0xf bank_mask:0xf
  s_nop 0
  v_add_f32_dpp v24, v24, v24 row_half_mirror row_mask:0xf bank_mask:0xf
  v_add_f32_dpp v26, v26, v26 row_half_mirror row_mask:0xf bank_mask:0xf
  v_mul_f32 v24, 0x3acccccd, v24
  v_mul_f32 v26, 0x3acccccd, v26
  v_fma_f32 v26, -v24, v24, v26
  v_max_f32 v26, 0, v26
  v_add_f32 v26, 0x3727c5ac, v26
  v_rsq_f32 v26, v26
  s_mov_b32 exec_lo, 0x01010101
  s_mov_b32 exec_hi, 0x01010101
  buffer_store_dword v24, v11, s[16:19], 0 offen sc0 sc1
  v_add_u32 v11, 8192, v11
  buffer_store_dword v26, v11, s[16:19], 0 offen sc0 sc1
  s_mov_b64 exec, -1
  s_waitcnt lgkmcnt(0)
  s_barrier
  s_barrier
  s_barrier
  s_waitcnt vmcnt(0)
  v_mov_b32 v8, 1
  s_lshl_b32 s27, s25, 4
  s_add_u32 s27, s27, 0
  v_mov_b32 v9, s27
  s_mov_b64 exec, 1
  buffer_atomic_add v8, v9, s[56:59], 0 offen sc1
  s_mov_b64 exec, -1
  s_barrier
  s_barrier
  s_barrier
  s_barrier
  s_barrier
  s_barrier
  s_barrier
  s_barrier
  s_barrier
  s_barrier
  s_barrier
  s_barrier
  s_barrier
  v_lshlrev_b32 v17, 4, v0
  v_mov_b32 v18, 16
  v_mov_b32 v22, 0
  v_cmp_lt_u32 vcc, 15, v0
  s_nop 1
  v_cndmask_b32 v18, v18, v22, vcc
  buffer_load_dword v19, v17, s[56:59], 0 offen sc1
  s_barrier
  s_barrier
  s_waitcnt vmcnt(0)
  s_mov_b32 s30, 0
L_poll_35:
  v_cmp_ge_u32 vcc, v19, v18
  s_nop 4
  s_cmp_eq_u64 vcc, -1
  s_cbranch_scc1 L_pollok_36
  s_add_u32 s30, s30, 1
  s_cmp_ge_u32 s30, 0x40000
  s_cbranch_scc1 L_pollok_36
  s_sleep 4
  buffer_load_dword v19, v17, s[56:59], 0 offen sc1
  s_waitcnt vmcnt(0)
  s_branch L_poll_35
L_pollok_36:
  s_lshl_b32 s27, s25, 7
  s_sub_u32 s27, s27, 16
  v_add_u32 v15, 0, v0
  v_add_u32 v15, s27, v15
  v_max_i32 v15, 0, v15
  v_min_i32 v15, 2047, v15
  v_lshlrev_b32 v15, 2, v15
  v_add_u32 v15, 25165824, v15
  buffer_load_dword v40, v15, s[16:19], 0 offen sc1
  v_add_u32 v15, 8192, v15
  buffer_load_dword v44, v15, s[16:19], 0 offen sc1
  v_add_u32 v15, 64, v0
  v_add_u32 v15, s27, v15
  v_max_i32 v15, 0, v15
  v_min_i32 v15, 2047, v15
  v_lshlrev_b32 v15, 2, v15
  v_add_u32 v15, 25165824, v15
  buffer_load_dword v41, v15, s[16:19], 0 offen sc1
  v_add_u32 v15, 8192, v15
  buffer_load_dword v45, v15, s[16:19], 0 offen sc1
  v_add_u32 v15, 128, v0
  v_add_u32 v15, s27, v15
  v_max_i32 v15, 0, v15
  v_min_i32 v15, 2047, v15
  v_lshlrev_b32 v15, 2, v15
  v_add_u32 v15, 25165824, v15
  buffer_load_dword v42, v15, s[16:19], 0 offen sc1
  v_add_u32 v15, 8192, v15
  buffer_load_dword v46, v15, s[16:19], 0 offen sc1
  v_lshlrev_b32 v48, 7, v0
  v_add_u32 v48, 26279936, v48
  v_add_u32 v49, 8192, v48
  buffer_load_dword v50, v48, s[16:19], 0 offen sc1
  buffer_load_dword v51, v49, s[16:19], 0 offen sc1
  s_barrier
  s_barrier
  s_barrier
  s_waitcnt vmcnt(2)
  v_lshlrev_b32 v15, 2, v0
  v_add_u32 v15, 147456, v15
  ds_write_b32 v15, v40 offset:0
  ds_write_b32 v15, v44 offset:576
  ds_write_b32 v15, v41 offset:256
  ds_write_b32 v15, v45 offset:832
  s_mov_b64 exec, 0xffff
  ds_write_b32 v15, v42 offset:512
  ds_write_b32 v15, v46 offset:1088
  s_mov_b64 exec, -1
  s_waitcnt lgkmcnt(0)
  s_barrier
  s_waitcnt vmcnt(0)
  s_mov_b32 s30, 0
L_fb_37:
  v_min_u32 v50, v50, v51
  v_cmp_le_u32 vcc, 1, v50
  s_nop 4
  s_cmp_eq_u64 vcc, -1
  s_cbranch_scc1 L_fbok_38
  s_add_u32 s30, s30, 1
  s_cmp_ge_u32 s30, 0x40000
  s_cbranch_scc1 L_fbok_38
  s_sleep 6
  buffer_load_dword v50, v48, s[16:19], 0 offen sc1
  buffer_load_dword v51, v49, s[16:19], 0 offen sc1
  s_waitcnt vmcnt(0)
  s_branch L_fb_37
L_fbok_38:
  v_mov_b32 v31, 1
  ds_write_b32 v30, v31
  s_waitcnt lgkmcnt(0)
  s_lshr_b32 s48, s86, 1
  s_lshl_b32 s48, s48, 4
  s_mov_b32 s41, s48
  s_barrier
  s_sleep 12
  s_lshr_b32 s27, s86, 1
  s_lshl_b32 s27, s27, 4
  s_add_u32 s27, s27, 8
  s_lshl_b32 s27, s27, 7
  s_add_u32 s27, s27, 26214400
  v_lshlrev_b32 v17, 7, v0
  v_add_u32 v17, s27, v17
  v_mov_b32 v18, 1
  v_mov_b32 v22, 0
  v_mov_b32 v23, 1073741824
  v_cmp_lt_u32 vcc, 7, v0
  s_nop 1
  v_cndmask_b32 v18, v18, v22, vcc
  v_cndmask_b32 v17, v17, v23, vcc
  s_mov_b32 s28, 3
  s_mov_b32 s29, 0
  v_mov_b32 v18, 1
  v_cndmask_b32 v18, v22, v18, s[28:29]
  buffer_load_dword v19, v17, s[16:19], 0 offen sc1
  s_waitcnt vmcnt(0)
  s_mov_b32 s30, 0
L_poll_39:
  v_cmp_ge_u32 vcc, v19, v18
  s_nop 4
  s_cmp_eq_u64 vcc, -1
  s_cbranch_scc1 L_pollok_40
  s_add_u32 s30, s30, 1
  s_cmp_ge_u32 s30, 0x40000
  s_cbranch_scc1 L_pollok_40
  s_sleep 6
  buffer_load_dword v19, v17, s[16:19], 0 offen sc1
  s_waitcnt vmcnt(0)
  s_branch L_poll_39
L_pollok_40:
  v_mov_b32 v31, 2
  ds_write_b32 v30, v31
  s_waitcnt lgkmcnt(0)
  s_barrier
  s_mov_b32 s31, 0
  buffer_load_dword v19, v17, s[16:19], 0 offen sc1
  s_barrier
  s_barrier
  s_cmp_eq_u32 s31, 1
  s_cbranch_scc1 L_gate_41
  s_waitcnt vmcnt(0)
  s_mov_b32 s28, 7
  s_mov_b32 s29, 0
  v_mov_b32 v18, 1
  v_cndmask_b32 v18, v22, v18, s[28:29]
  s_mov_b32 s30, 0
L_poll_42:
  v_cmp_ge_u32 vcc, v19, v18
  s_nop 4
  s_cmp_eq_u64 vcc, -1
  s_cbranch_scc1 L_pollok_43
  s_add_u32 s30, s30, 1
  s_cmp_ge_u32 s30, 0x40000
  s_cbranch_scc1 L_pollok_43
  s_sleep 4
  buffer_load_dword v19, v17, s[16:19], 0 offen sc1
  s_waitcnt vmcnt(0)
  s_branch L_poll_42
L_pollok_43:
  v_cmp_le_u32 vcc, 1, v19
  s_nop 4
  s_and_b32 s27, vcc_lo, 0xff
  s_cmp_eq_u32 s27, 0xff
  s_cselect_b32 s31, 1, 0
L_gate_41:
  s_barrier
  s_barrier
  v_lshlrev_b32 v48, 3, v0
  v_add_u32 v48, 26296320, v48
  v_add_u32 v49, 8192, v48
  buffer_load_dwordx2 v[50:51], v48, s[16:19], 0 offen sc1
  s_barrier
  s_lshl_b32 s27, s25, 4
  s_add_u32 s27, s27, s50
  s_lshl_b32 s27, s27, 7
  s_add_u32 s27, s27, 26214400
  v_mov_b32 v8, 1
  v_mov_b32 v9, 0
  s_mov_b64 exec, 1
  buffer_store_dword v8, v9, s[16:19], s27 offen sc0 sc1
  s_mov_b64 exec, -1
  s_cmp_eq_u32 s31, 1
  s_cbranch_scc1 L_gate_44
  buffer_load_dword v19, v17, s[16:19], 0 offen sc1
  s_waitcnt vmcnt(0)
  s_mov_b32 s28, 15
  s_mov_b32 s29, 0
  v_mov_b32 v18, 1
  v_cndmask_b32 v18, v22, v18, s[28:29]
  s_mov_b32 s30, 0
L_poll_45:
  v_cmp_ge_u32 vcc, v19, v18
  s_nop 4
  s_cmp_eq_u64 vcc, -1
  s_cbranch_scc1 L_pollok_46
  s_add_u32 s30, s30, 1
  s_cmp_ge_u32 s30, 0x40000
  s_cbranch_scc1 L_pollok_46
  s_sleep 4
  buffer_load_dword v19, v17, s[16:19], 0 offen sc1
  s_waitcnt vmcnt(0)
  s_branch L_poll_45
L_pollok_46:
  v_cmp_le_u32 vcc, 1, v19
  s_nop 4
  s_and_b32 s27, vcc_lo, 0xff
  s_cmp_eq_u32 s27, 0xff
  s_cselect_b32 s31, 1, 0
L_gate_44:
  s_barrier
  s_barrier
  s_waitcnt vmcnt(0)
  s_mov_b32 s30, 0
L_fb2_47:
  v_min_u32 v50, v50, v51
  v_cmp_le_u32 vcc, 1, v50
  s_nop 4
  s_cmp_eq_u64 vcc, -1
  s_cbranch_scc1 L_fb2ok_48
  s_add_u32 s30, s30, 1
  s_cmp_ge_u32 s30, 0x40000
  s_cbranch_scc1 L_fb2ok_48
  s_sleep 6
  buffer_load_dwordx2 v[50:51], v48, s[16:19], 0 offen sc1
  s_waitcnt vmcnt(0)
  s_branch L_fb2_47
L_fb2ok_48:
  s_barrier
  s_barrier
  s_cmp_eq_u32 s31, 1
  s_cbranch_scc1 L_gate_49
  buffer_load_dword v19, v17, s[16:19], 0 offen sc1
  s_waitcnt vmcnt(0)
  s_mov_b32 s28, 31
  s_mov_b32 s29, 0
  v_mov_b32 v18, 1
  v_cndmask_b32 v18, v22, v18, s[28:29]
  s_mov_b32 s30, 0
L_poll_50:
  v_cmp_ge_u32 vcc, v19, v18
  s_nop 4
  s_cmp_eq_u64 vcc, -1
  s_cbranch_scc1 L_pollok_51
  s_add_u32 s30, s30, 1
  s_cmp_ge_u32 s30, 0x40000
  s_cbranch_scc1 L_pollok_51
  s_sleep 4
  buffer_load_dword v19, v17, s[16:19], 0 offen sc1
  s_waitcnt vmcnt(0)
  s_branch L_poll_50
L_pollok_51:
  v_cmp_le_u32 vcc, 1, v19
  s_nop 4
  s_and_b32 s27, vcc_lo, 0xff
  s_cmp_eq_u32 s27, 0xff
  s_cselect_b32 s31, 1, 0
L_gate_49:
  s_barrier
  s_barrier
  s_barrier
  s_cmp_eq_u32 s31, 1
  s_cbranch_scc1 L_gate_52
  buffer_load_dword v19, v17, s[16:19], 0 offen sc1
  s_waitcnt vmcnt(0)
  s_mov_b32 s28, 63
  s_mov_b32 s29, 0
  v_mov_b32 v18, 1
  v_cndmask_b32 v18, v22, v18, s[28:29]
  s_mov_b32 s30, 0
L_poll_53:
  v_cmp_ge_u32 vcc, v19, v18
  s_nop 4
  s_cmp_eq_u64 vcc, -1
  s_cbranch_scc1 L_pollok_54
  s_add_u32 s30, s30, 1
  s_cmp_ge_u32 s30, 0x40000
  s_cbranch_scc1 L_pollok_54
  s_sleep 4
  buffer_load_dword v19, v17, s[16:19], 0 offen sc1
  s_waitcnt vmcnt(0)
  s_branch L_poll_53
L_pollok_54:
  v_cmp_le_u32 vcc, 1, v19
  s_nop 4
  s_and_b32 s27, vcc_lo, 0xff
  s_cmp_eq_u32 s27, 0xff
  s_cselect_b32 s31, 1, 0
L_gate_52:
  s_barrier
  s_barrier
  s_barrier
  s_barrier
  s_cmp_eq_u32 s31, 1
  s_cbranch_scc1 L_gate_55
  buffer_load_dword v19, v17, s[16:19], 0 offen sc1
  s_waitcnt vmcnt(0)
  s_mov_b32 s28, 127
  s_mov_b32 s29, 0
  v_mov_b32 v18, 1
  v_cndmask_b32 v18, v22, v18, s[28:29]
  s_mov_b32 s30, 0
L_poll_56:
  v_cmp_ge_u32 vcc, v19, v18
  s_nop 4
  s_cmp_eq_u64 vcc, -1
  s_cbranch_scc1 L_pollok_57
  s_add_u32 s30, s30, 1
  s_cmp_ge_u32 s30, 0x40000
  s_cbranch_scc1 L_pollok_57
  s_sleep 4
  buffer_load_dword v19, v17, s[16:19], 0 offen sc1
  s_waitcnt vmcnt(0)
  s_branch L_poll_56
L_pollok_57:
  v_cmp_le_u32 vcc, 1, v19
  s_nop 4
  s_and_b32 s27, vcc_lo, 0xff
  s_cmp_eq_u32 s27, 0xff
  s_cselect_b32 s31, 1, 0
L_gate_55:
  s_barrier
  s_barrier
  s_barrier
  s_cmp_eq_u32 s31, 1
  s_cbranch_scc1 L_gate_58
  buffer_load_dword v19, v17, s[16:19], 0 offen sc1
  s_waitcnt vmcnt(0)
  s_mov_b32 s28, 255
  s_mov_b32 s29, 0
  v_mov_b32 v18, 1
  v_cndmask_b32 v18, v22, v18, s[28:29]
  s_mov_b32 s30, 0
L_poll_59:
  v_cmp_ge_u32 vcc, v19, v18
  s_nop 4
  s_cmp_eq_u64 vcc, -1
  s_cbranch_scc1 L_pollok_60
  s_add_u32 s30, s30, 1
  s_cmp_ge_u32 s30, 0x40000
  s_cbranch_scc1 L_pollok_60
  s_sleep 4
  buffer_load_dword v19, v17, s[16:19], 0 offen sc1
  s_waitcnt vmcnt(0)
  s_branch L_poll_59
L_pollok_60:
  v_cmp_le_u32 vcc, 1, v19
  s_nop 4
  s_and_b32 s27, vcc_lo, 0xff
  s_cmp_eq_u32 s27, 0xff
  s_cselect_b32 s31, 1, 0
L_gate_58:
  s_lshr_b32 s27, s86, 1
  s_lshl_b32 s27, s27, 4
  s_add_u32 s27, s27, 0
  s_lshl_b32 s27, s27, 7
  s_add_u32 s27, s27, 26214400
  v_lshlrev_b32 v17, 7, v0
  v_add_u32 v17, s27, v17
  v_mov_b32 v18, 1
  v_mov_b32 v22, 0
  v_mov_b32 v23, 1073741824
  v_cmp_lt_u32 vcc, 7, v0
  s_nop 1
  v_cndmask_b32 v18, v18, v22, vcc
  v_cndmask_b32 v17, v17, v23, vcc
  s_barrier
  buffer_load_dword v19, v17, s[16:19], 0 offen sc1
  s_barrier
  s_barrier
  s_waitcnt vmcnt(0)
  s_mov_b32 s30, 0
L_poll_61:
  v_cmp_ge_u32 vcc, v19, v18
  s_nop 4
  s_cmp_eq_u64 vcc, -1
  s_cbranch_scc1 L_pollok_62
  s_add_u32 s30, s30, 1
  s_cmp_ge_u32 s30, 0x40000
  s_cbranch_scc1 L_pollok_62
  s_sleep 8
  buffer_load_dword v19, v17, s[16:19], 0 offen sc1
  s_waitcnt vmcnt(0)
  s_branch L_poll_61
L_pollok_62:
  s_barrier
  s_barrier
  s_barrier
  s_barrier
  s_barrier
  s_barrier
  s_barrier
  s_barrier
  s_barrier
  s_barrier
  s_barrier
  s_barrier
  s_barrier
  s_barrier
  s_barrier
  s_endpgm
L_utilH:
  v_mov_b32 v30, 159488
  v_mov_b32 v31, 0
  ds_write_b32 v30, v31
  s_lshl_b32 s27, s25, 4
  s_add_u32 s27, s27, s50
  s_lshl_b32 s27, s27, 7
  s_add_u32 s27, s27, 26214400
  v_mov_b32 v8, 0
  v_mov_b32 v9, 0
  s_mov_b64 exec, 1
  buffer_store_dword v8, v9, s[16:19], s27 offen sc0 sc1
  s_mov_b64 exec, -1
  s_lshl_b32 s27, s25, 3
  s_add_u32 s27, s27, s26
  s_lshl_b32 s27, s27, 7
  s_add_u32 s27, s27, 26279936
  v_mov_b32 v8, 0
  v_mov_b32 v9, 0
  s_mov_b64 exec, 1
  buffer_store_dword v8, v9, s[16:19], s27 offen sc0 sc1
  s_mov_b64 exec, -1
  s_lshl_b32 s27, s25, 3
  s_add_u32 s27, s27, s26
  s_lshl_b32 s27, s27, 2
  s_add_u32 s27, s27, 26296320
  v_mov_b32 v8, 0
  v_mov_b32 v9, 0
  s_mov_b64 exec, 1
  buffer_store_dword v8, v9, s[16:19], s27 offen sc0 sc1
  s_mov_b64 exec, -1
  s_waitcnt vmcnt(4)
  v_mov_b32 v28, 0x3f803f80
  v_mov_b32 v24, 0
  v_mov_b32 v25, 0
  v_mov_b32 v26, 0
  v_mov_b32 v27, 0
  v_dot2_f32_bf16 v24, v32, v28, v24
  v_dot2_f32_bf16 v26, v32, v32, v26
  v_dot2_f32_bf16 v25, v33, v28, v25
  v_dot2_f32_bf16 v27, v33, v33, v27
  v_dot2_f32_bf16 v24, v34, v28, v24
  v_dot2_f32_bf16 v26, v34, v34, v26
  v_dot2_f32_bf16 v25, v35, v28, v25
  v_dot2_f32_bf16 v27, v35, v35, v27
  v_dot2_f32_bf16 v24, v36, v28, v24
  v_dot2_f32_bf16 v26, v36, v36, v26
  v_dot2_f32_bf16 v25, v37, v28, v25
  v_dot2_f32_bf16 v27, v37, v37, v27
  v_dot2_f32_bf16 v24, v38, v28, v24
  v_dot2_f32_bf16 v26, v38, v38, v26
  v_dot2_f32_bf16 v25, v39, v28, v25
  v_dot2_f32_bf16 v27, v39, v39, v27
  v_dot2_f32_bf16 v24, v40, v28, v24
  v_dot2_f32_bf16 v26, v40, v40, v26
  v_dot2_f32_bf16 v25, v41, v28, v25
  v_dot2_f32_bf16 v27, v41, v41, v27
  v_dot2_f32_bf16 v24, v42, v28, v24
  v_dot2_f32_bf16 v26, v42, v42, v26
  v_dot2_f32_bf16 v25, v43, v28, v25
  v_dot2_f32_bf16 v27, v43, v43, v27
  v_dot2_f32_bf16 v24, v44, v28, v24
  v_dot2_f32_bf16 v26, v44, v44, v26
  v_dot2_f32_bf16 v25, v45, v28, v25
  v_dot2_f32_bf16 v27, v45, v45, v27
  v_dot2_f32_bf16 v24, v46, v28, v24
  v_dot2_f32_bf16 v26, v46, v46, v26
  v_dot2_f32_bf16 v25, v47, v28, v25
  v_dot2_f32_bf16 v27, v47, v47, v27
  v_dot2_f32_bf16 v24, v48, v28, v24
  v_dot2_f32_bf16 v26, v48, v48, v26
  v_dot2_f32_bf16 v25, v49, v28, v25
  v_dot2_f32_bf16 v27, v49, v49, v27
  v_dot2_f32_bf16 v24, v50, v28, v24
  v_dot2_f32_bf16 v26, v50, v50, v26
  v_dot2_f32_bf16 v25, v51, v28, v25
  v_dot2_f32_bf16 v27, v51, v51, v27
  v_dot2_f32_bf16 v24, v52, v28, v24
  v_dot2_f32_bf16 v26, v52, v52, v26
  v_dot2_f32_bf16 v25, v53, v28, v25
  v_dot2_f32_bf16 v27, v53, v53, v27
  v_dot2_f32_bf16 v24, v54, v28, v24
  v_dot2_f32_bf16 v26, v54, v54, v26
  v_dot2_f32_bf16 v25, v55, v28, v25
  v_dot2_f32_bf16 v27, v55, v55, v27
  v_dot2_f32_bf16 v24, v56, v28, v24
  v_dot2_f32_bf16 v26, v56, v56, v26
  v_dot2_f32_bf16 v25, v57, v28, v25
  v_dot2_f32_bf16 v27, v57, v57, v27
  v_dot2_f32_bf16 v24, v58, v28, v24
  v_dot2_f32_bf16 v26, v58, v58, v26
  v_dot2_f32_bf16 v25, v59, v28, v25
  v_dot2_f32_bf16 v27, v59, v59, v27
  v_dot2_f32_bf16 v24, v60, v28, v24
  v_dot2_f32_bf16 v26, v60, v60, v26
  v_dot2_f32_bf16 v25, v61, v28, v25
  v_dot2_f32_bf16 v27, v61, v61, v27
  v_dot2_f32_bf16 v24, v62, v28, v24
  v_dot2_f32_bf16 v26, v62, v62, v26
  v_dot2_f32_bf16 v25, v63, v28, v25
  v_dot2_f32_bf16 v27, v63, v63, v27
  v_dot2_f32_bf16 v24, v64, v28, v24
  v_dot2_f32_bf16 v26, v64, v64, v26
  v_dot2_f32_bf16 v25, v65, v28, v25
  v_dot2_f32_bf16 v27, v65, v65, v27
  v_dot2_f32_bf16 v24, v66, v28, v24
  v_dot2_f32_bf16 v26, v66, v66, v26
  v_dot2_f32_bf16 v25, v67, v28, v25
  v_dot2_f32_bf16 v27, v67, v67, v27
  v_dot2_f32_bf16 v24, v68, v28, v24
  v_dot2_f32_bf16 v26, v68, v68, v26
  v_dot2_f32_bf16 v25, v69, v28, v25
  v_dot2_f32_bf16 v27, v69, v69, v27
  v_dot2_f32_bf16 v24, v70, v28, v24
  v_dot2_f32_bf16 v26, v70, v70, v26
  v_dot2_f32_bf16 v25, v71, v28, v25
  v_dot2_f32_bf16 v27, v71, v71, v27
  s_nop 2
  v_add_f32 v24, v24, v25
  v_add_f32 v26, v26, v27
  s_nop 0
  v_add_f32_dpp v24, v24, v24 quad_perm:[1,0,3,2] row_mask:0xf bank_mask:0xf
  v_add_f32_dpp v26, v26, v26 quad_perm:[1,0,3,2] row_mask:0xf bank_mask:0xf
  s_nop 0
  v_add_f32_dpp v24, v24, v24 quad_perm:[2,3,0,1] row_mask:0xf bank_mask:0xf
  v_add_f32_dpp v26, v26, v26 quad_perm:[2,3,0,1] row_mask:0xf bank_mask:0xf
  s_nop 0
  v_add_f32_dpp v24, v24, v24 row_half_mirror row_mask:0xf bank_mask:0xf
  v_add_f32_dpp v26, v26, v26 row_half_mirror row_mask:0xf bank_mask:0xf
  v_mul_f32 v24, 0x3acccccd, v24
  v_mul_f32 v26, 0x3acccccd, v26
  v_fma_f32 v26, -v24, v24, v26
  v_max_f32 v26, 0, v26
  v_add_f32 v26, 0x3727c5ac, v26
  v_rsq_f32 v26, v26
  s_mov_b32 exec_lo, 0x01010101
  s_mov_b32 exec_hi, 0x01010101
  buffer_store_dword v24, v11, s[16:19], 0 offen sc0 sc1
  v_add_u32 v11, 8192, v11
  buffer_store_dword v26, v11, s[16:19], 0 offen sc0 sc1
  s_mov_b64 exec, -1
  s_waitcnt lgkmcnt(0)
  s_barrier
  s_barrier
  s_barrier
  s_waitcnt vmcnt(0)
  v_mov_b32 v8, 1
  s_lshl_b32 s27, s25, 4
  s_add_u32 s27, s27, 0
  v_mov_b32 v9, s27
  s_mov_b64 exec, 1
  buffer_atomic_add v8, v9, s[56:59], 0 offen sc1
  s_mov_b64 exec, -1
  s_barrier
  s_barrier
  v_lshrrev_b32 v72, 3, v0
  v_lshrrev_b32 v73, 4, v0
  v_lshlrev_b32 v73, 1, v73
  v_and_b32 v74, 7, v0
  v_xor_b32 v74, v74, v73
  v_mul_u32_u24 v72, 1280, v72
  v_lshl_add_u32 v76, v74, 4, v72
  v_add_u32 v77, 10240, v76
  v_add_u32 v78, 20480, v76
  v_add_u32 v79, 30720, v76
  s_lshl_b32 s48, s25, 3
  s_add_u32 s48, s48, s26
  s_barrier
  v_lshrrev_b32 v72, 2, v0
  v_bfe_u32 v73, v0, 3, 2
  v_lshlrev_b32 v73, 1, v73
  v_bfe_u32 v74, v0, 1, 1
  v_and_b32 v75, 1, v0
  v_lshlrev_b32 v72, 7, v72
  v_lshl_add_u32 v72, v75, 3, v72
  v_lshl_add_u32 v72, v74, 4, v72
  v_xor_b32 v74, 0, v73
  v_lshl_add_u32 v80, v74, 4, v72
  v_xor_b32 v74, 2, v73
  v_lshl_add_u32 v81, v74, 4, v72
  v_xor_b32 v74, 4, v73
  v_lshl_add_u32 v82, v74, 4, v72
  v_xor_b32 v74, 6, v73
  v_lshl_add_u32 v83, v74, 4, v72
  v_lshlrev_b32 v84, 4, v0
  s_barrier
  s_add_u32 s49, s48, 0
  s_mul_i32 s28, s49, 6554
  s_lshr_b32 s28, s28, 16
  s_mul_i32 s27, s28, 10
  s_sub_u32 s29, s49, s27
  s_mov_b32 s27, -54
  s_cmp_lt_u32 s28, 54
  s_cselect_b32 s27, 20, s27
  s_add_u32 s28, s28, s27
  s_lshl_b32 s27, s29, 2
  s_mul_i32 s66, s27, 13108
  s_lshr_b32 s66, s66, 16
  s_mul_i32 s55, s66, 5
  s_sub_u32 s4, s27, s55
  s_mul_i32 s66, s66, 74
  s_add_u32 s66, s66, s28
  s_mul_i32 s66, s66, 5120
  s_lshl_b32 s27, s4, 10
  s_add_u32 s66, s66, s27
  s_add_u32 s66, s66, 16777216
  s_cmp_ge_u32 s49, 740
  s_cselect_b32 s66, 1073741824, s66
  s_cselect_b32 s55, 1073741824, 0
  s_mul_i32 s27, s28, 13108
  s_lshr_b32 s27, s27, 16
  s_mul_i32 s27, s27, 5
  s_sub_u32 s27, s28, s27
  s_cmp_eq_u32 s27, 2
  s_cselect_b32 s27, 1, 0
  s_cmp_lt_u32 s28, 20
  s_cselect_b32 s33, s27, 0
  s_cselect_b32 s76, s62, s64
  s_cselect_b32 s77, s63, s65
  s_mov_b32 s27, 2211840
  s_cselect_b32 s78, 819200, s27
  s_cselect_b32 s27, 0, 20
  s_and_b32 s77, s77, 0xffff
  s_mov_b32 s79, 0x20000
  s_sub_u32 s27, s28, s27
  s_mul_i32 s27, s27, 40960
  s_lshl_b32 s29, s29, 7
  s_add_u32 s27, s27, s29
  s_add_u32 s27, s27, s55
  s_mov_b32 m0, 132096
  s_nop 0
  buffer_load_dwordx4 v76, s[76:79], s27 offen lds
  s_mov_b32 m0, 133120
  s_nop 0
  buffer_load_dwordx4 v77, s[76:79], s27 offen lds
  s_mov_b32 m0, 134144
  s_nop 0
  buffer_load_dwordx4 v78, s[76:79], s27 offen lds
  s_mov_b32 m0, 135168
  s_nop 0
  buffer_load_dwordx4 v79, s[76:79], s27 offen lds
  s_add_u32 s49, s48, 128
  s_mul_i32 s28, s49, 6554
  s_lshr_b32 s28, s28, 16
  s_mul_i32 s27, s28, 10
  s_sub_u32 s29, s49, s27
  s_mov_b32 s27, -54
  s_cmp_lt_u32 s28, 54
  s_cselect_b32 s27, 20, s27
  s_add_u32 s28, s28, s27
  s_lshl_b32 s27, s29, 2
  s_mul_i32 s67, s27, 13108
  s_lshr_b32 s67, s67, 16
  s_mul_i32 s55, s67, 5
  s_sub_u32 s5, s27, s55
  s_mul_i32 s67, s67, 74
  s_add_u32 s67, s67, s28
  s_mul_i32 s67, s67, 5120
  s_lshl_b32 s27, s5, 10
  s_add_u32 s67, s67, s27
  s_add_u32 s67, s67, 16777216
  s_cmp_ge_u32 s49, 740
  s_cselect_b32 s67, 1073741824, s67
  s_cselect_b32 s55, 1073741824, 0
  s_mul_i32 s27, s28, 13108
  s_lshr_b32 s27, s27, 16
  s_mul_i32 s27, s27, 5
  s_sub_u32 s27, s28, s27
  s_cmp_eq_u32 s27, 2
  s_cselect_b32 s27, 1, 0
  s_cmp_lt_u32 s28, 20
  s_cselect_b32 s42, s27, 0
  s_cselect_b32 s76, s62, s64
  s_cselect_b32 s77, s63, s65
  s_mov_b32 s27, 2211840
  s_cselect_b32 s78, 819200, s27
  s_cselect_b32 s27, 0, 20
  s_and_b32 s77, s77, 0xffff
  s_mov_b32 s79, 0x20000
  s_sub_u32 s27, s28, s27
  s_mul_i32 s27, s27, 40960
  s_lshl_b32 s29, s29, 7
  s_add_u32 s27, s27, s29
  s_add_u32 s27, s27, s55
  s_mov_b32 m0, 136192
  s_nop 0
  buffer_load_dwordx4 v76, s[76:79], s27 offen lds
  s_mov_b32 m0, 137216
  s_nop 0
  buffer_load_dwordx4 v77, s[76:79], s27 offen lds
  s_mov_b32 m0, 138240
  s_nop 0
  buffer_load_dwordx4 v78, s[76:79], s27 offen lds
  s_mov_b32 m0, 139264
  s_nop 0
  buffer_load_dwordx4 v79, s[76:79], s27 offen lds
  s_barrier
  s_barrier
  s_barrier
  s_barrier
  s_waitcnt vmcnt(4)
  s_cmp_eq_u32 s33, 1
  s_cbranch_scc1 L_rlsp_63
  v_add_u32 v120, 132096, v80
  v_add_u32 v121, 132096, v81
  v_add_u32 v122, 132096, v82
  v_add_u32 v123, 132096, v83
  ds_read_b64_tr_b16 v[88:89], v120
  ds_read_b64_tr_b16 v[90:91], v120 offset:2048
  ds_read_b64_tr_b16 v[92:93], v121
  ds_read_b64_tr_b16 v[94:95], v121 offset:2048
  ds_read_b64_tr_b16 v[96:97], v122
  ds_read_b64_tr_b16 v[98:99], v122 offset:2048
  ds_read_b64_tr_b16 v[100:101], v123
  ds_read_b64_tr_b16 v[102:103], v123 offset:2048
  s_branch L_rldn_64
L_rlsp_63:
  v_lshrrev_b32 v124, 4, v0
  v_and_b32 v125, 1, v124
  v_lshrrev_b32 v124, 1, v124
  v_lshl_add_u32 v124, v125, 1, v124
  v_bfe_u32 v125, v0, 2, 2
  v_lshl_add_u32 v124, v124, 3, v125
  v_lshlrev_b32 v124, 7, v124
  v_and_b32 v126, 1, v0
  v_lshl_add_u32 v124, v126, 3, v124
  v_add_u32 v124, 132096, v124
  v_lshrrev_b32 v125, 1, v125
  v_lshlrev_b32 v125, 1, v125
  v_bfe_u32 v126, v0, 1, 1
  v_add_u32 v127, 0, v126
  v_xor_b32 v128, v127, v125
  v_lshl_add_u32 v128, v128, 4, v124
  ds_read_b64_tr_b16 v[88:89], v128
  v_xor_b32 v129, 4, v125
  v_xor_b32 v129, v127, v129
  v_lshl_add_u32 v129, v129, 4, v124
  ds_read_b64_tr_b16 v[90:91], v129 offset:512
  v_add_u32 v127, 2, v126
  v_xor_b32 v128, v127, v125
  v_lshl_add_u32 v128, v128, 4, v124
  ds_read_b64_tr_b16 v[92:93], v128
  v_xor_b32 v129, 4, v125
  v_xor_b32 v129, v127, v129
  v_lshl_add_u32 v129, v129, 4, v124
  ds_read_b64_tr_b16 v[94:95], v129 offset:512
  v_add_u32 v127, 4, v126
  v_xor_b32 v128, v127, v125
  v_lshl_add_u32 v128, v128, 4, v124
  ds_read_b64_tr_b16 v[96:97], v128
  v_xor_b32 v129, 4, v125
  v_xor_b32 v129, v127, v129
  v_lshl_add_u32 v129, v129, 4, v124
  ds_read_b64_tr_b16 v[98:99], v129 offset:512
  v_add_u32 v127, 6, v126
  v_xor_b32 v128, v127, v125
  v_lshl_add_u32 v128, v128, 4, v124
  ds_read_b64_tr_b16 v[100:101], v128
  v_xor_b32 v129, 4, v125
  v_xor_b32 v129, v127, v129
  v_lshl_add_u32 v129, v129, 4, v124
  ds_read_b64_tr_b16 v[102:103], v129 offset:512
L_rldn_64:
  s_barrier
  s_movk_i32 s29, 0x400
  s_waitcnt lgkmcnt(0)
  buffer_store_dwordx4 v[88:91], v84, s[16:19], s66 offen sc0 sc1
  s_cmp_eq_u32 s4, 4
  s_cselect_b32 s27, 374784, s29
  s_cselect_b32 s4, -1, s4
  s_add_u32 s66, s66, s27
  s_add_u32 s4, s4, 1
  buffer_store_dwordx4 v[92:95], v84, s[16:19], s66 offen sc0 sc1
  s_cmp_eq_u32 s4, 4
  s_cselect_b32 s27, 374784, s29
  s_cselect_b32 s4, -1, s4
  s_add_u32 s66, s66, s27
  s_add_u32 s4, s4, 1
  buffer_store_dwordx4 v[96:99], v84, s[16:19], s66 offen sc0 sc1
  s_cmp_eq_u32 s4, 4
  s_cselect_b32 s27, 374784, s29
  s_cselect_b32 s4, -1, s4
  s_add_u32 s66, s66, s27
  s_add_u32 s4, s4, 1
  buffer_store_dwordx4 v[100:103], v84, s[16:19], s66 offen sc0 sc1
  s_waitcnt vmcnt(4)
  s_cmp_eq_u32 s42, 1
  s_cbranch_scc1 L_rlsp_65
  v_add_u32 v120, 136192, v80
  v_add_u32 v121, 136192, v81
  v_add_u32 v122, 136192, v82
  v_add_u32 v123, 136192, v83
  ds_read_b64_tr_b16 v[104:105], v120
  ds_read_b64_tr_b16 v[106:107], v120 offset:2048
  ds_read_b64_tr_b16 v[108:109], v121
  ds_read_b64_tr_b16 v[110:111], v121 offset:2048
  ds_read_b64_tr_b16 v[112:113], v122
  ds_read_b64_tr_b16 v[114:115], v122 offset:2048
  ds_read_b64_tr_b16 v[116:117], v123
  ds_read_b64_tr_b16 v[118:119], v123 offset:2048
  s_branch L_rldn_66
L_rlsp_65:
  v_lshrrev_b32 v124, 4, v0
  v_and_b32 v125, 1, v124
  v_lshrrev_b32 v124, 1, v124
  v_lshl_add_u32 v124, v125, 1, v124
  v_bfe_u32 v125, v0, 2, 2
  v_lshl_add_u32 v124, v124, 3, v125
  v_lshlrev_b32 v124, 7, v124
  v_and_b32 v126, 1, v0
  v_lshl_add_u32 v124, v126, 3, v124
  v_add_u32 v124, 136192, v124
  v_lshrrev_b32 v125, 1, v125
  v_lshlrev_b32 v125, 1, v125
  v_bfe_u32 v126, v0, 1, 1
  v_add_u32 v127, 0, v126
  v_xor_b32 v128, v127, v125
  v_lshl_add_u32 v128, v128, 4, v124
  ds_read_b64_tr_b16 v[104:105], v128
  v_xor_b32 v129, 4, v125
  v_xor_b32 v129, v127, v129
  v_lshl_add_u32 v129, v129, 4, v124
  ds_read_b64_tr_b16 v[106:107], v129 offset:512
  v_add_u32 v127, 2, v126
  v_xor_b32 v128, v127, v125
  v_lshl_add_u32 v128, v128, 4, v124
  ds_read_b64_tr_b16 v[108:109], v128
  v_xor_b32 v129, 4, v125
  v_xor_b32 v129, v127, v129
  v_lshl_add_u32 v129, v129, 4, v124
  ds_read_b64_tr_b16 v[110:111], v129 offset:512
  v_add_u32 v127, 4, v126
  v_xor_b32 v128, v127, v125
  v_lshl_add_u32 v128, v128, 4, v124
  ds_read_b64_tr_b16 v[112:113], v128
  v_xor_b32 v129, 4, v125
  v_xor_b32 v129, v127, v129
  v_lshl_add_u32 v129, v129, 4, v124
  ds_read_b64_tr_b16 v[114:115], v129 offset:512
  v_add_u32 v127, 6, v126
  v_xor_b32 v128, v127, v125
  v_lshl_add_u32 v128, v128, 4, v124
  ds_read_b64_tr_b16 v[116:117], v128
  v_xor_b32 v129, 4, v125
  v_xor_b32 v129, v127, v129
  v_lshl_add_u32 v129, v129, 4, v124
  ds_read_b64_tr_b16 v[118:119], v129 offset:512
L_rldn_66:
  s_barrier
  s_movk_i32 s29, 0x400
  s_waitcnt lgkmcnt(0)
  buffer_store_dwordx4 v[104:107], v84, s[16:19], s67 offen sc0 sc1
  s_cmp_eq_u32 s5, 4
  s_cselect_b32 s27, 374784, s29
  s_cselect_b32 s5, -1, s5
  s_add_u32 s67, s67, s27
  s_add_u32 s5, s5, 1
  buffer_store_dwordx4 v[108:111], v84, s[16:19], s67 offen sc0 sc1
  s_cmp_eq_u32 s5, 4
  s_cselect_b32 s27, 374784, s29
  s_cselect_b32 s5, -1, s5
  s_add_u32 s67, s67, s27
  s_add_u32 s5, s5, 1
  buffer_store_dwordx4 v[112:115], v84, s[16:19], s67 offen sc0 sc1
  s_cmp_eq_u32 s5, 4
  s_cselect_b32 s27, 374784, s29
  s_cselect_b32 s5, -1, s5
  s_add_u32 s67, s67, s27
  s_add_u32 s5, s5, 1
  buffer_store_dwordx4 v[116:119], v84, s[16:19], s67 offen sc0 sc1
  s_barrier
  s_barrier
  s_barrier
  s_waitcnt vmcnt(0)
  s_lshl_b32 s27, s25, 3
  s_add_u32 s27, s27, s26
  s_lshl_b32 s27, s27, 7
  s_add_u32 s27, s27, 26279936
  v_mov_b32 v8, 1
  v_mov_b32 v9, 0
  s_mov_b64 exec, 1
  buffer_store_dword v8, v9, s[16:19], s27 offen sc0 sc1
  s_mov_b64 exec, -1
  v_lshlrev_b32 v17, 4, v0
  v_mov_b32 v18, 16
  v_mov_b32 v22, 0
  v_cmp_lt_u32 vcc, 15, v0
  s_nop 1
  v_cndmask_b32 v18, v18, v22, vcc
  buffer_load_dword v19, v17, s[56:59], 0 offen sc1
  s_barrier
  s_add_u32 s49, s48, 256
  s_mul_i32 s28, s49, 6554
  s_lshr_b32 s28, s28, 16
  s_mul_i32 s27, s28, 10
  s_sub_u32 s29, s49, s27
  s_mov_b32 s27, -54
  s_cmp_lt_u32 s28, 54
  s_cselect_b32 s27, 20, s27
  s_add_u32 s28, s28, s27
  s_lshl_b32 s27, s29, 2
  s_mul_i32 s68, s27, 13108
  s_lshr_b32 s68, s68, 16
  s_mul_i32 s55, s68, 5
  s_sub_u32 s6, s27, s55
  s_mul_i32 s68, s68, 74
  s_add_u32 s68, s68, s28
  s_mul_i32 s68, s68, 5120
  s_lshl_b32 s27, s6, 10
  s_add_u32 s68, s68, s27
  s_add_u32 s68, s68, 16777216
  s_cmp_ge_u32 s49, 740
  s_cselect_b32 s68, 1073741824, s68
  s_cselect_b32 s55, 1073741824, 0
  s_mul_i32 s27, s28, 13108
  s_lshr_b32 s27, s27, 16
  s_mul_i32 s27, s27, 5
  s_sub_u32 s27, s28, s27
  s_cmp_eq_u32 s27, 2
  s_cselect_b32 s27, 1, 0
  s_cmp_lt_u32 s28, 20
  s_cselect_b32 s43, s27, 0
  s_cselect_b32 s76, s62, s64
  s_cselect_b32 s77, s63, s65
  s_mov_b32 s27, 2211840
  s_cselect_b32 s78, 819200, s27
  s_cselect_b32 s27, 0, 20
  s_and_b32 s77, s77, 0xffff
  s_mov_b32 s79, 0x20000
  s_sub_u32 s27, s28, s27
  s_mul_i32 s27, s27, 40960
  s_lshl_b32 s29, s29, 7
  s_add_u32 s27, s27, s29
  s_add_u32 s27, s27, s55
  s_mov_b32 m0, 140288
  s_nop 0
  buffer_load_dwordx4 v76, s[76:79], s27 offen lds
  s_mov_b32 m0, 141312
  s_nop 0
  buffer_load_dwordx4 v77, s[76:79], s27 offen lds
  s_mov_b32 m0, 142336
  s_nop 0
  buffer_load_dwordx4 v78, s[76:79], s27 offen lds
  s_mov_b32 m0, 143360
  s_nop 0
  buffer_load_dwordx4 v79, s[76:79], s27 offen lds
  s_add_u32 s49, s48, 384
  s_mul_i32 s28, s49, 6554
  s_lshr_b32 s28, s28, 16
  s_mul_i32 s27, s28, 10
  s_sub_u32 s29, s49, s27
  s_mov_b32 s27, -54
  s_cmp_lt_u32 s28, 54
  s_cselect_b32 s27, 20, s27
  s_add_u32 s28, s28, s27
  s_lshl_b32 s27, s29, 2
  s_mul_i32 s69, s27, 13108
  s_lshr_b32 s69, s69, 16
  s_mul_i32 s55, s69, 5
  s_sub_u32 s7, s27, s55
  s_mul_i32 s69, s69, 74
  s_add_u32 s69, s69, s28
  s_mul_i32 s69, s69, 5120
  s_lshl_b32 s27, s7, 10
  s_add_u32 s69, s69, s27
  s_add_u32 s69, s69, 16777216
  s_cmp_ge_u32 s49, 740
  s_cselect_b32 s69, 1073741824, s69
  s_cselect_b32 s55, 1073741824, 0
  s_mul_i32 s27, s28, 13108
  s_lshr_b32 s27, s27, 16
  s_mul_i32 s27, s27, 5
  s_sub_u32 s27, s28, s27
  s_cmp_eq_u32 s27, 2
  s_cselect_b32 s27, 1, 0
  s_cmp_lt_u32 s28, 20
  s_cselect_b32 s46, s27, 0
  s_cselect_b32 s76, s62, s64
  s_cselect_b32 s77, s63, s65
  s_mov_b32 s27, 2211840
  s_cselect_b32 s78, 819200, s27
  s_cselect_b32 s27, 0, 20
  s_and_b32 s77, s77, 0xffff
  s_mov_b32 s79, 0x20000
  s_sub_u32 s27, s28, s27
  s_mul_i32 s27, s27, 40960
  s_lshl_b32 s29, s29, 7
  s_add_u32 s27, s27, s29
  s_add_u32 s27, s27, s55
  s_mov_b32 m0, 144384
  s_nop 0
  buffer_load_dwordx4 v76, s[76:79], s27 offen lds
  s_mov_b32 m0, 145408
  s_nop 0
  buffer_load_dwordx4 v77, s[76:79], s27 offen lds
  s_mov_b32 m0, 146432
  s_nop 0
  buffer_load_dwordx4 v78, s[76:79], s27 offen lds
  s_mov_b32 m0, 147456
  s_nop 0
  buffer_load_dwordx4 v79, s[76:79], s27 offen lds
  s_barrier
  s_add_u32 s49, s48, 512
  s_mul_i32 s28, s49, 6554
  s_lshr_b32 s28, s28, 16
  s_mul_i32 s27, s28, 10
  s_sub_u32 s29, s49, s27
  s_mov_b32 s27, -54
  s_cmp_lt_u32 s28, 54
  s_cselect_b32 s27, 20, s27
  s_add_u32 s28, s28, s27
  s_lshl_b32 s27, s29, 2
  s_mul_i32 s70, s27, 13108
  s_lshr_b32 s70, s70, 16
  s_mul_i32 s55, s70, 5
  s_sub_u32 s31, s27, s55
  s_mul_i32 s70, s70, 74
  s_add_u32 s70, s70, s28
  s_mul_i32 s70, s70, 5120
  s_lshl_b32 s27, s31, 10
  s_add_u32 s70, s70, s27
  s_add_u32 s70, s70, 16777216
  s_cmp_ge_u32 s49, 740
  s_cselect_b32 s70, 1073741824, s70
  s_cselect_b32 s55, 1073741824, 0
  s_mul_i32 s27, s28, 13108
  s_lshr_b32 s27, s27, 16
  s_mul_i32 s27, s27, 5
  s_sub_u32 s27, s28, s27
  s_cmp_eq_u32 s27, 2
  s_cselect_b32 s27, 1, 0
  s_cmp_lt_u32 s28, 20
  s_cselect_b32 s47, s27, 0
  s_cselect_b32 s76, s62, s64
  s_cselect_b32 s77, s63, s65
  s_mov_b32 s27, 2211840
  s_cselect_b32 s78, 819200, s27
  s_cselect_b32 s27, 0, 20
  s_and_b32 s77, s77, 0xffff
  s_mov_b32 s79, 0x20000
  s_sub_u32 s27, s28, s27
  s_mul_i32 s27, s27, 40960
  s_lshl_b32 s29, s29, 7
  s_add_u32 s27, s27, s29
  s_add_u32 s27, s27, s55
  s_mov_b32 m0, 148480
  s_nop 0
  buffer_load_dwordx4 v76, s[76:79], s27 offen lds
  s_mov_b32 m0, 149504
  s_nop 0
  buffer_load_dwordx4 v77, s[76:79], s27 offen lds
  s_mov_b32 m0, 150528
  s_nop 0
  buffer_load_dwordx4 v78, s[76:79], s27 offen lds
  s_mov_b32 m0, 151552
  s_nop 0
  buffer_load_dwordx4 v79, s[76:79], s27 offen lds
  s_add_u32 s49, s48, 640
  s_mul_i32 s28, s49, 6554
  s_lshr_b32 s28, s28, 16
  s_mul_i32 s27, s28, 10
  s_sub_u32 s29, s49, s27
  s_mov_b32 s27, -54
  s_cmp_lt_u32 s28, 54
  s_cselect_b32 s27, 20, s27
  s_add_u32 s28, s28, s27
  s_lshl_b32 s27, s29, 2
  s_mul_i32 s71, s27, 13108
  s_lshr_b32 s71, s71, 16
  s_mul_i32 s55, s71, 5
  s_sub_u32 s32, s27, s55
  s_mul_i32 s71, s71, 74
  s_add_u32 s71, s71, s28
  s_mul_i32 s71, s71, 5120
  s_lshl_b32 s27, s32, 10
  s_add_u32 s71, s71, s27
  s_add_u32 s71, s71, 16777216
  s_cmp_ge_u32 s49, 740
  s_cselect_b32 s71, 1073741824, s71
  s_cselect_b32 s55, 1073741824, 0
  s_mul_i32 s27, s28, 13108
  s_lshr_b32 s27, s27, 16
  s_mul_i32 s27, s27, 5
  s_sub_u32 s27, s28, s27
  s_cmp_eq_u32 s27, 2
  s_cselect_b32 s27, 1, 0
  s_cmp_lt_u32 s28, 20
  s_cselect_b32 s51, s27, 0
  s_cselect_b32 s76, s62, s64
  s_cselect_b32 s77, s63, s65
  s_mov_b32 s27, 2211840
  s_cselect_b32 s78, 819200, s27
  s_cselect_b32 s27, 0, 20
  s_and_b32 s77, s77, 0xffff
  s_mov_b32 s79, 0x20000
  s_sub_u32 s27, s28, s27
  s_mul_i32 s27, s27, 40960
  s_lshl_b32 s29, s29, 7
  s_add_u32 s27, s27, s29
  s_add_u32 s27, s27, s55
  s_mov_b32 m0, 152576
  s_nop 0
  buffer_load_dwordx4 v76, s[76:79], s27 offen lds
  s_mov_b32 m0, 153600
  s_nop 0
  buffer_load_dwordx4 v77, s[76:79], s27 offen lds
  s_mov_b32 m0, 154624
  s_nop 0
  buffer_load_dwordx4 v78, s[76:79], s27 offen lds
  s_mov_b32 m0, 155648
  s_nop 0
  buffer_load_dwordx4 v79, s[76:79], s27 offen lds
  s_waitcnt vmcnt(16)
  s_mov_b32 s30, 0
L_poll_67:
  v_cmp_ge_u32 vcc, v19, v18
  s_nop 4
  s_cmp_eq_u64 vcc, -1
  s_cbranch_scc1 L_pollok_68
  s_add_u32 s30, s30, 1
  s_cmp_ge_u32 s30, 0x40000
  s_cbranch_scc1 L_pollok_68
  s_sleep 4
  buffer_load_dword v19, v17, s[56:59], 0 offen sc1
  s_waitcnt vmcnt(0)
  s_branch L_poll_67
L_pollok_68:
  s_lshl_b32 s27, s25, 7
  v_add_u32 v15, 0, v0
  v_add_u32 v15, s27, v15
  v_max_i32 v15, 0, v15
  v_min_i32 v15, 2047, v15
  v_lshlrev_b32 v15, 2, v15
  v_add_u32 v15, 25165824, v15
  buffer_load_dword v40, v15, s[16:19], 0 offen sc1
  v_add_u32 v15, 8192, v15
  buffer_load_dword v44, v15, s[16:19], 0 offen sc1
  v_add_u32 v15, 64, v0
  v_add_u32 v15, s27, v15
  v_max_i32 v15, 0, v15
  v_min_i32 v15, 2047, v15
  v_lshlrev_b32 v15, 2, v15
  v_add_u32 v15, 25165824, v15
  buffer_load_dword v41, v15, s[16:19], 0 offen sc1
  v_add_u32 v15, 8192, v15
  buffer_load_dword v45, v15, s[16:19], 0 offen sc1
  v_lshlrev_b32 v48, 7, v0
  v_add_u32 v48, 26279936, v48
  v_add_u32 v49, 8192, v48
  buffer_load_dword v50, v48, s[16:19], 0 offen sc1
  buffer_load_dword v51, v49, s[16:19], 0 offen sc1
  s_barrier
  s_barrier
  s_barrier
  s_waitcnt vmcnt(2)
  v_lshlrev_b32 v15, 2, v0
  v_add_u32 v15, 156672, v15
  ds_write_b32 v15, v40 offset:0
  ds_write_b32 v15, v44 offset:576
  ds_write_b32 v15, v41 offset:256
  ds_write_b32 v15, v45 offset:832
  s_mov_b64 exec, -1
  s_waitcnt lgkmcnt(0)
  s_barrier
  s_waitcnt vmcnt(0)
  s_mov_b32 s30, 0
L_fb_69:
  v_min_u32 v50, v50, v51
  v_cmp_le_u32 vcc, 1, v50
  s_nop 4
  s_cmp_eq_u64 vcc, -1
  s_cbranch_scc1 L_fbok_70
  s_add_u32 s30, s30, 1
  s_cmp_ge_u32 s30, 0x40000
  s_cbranch_scc1 L_fbok_70
  s_sleep 6
  buffer_load_dword v50, v48, s[16:19], 0 offen sc1
  buffer_load_dword v51, v49, s[16:19], 0 offen sc1
  s_waitcnt vmcnt(0)
  s_branch L_fb_69
L_fbok_70:
  v_mov_b32 v31, 1
  ds_write_b32 v30, v31
  s_waitcnt lgkmcnt(0)
  s_lshr_b32 s48, s86, 1
  s_lshl_b32 s48, s48, 4
  s_mov_b32 s41, s48
  s_cmp_eq_u32 s43, 1
  s_cbranch_scc1 L_rlsp_71
  v_add_u32 v120, 140288, v80
  v_add_u32 v121, 140288, v81
  v_add_u32 v122, 140288, v82
  v_add_u32 v123, 140288, v83
  ds_read_b64_tr_b16 v[88:89], v120
  ds_read_b64_tr_b16 v[90:91], v120 offset:2048
  ds_read_b64_tr_b16 v[92:93], v121
  ds_read_b64_tr_b16 v[94:95], v121 offset:2048
  ds_read_b64_tr_b16 v[96:97], v122
  ds_read_b64_tr_b16 v[98:99], v122 offset:2048
  ds_read_b64_tr_b16 v[100:101], v123
  ds_read_b64_tr_b16 v[102:103], v123 offset:2048
  s_branch L_rldn_72
L_rlsp_71:
  v_lshrrev_b32 v124, 4, v0
  v_and_b32 v125, 1, v124
  v_lshrrev_b32 v124, 1, v124
  v_lshl_add_u32 v124, v125, 1, v124
  v_bfe_u32 v125, v0, 2, 2
  v_lshl_add_u32 v124, v124, 3, v125
  v_lshlrev_b32 v124, 7, v124
  v_and_b32 v126, 1, v0
  v_lshl_add_u32 v124, v126, 3, v124
  v_add_u32 v124, 140288, v124
  v_lshrrev_b32 v125, 1, v125
  v_lshlrev_b32 v125, 1, v125
  v_bfe_u32 v126, v0, 1, 1
  v_add_u32 v127, 0, v126
  v_xor_b32 v128, v127, v125
  v_lshl_add_u32 v128, v128, 4, v124
  ds_read_b64_tr_b16 v[88:89], v128
  v_xor_b32 v129, 4, v125
  v_xor_b32 v129, v127, v129
  v_lshl_add_u32 v129, v129, 4, v124
  ds_read_b64_tr_b16 v[90:91], v129 offset:512
  v_add_u32 v127, 2, v126
  v_xor_b32 v128, v127, v125
  v_lshl_add_u32 v128, v128, 4, v124
  ds_read_b64_tr_b16 v[92:93], v128
  v_xor_b32 v129, 4, v125
  v_xor_b32 v129, v127, v129
  v_lshl_add_u32 v129, v129, 4, v124
  ds_read_b64_tr_b16 v[94:95], v129 offset:512
  v_add_u32 v127, 4, v126
  v_xor_b32 v128, v127, v125
  v_lshl_add_u32 v128, v128, 4, v124
  ds_read_b64_tr_b16 v[96:97], v128
  v_xor_b32 v129, 4, v125
  v_xor_b32 v129, v127, v129
  v_lshl_add_u32 v129, v129, 4, v124
  ds_read_b64_tr_b16 v[98:99], v129 offset:512
  v_add_u32 v127, 6, v126
  v_xor_b32 v128, v127, v125
  v_lshl_add_u32 v128, v128, 4, v124
  ds_read_b64_tr_b16 v[100:101], v128
  v_xor_b32 v129, 4, v125
  v_xor_b32 v129, v127, v129
  v_lshl_add_u32 v129, v129, 4, v124
  ds_read_b64_tr_b16 v[102:103], v129 offset:512
L_rldn_72:
  s_movk_i32 s29, 0x400
  s_waitcnt lgkmcnt(0)
  buffer_store_dwordx4 v[88:91], v84, s[16:19], s68 offen sc0 sc1
  s_cmp_eq_u32 s6, 4
  s_cselect_b32 s27, 374784, s29
  s_cselect_b32 s6, -1, s6
  s_add_u32 s68, s68, s27
  s_add_u32 s6, s6, 1
  buffer_store_dwordx4 v[92:95], v84, s[16:19], s68 offen sc0 sc1
  s_cmp_eq_u32 s6, 4
  s_cselect_b32 s27, 374784, s29
  s_cselect_b32 s6, -1, s6
  s_add_u32 s68, s68, s27
  s_add_u32 s6, s6, 1
  buffer_store_dwordx4 v[96:99], v84, s[16:19], s68 offen sc0 sc1
  s_cmp_eq_u32 s6, 4
  s_cselect_b32 s27, 374784, s29
  s_cselect_b32 s6, -1, s6
  s_add_u32 s68, s68, s27
  s_add_u32 s6, s6, 1
  buffer_store_dwordx4 v[100:103], v84, s[16:19], s68 offen sc0 sc1
  s_cmp_eq_u32 s46, 1
  s_cbranch_scc1 L_rlsp_73
  v_add_u32 v120, 144384, v80
  v_add_u32 v121, 144384, v81
  v_add_u32 v122, 144384, v82
  v_add_u32 v123, 144384, v83
  ds_read_b64_tr_b16 v[104:105], v120
  ds_read_b64_tr_b16 v[106:107], v120 offset:2048
  ds_read_b64_tr_b16 v[108:109], v121
  ds_read_b64_tr_b16 v[110:111], v121 offset:2048
  ds_read_b64_tr_b16 v[112:113], v122
  ds_read_b64_tr_b16 v[114:115], v122 offset:2048
  ds_read_b64_tr_b16 v[116:117], v123
  ds_read_b64_tr_b16 v[118:119], v123 offset:2048
  s_branch L_rldn_74
L_rlsp_73:
  v_lshrrev_b32 v124, 4, v0
  v_and_b32 v125, 1, v124
  v_lshrrev_b32 v124, 1, v124
  v_lshl_add_u32 v124, v125, 1, v124
  v_bfe_u32 v125, v0, 2, 2
  v_lshl_add_u32 v124, v124, 3, v125
  v_lshlrev_b32 v124, 7, v124
  v_and_b32 v126, 1, v0
  v_lshl_add_u32 v124, v126, 3, v124
  v_add_u32 v124, 144384, v124
  v_lshrrev_b32 v125, 1, v125
  v_lshlrev_b32 v125, 1, v125
  v_bfe_u32 v126, v0, 1, 1
  v_add_u32 v127, 0, v126
  v_xor_b32 v128, v127, v125
  v_lshl_add_u32 v128, v128, 4, v124
  ds_read_b64_tr_b16 v[104:105], v128
  v_xor_b32 v129, 4, v125
  v_xor_b32 v129, v127, v129
  v_lshl_add_u32 v129, v129, 4, v124
  ds_read_b64_tr_b16 v[106:107], v129 offset:512
  v_add_u32 v127, 2, v126
  v_xor_b32 v128, v127, v125
  v_lshl_add_u32 v128, v128, 4, v124
  ds_read_b64_tr_b16 v[108:109], v128
  v_xor_b32 v129, 4, v125
  v_xor_b32 v129, v127, v129
  v_lshl_add_u32 v129, v129, 4, v124
  ds_read_b64_tr_b16 v[110:111], v129 offset:512
  v_add_u32 v127, 4, v126
  v_xor_b32 v128, v127, v125
  v_lshl_add_u32 v128, v128, 4, v124
  ds_read_b64_tr_b16 v[112:113], v128
  v_xor_b32 v129, 4, v125
  v_xor_b32 v129, v127, v129
  v_lshl_add_u32 v129, v129, 4, v124
  ds_read_b64_tr_b16 v[114:115], v129 offset:512
  v_add_u32 v127, 6, v126
  v_xor_b32 v128, v127, v125
  v_lshl_add_u32 v128, v128, 4, v124
  ds_read_b64_tr_b16 v[116:117], v128
  v_xor_b32 v129, 4, v125
  v_xor_b32 v129, v127, v129
  v_lshl_add_u32 v129, v129, 4, v124
  ds_read_b64_tr_b16 v[118:119], v129 offset:512
L_rldn_74:
  s_movk_i32 s29, 0x400
  s_waitcnt lgkmcnt(0)
  buffer_store_dwordx4 v[104:107], v84, s[16:19], s69 offen sc0 sc1
  s_cmp_eq_u32 s7, 4
  s_cselect_b32 s27, 374784, s29
  s_cselect_b32 s7, -1, s7
  s_add_u32 s69, s69, s27
  s_add_u32 s7, s7, 1
  buffer_store_dwordx4 v[108:111], v84, s[16:19], s69 offen sc0 sc1
  s_cmp_eq_u32 s7, 4
  s_cselect_b32 s27, 374784, s29
  s_cselect_b32 s7, -1, s7
  s_add_u32 s69, s69, s27
  s_add_u32 s7, s7, 1
  buffer_store_dwordx4 v[112:115], v84, s[16:19], s69 offen sc0 sc1
  s_cmp_eq_u32 s7, 4
  s_cselect_b32 s27, 374784, s29
  s_cselect_b32 s7, -1, s7
  s_add_u32 s69, s69, s27
  s_add_u32 s7, s7, 1
  buffer_store_dwordx4 v[116:119], v84, s[16:19], s69 offen sc0 sc1
  s_cmp_eq_u32 s47, 1
  s_cbranch_scc1 L_rlsp_75
  v_add_u32 v120, 148480, v80
  v_add_u32 v121, 148480, v81
  v_add_u32 v122, 148480, v82
  v_add_u32 v123, 148480, v83
  ds_read_b64_tr_b16 v[88:89], v120
  ds_read_b64_tr_b16 v[90:91], v120 offset:2048
  ds_read_b64_tr_b16 v[92:93], v121
  ds_read_b64_tr_b16 v[94:95], v121 offset:2048
  ds_read_b64_tr_b16 v[96:97], v122
  ds_read_b64_tr_b16 v[98:99], v122 offset:2048
  ds_read_b64_tr_b16 v[100:101], v123
  ds_read_b64_tr_b16 v[102:103], v123 offset:2048
  s_branch L_rldn_76
L_rlsp_75:
  v_lshrrev_b32 v124, 4, v0
  v_and_b32 v125, 1, v124
  v_lshrrev_b32 v124, 1, v124
  v_lshl_add_u32 v124, v125, 1, v124
  v_bfe_u32 v125, v0, 2, 2
  v_lshl_add_u32 v124, v124, 3, v125
  v_lshlrev_b32 v124, 7, v124
  v_and_b32 v126, 1, v0
  v_lshl_add_u32 v124, v126, 3, v124
  v_add_u32 v124, 148480, v124
  v_lshrrev_b32 v125, 1, v125
  v_lshlrev_b32 v125, 1, v125
  v_bfe_u32 v126, v0, 1, 1
  v_add_u32 v127, 0, v126
  v_xor_b32 v128, v127, v125
  v_lshl_add_u32 v128, v128, 4, v124
  ds_read_b64_tr_b16 v[88:89], v128
  v_xor_b32 v129, 4, v125
  v_xor_b32 v129, v127, v129
  v_lshl_add_u32 v129, v129, 4, v124
  ds_read_b64_tr_b16 v[90:91], v129 offset:512
  v_add_u32 v127, 2, v126
  v_xor_b32 v128, v127, v125
  v_lshl_add_u32 v128, v128, 4, v124
  ds_read_b64_tr_b16 v[92:93], v128
  v_xor_b32 v129, 4, v125
  v_xor_b32 v129, v127, v129
  v_lshl_add_u32 v129, v129, 4, v124
  ds_read_b64_tr_b16 v[94:95], v129 offset:512
  v_add_u32 v127, 4, v126
  v_xor_b32 v128, v127, v125
  v_lshl_add_u32 v128, v128, 4, v124
  ds_read_b64_tr_b16 v[96:97], v128
  v_xor_b32 v129, 4, v125
  v_xor_b32 v129, v127, v129
  v_lshl_add_u32 v129, v129, 4, v124
  ds_read_b64_tr_b16 v[98:99], v129 offset:512
  v_add_u32 v127, 6, v126
  v_xor_b32 v128, v127, v125
  v_lshl_add_u32 v128, v128, 4, v124
  ds_read_b64_tr_b16 v[100:101], v128
  v_xor_b32 v129, 4, v125
  v_xor_b32 v129, v127, v129
  v_lshl_add_u32 v129, v129, 4, v124
  ds_read_b64_tr_b16 v[102:103], v129 offset:512
L_rldn_76:
  s_movk_i32 s29, 0x400
  s_waitcnt lgkmcnt(0)
  buffer_store_dwordx4 v[88:91], v84, s[16:19], s70 offen sc0 sc1
  s_cmp_eq_u32 s31, 4
  s_cselect_b32 s27, 374784, s29
  s_cselect_b32 s31, -1, s31
  s_add_u32 s70, s70, s27
  s_add_u32 s31, s31, 1
  buffer_store_dwordx4 v[92:95], v84, s[16:19], s70 offen sc0 sc1
  s_cmp_eq_u32 s31, 4
  s_cselect_b32 s27, 374784, s29
  s_cselect_b32 s31, -1, s31
  s_add_u32 s70, s70, s27
  s_add_u32 s31, s31, 1
  buffer_store_dwordx4 v[96:99], v84, s[16:19], s70 offen sc0 sc1
  s_cmp_eq_u32 s31, 4
  s_cselect_b32 s27, 374784, s29
  s_cselect_b32 s31, -1, s31
  s_add_u32 s70, s70, s27
  s_add_u32 s31, s31, 1
  buffer_store_dwordx4 v[100:103], v84, s[16:19], s70 offen sc0 sc1
  s_cmp_eq_u32 s51, 1
  s_cbranch_scc1 L_rlsp_77
  v_add_u32 v120, 152576, v80
  v_add_u32 v121, 152576, v81
  v_add_u32 v122, 152576, v82
  v_add_u32 v123, 152576, v83
  ds_read_b64_tr_b16 v[104:105], v120
  ds_read_b64_tr_b16 v[106:107], v120 offset:2048
  ds_read_b64_tr_b16 v[108:109], v121
  ds_read_b64_tr_b16 v[110:111], v121 offset:2048
  ds_read_b64_tr_b16 v[112:113], v122
  ds_read_b64_tr_b16 v[114:115], v122 offset:2048
  ds_read_b64_tr_b16 v[116:117], v123
  ds_read_b64_tr_b16 v[118:119], v123 offset:2048
  s_branch L_rldn_78
L_rlsp_77:
  v_lshrrev_b32 v124, 4, v0
  v_and_b32 v125, 1, v124
  v_lshrrev_b32 v124, 1, v124
  v_lshl_add_u32 v124, v125, 1, v124
  v_bfe_u32 v125, v0, 2, 2
  v_lshl_add_u32 v124, v124, 3, v125
  v_lshlrev_b32 v124, 7, v124
  v_and_b32 v126, 1, v0
  v_lshl_add_u32 v124, v126, 3, v124
  v_add_u32 v124, 152576, v124
  v_lshrrev_b32 v125, 1, v125
  v_lshlrev_b32 v125, 1, v125
  v_bfe_u32 v126, v0, 1, 1
  v_add_u32 v127, 0, v126
  v_xor_b32 v128, v127, v125
  v_lshl_add_u32 v128, v128, 4, v124
  ds_read_b64_tr_b16 v[104:105], v128
  v_xor_b32 v129, 4, v125
  v_xor_b32 v129, v127, v129
  v_lshl_add_u32 v129, v129, 4, v124
  ds_read_b64_tr_b16 v[106:107], v129 offset:512
  v_add_u32 v127, 2, v126
  v_xor_b32 v128, v127, v125
  v_lshl_add_u32 v128, v128, 4, v124
  ds_read_b64_tr_b16 v[108:109], v128
  v_xor_b32 v129, 4, v125
  v_xor_b32 v129, v127, v129
  v_lshl_add_u32 v129, v129, 4, v124
  ds_read_b64_tr_b16 v[110:111], v129 offset:512
  v_add_u32 v127, 4, v126
  v_xor_b32 v128, v127, v125
  v_lshl_add_u32 v128, v128, 4, v124
  ds_read_b64_tr_b16 v[112:113], v128
  v_xor_b32 v129, 4, v125
  v_xor_b32 v129, v127, v129
  v_lshl_add_u32 v129, v129, 4, v124
  ds_read_b64_tr_b16 v[114:115], v129 offset:512
  v_add_u32 v127, 6, v126
  v_xor_b32 v128, v127, v125
  v_lshl_add_u32 v128, v128, 4, v124
  ds_read_b64_tr_b16 v[116:117], v128
  v_xor_b32 v129, 4, v125
  v_xor_b32 v129, v127, v129
  v_lshl_add_u32 v129, v129, 4, v124
  ds_read_b64_tr_b16 v[118:119], v129 offset:512
L_rldn_78:
  s_movk_i32 s29, 0x400
  s_waitcnt lgkmcnt(0)
  buffer_store_dwordx4 v[104:107], v84, s[16:19], s71 offen sc0 sc1
  s_cmp_eq_u32 s32, 4
  s_cselect_b32 s27, 374784, s29
  s_cselect_b32 s32, -1, s32
  s_add_u32 s71, s71, s27
  s_add_u32 s32, s32, 1
  buffer_store_dwordx4 v[108:111], v84, s[16:19], s71 offen sc0 sc1
  s_cmp_eq_u32 s32, 4
  s_cselect_b32 s27, 374784, s29
  s_cselect_b32 s32, -1, s32
  s_add_u32 s71, s71, s27
  s_add_u32 s32, s32, 1
  buffer_store_dwordx4 v[112:115], v84, s[16:19], s71 offen sc0 sc1
  s_cmp_eq_u32 s32, 4
  s_cselect_b32 s27, 374784, s29
  s_cselect_b32 s32, -1, s32
  s_add_u32 s71, s71, s27
  s_add_u32 s32, s32, 1
  buffer_store_dwordx4 v[116:119], v84, s[16:19], s71 offen sc0 sc1
  s_waitcnt vmcnt(0)
  s_lshl_b32 s27, s25, 3
  s_add_u32 s27, s27, s26
  s_lshl_b32 s27, s27, 2
  s_add_u32 s27, s27, 26296320
  v_mov_b32 v8, 1
  v_mov_b32 v9, 0
  s_mov_b64 exec, 1
  buffer_store_dword v8, v9, s[16:19], s27 offen sc0 sc1
  s_mov_b64 exec, -1
  s_barrier
  s_lshl_b32 s27, s25, 4
  s_add_u32 s27, s27, s50
  s_lshl_b32 s27, s27, 7
  s_add_u32 s27, s27, 26214400
  v_mov_b32 v8, 1
  v_mov_b32 v9, 0
  s_mov_b64 exec, 1
  buffer_store_dword v8, v9, s[16:19], s27 offen sc0 sc1
  s_mov_b64 exec, -1
  s_lshr_b32 s27, s86, 1
  s_lshl_b32 s27, s27, 4
  s_add_u32 s27, s27, 8
  s_lshl_b32 s27, s27, 7
  s_add_u32 s27, s27, 26214400
  v_lshlrev_b32 v17, 7, v0
  v_add_u32 v17, s27, v17
  v_mov_b32 v18, 1
  v_mov_b32 v22, 0
  v_mov_b32 v23, 1073741824
  v_cmp_lt_u32 vcc, 7, v0
  s_nop 1
  v_cndmask_b32 v18, v18, v22, vcc
  v_cndmask_b32 v17, v17, v23, vcc
  s_mov_b32 s28, 3
  s_mov_b32 s29, 0
  v_mov_b32 v18, 1
  v_cndmask_b32 v18, v22, v18, s[28:29]
  buffer_load_dword v19, v17, s[16:19], 0 offen sc1
  s_waitcnt vmcnt(0)
  s_mov_b32 s30, 0
L_poll_79:
  v_cmp_ge_u32 vcc, v19, v18
  s_nop 4
  s_cmp_eq_u64 vcc, -1
  s_cbranch_scc1 L_pollok_80
  s_add_u32 s30, s30, 1
  s_cmp_ge_u32 s30, 0x40000
  s_cbranch_scc1 L_pollok_80
  s_sleep 6
  buffer_load_dword v19, v17, s[16:19], 0 offen sc1
  s_waitcnt vmcnt(0)
  s_branch L_poll_79
L_pollok_80:
  v_mov_b32 v31, 2
  ds_write_b32 v30, v31
  s_waitcnt lgkmcnt(0)
  s_barrier
  s_mov_b32 s31, 0
  buffer_load_dword v19, v17, s[16:19], 0 offen sc1
  s_barrier
  s_barrier
  s_cmp_eq_u32 s31, 1
  s_cbranch_scc1 L_gate_81
  s_waitcnt vmcnt(0)
  s_mov_b32 s28, 7
  s_mov_b32 s29, 0
  v_mov_b32 v18, 1
  v_cndmask_b32 v18, v22, v18, s[28:29]
  s_mov_b32 s30, 0
L_poll_82:
  v_cmp_ge_u32 vcc, v19, v18
  s_nop 4
  s_cmp_eq_u64 vcc, -1
  s_cbranch_scc1 L_pollok_83
  s_add_u32 s30, s30, 1
  s_cmp_ge_u32 s30, 0x40000
  s_cbranch_scc1 L_pollok_83
  s_sleep 4
  buffer_load_dword v19, v17, s[16:19], 0 offen sc1
  s_waitcnt vmcnt(0)
  s_branch L_poll_82
L_pollok_83:
  v_cmp_le_u32 vcc, 1, v19
  s_nop 4
  s_and_b32 s27, vcc_lo, 0xff
  s_cmp_eq_u32 s27, 0xff
  s_cselect_b32 s31, 1, 0
L_gate_81:
  s_barrier
  s_barrier
  v_lshlrev_b32 v48, 3, v0
  v_add_u32 v48, 26296320, v48
  v_add_u32 v49, 8192, v48
  buffer_load_dwordx2 v[50:51], v48, s[16:19], 0 offen sc1
  s_barrier
  s_cmp_eq_u32 s31, 1
  s_cbranch_scc1 L_gate_84
  buffer_load_dword v19, v17, s[16:19], 0 offen sc1
  s_waitcnt vmcnt(0)
  s_mov_b32 s28, 15
  s_mov_b32 s29, 0
  v_mov_b32 v18, 1
  v_cndmask_b32 v18, v22, v18, s[28:29]
  s_mov_b32 s30, 0
L_poll_85:
  v_cmp_ge_u32 vcc, v19, v18
  s_nop 4
  s_cmp_eq_u64 vcc, -1
  s_cbranch_scc1 L_pollok_86
  s_add_u32 s30, s30, 1
  s_cmp_ge_u32 s30, 0x40000
  s_cbranch_scc1 L_pollok_86
  s_sleep 4
  buffer_load_dword v19, v17, s[16:19], 0 offen sc1
  s_waitcnt vmcnt(0)
  s_branch L_poll_85
L_pollok_86:
  v_cmp_le_u32 vcc, 1, v19
  s_nop 4
  s_and_b32 s27, vcc_lo, 0xff
  s_cmp_eq_u32 s27, 0xff
  s_cselect_b32 s31, 1, 0
L_gate_84:
  s_barrier
  s_barrier
  s_waitcnt vmcnt(0)
  s_mov_b32 s30, 0
L_fb2_87:
  v_min_u32 v50, v50, v51
  v_cmp_le_u32 vcc, 1, v50
  s_nop 4
  s_cmp_eq_u64 vcc, -1
  s_cbranch_scc1 L_fb2ok_88
  s_add_u32 s30, s30, 1
  s_cmp_ge_u32 s30, 0x40000
  s_cbranch_scc1 L_fb2ok_88
  s_sleep 6
  buffer_load_dwordx2 v[50:51], v48, s[16:19], 0 offen sc1
  s_waitcnt vmcnt(0)
  s_branch L_fb2_87
L_fb2ok_88:
  s_barrier
  s_barrier
  s_cmp_eq_u32 s31, 1
  s_cbranch_scc1 L_gate_89
  buffer_load_dword v19, v17, s[16:19], 0 offen sc1
  s_waitcnt vmcnt(0)
  s_mov_b32 s28, 31
  s_mov_b32 s29, 0
  v_mov_b32 v18, 1
  v_cndmask_b32 v18, v22, v18, s[28:29]
  s_mov_b32 s30, 0
L_poll_90:
  v_cmp_ge_u32 vcc, v19, v18
  s_nop 4
  s_cmp_eq_u64 vcc, -1
  s_cbranch_scc1 L_pollok_91
  s_add_u32 s30, s30, 1
  s_cmp_ge_u32 s30, 0x40000
  s_cbranch_scc1 L_pollok_91
  s_sleep 4
  buffer_load_dword v19, v17, s[16:19], 0 offen sc1
  s_waitcnt vmcnt(0)
  s_branch L_poll_90
L_pollok_91:
  v_cmp_le_u32 vcc, 1, v19
  s_nop 4
  s_and_b32 s27, vcc_lo, 0xff
  s_cmp_eq_u32 s27, 0xff
  s_cselect_b32 s31, 1, 0
L_gate_89:
  s_barrier
  s_barrier
  s_barrier
  s_cmp_eq_u32 s31, 1
  s_cbranch_scc1 L_gate_92
  buffer_load_dword v19, v17, s[16:19], 0 offen sc1
  s_waitcnt vmcnt(0)
  s_mov_b32 s28, 63
  s_mov_b32 s29, 0
  v_mov_b32 v18, 1
  v_cndmask_b32 v18, v22, v18, s[28:29]
  s_mov_b32 s30, 0
L_poll_93:
  v_cmp_ge_u32 vcc, v19, v18
  s_nop 4
  s_cmp_eq_u64 vcc, -1
  s_cbranch_scc1 L_pollok_94
  s_add_u32 s30, s30, 1
  s_cmp_ge_u32 s30, 0x40000
  s_cbranch_scc1 L_pollok_94
  s_sleep 4
  buffer_load_dword v19, v17, s[16:19], 0 offen sc1
  s_waitcnt vmcnt(0)
  s_branch L_poll_93
L_pollok_94:
  v_cmp_le_u32 vcc, 1, v19
  s_nop 4
  s_and_b32 s27, vcc_lo, 0xff
  s_cmp_eq_u32 s27, 0xff
  s_cselect_b32 s31, 1, 0
L_gate_92:
  s_barrier
  s_barrier
  s_barrier
  s_barrier
  s_cmp_eq_u32 s31, 1
  s_cbranch_scc1 L_gate_95
  buffer_load_dword v19, v17, s[16:19], 0 offen sc1
  s_waitcnt vmcnt(0)
  s_mov_b32 s28, 127
  s_mov_b32 s29, 0
  v_mov_b32 v18, 1
  v_cndmask_b32 v18, v22, v18, s[28:29]
  s_mov_b32 s30, 0
L_poll_96:
  v_cmp_ge_u32 vcc, v19, v18
  s_nop 4
  s_cmp_eq_u64 vcc, -1
  s_cbranch_scc1 L_pollok_97
  s_add_u32 s30, s30, 1
  s_cmp_ge_u32 s30, 0x40000
  s_cbranch_scc1 L_pollok_97
  s_sleep 4
  buffer_load_dword v19, v17, s[16:19], 0 offen sc1
  s_waitcnt vmcnt(0)
  s_branch L_poll_96
L_pollok_97:
  v_cmp_le_u32 vcc, 1, v19
  s_nop 4
  s_and_b32 s27, vcc_lo, 0xff
  s_cmp_eq_u32 s27, 0xff
  s_cselect_b32 s31, 1, 0
L_gate_95:
  s_barrier
  s_barrier
  s_barrier
  s_cmp_eq_u32 s31, 1
  s_cbranch_scc1 L_gate_98
  buffer_load_dword v19, v17, s[16:19], 0 offen sc1
  s_waitcnt vmcnt(0)
  s_mov_b32 s28, 255
  s_mov_b32 s29, 0
  v_mov_b32 v18, 1
  v_cndmask_b32 v18, v22, v18, s[28:29]
  s_mov_b32 s30, 0
L_poll_99:
  v_cmp_ge_u32 vcc, v19, v18
  s_nop 4
  s_cmp_eq_u64 vcc, -1
  s_cbranch_scc1 L_pollok_100
  s_add_u32 s30, s30, 1
  s_cmp_ge_u32 s30, 0x40000
  s_cbranch_scc1 L_pollok_100
  s_sleep 4
  buffer_load_dword v19, v17, s[16:19], 0 offen sc1
  s_waitcnt vmcnt(0)
  s_branch L_poll_99
L_pollok_100:
  v_cmp_le_u32 vcc, 1, v19
  s_nop 4
  s_and_b32 s27, vcc_lo, 0xff
  s_cmp_eq_u32 s27, 0xff
  s_cselect_b32 s31, 1, 0
L_gate_98:
  s_lshr_b32 s27, s86, 1
  s_lshl_b32 s27, s27, 4
  s_add_u32 s27, s27, 0
  s_lshl_b32 s27, s27, 7
  s_add_u32 s27, s27, 26214400
  v_lshlrev_b32 v17, 7, v0
  v_add_u32 v17, s27, v17
  v_mov_b32 v18, 1
  v_mov_b32 v22, 0
  v_mov_b32 v23, 1073741824
  v_cmp_lt_u32 vcc, 7, v0
  s_nop 1
  v_cndmask_b32 v18, v18, v22, vcc
  v_cndmask_b32 v17, v17, v23, vcc
  s_barrier
  buffer_load_dword v19, v17, s[16:19], 0 offen sc1
  s_barrier
  s_barrier
  s_waitcnt vmcnt(0)
  s_mov_b32 s30, 0
L_poll_101:
  v_cmp_ge_u32 vcc, v19, v18
  s_nop 4
  s_cmp_eq_u64 vcc, -1
  s_cbranch_scc1 L_pollok_102
  s_add_u32 s30, s30, 1
  s_cmp_ge_u32 s30, 0x40000
  s_cbranch_scc1 L_pollok_102
  s_sleep 8
  buffer_load_dword v19, v17, s[16:19], 0 offen sc1
  s_waitcnt vmcnt(0)
  s_branch L_poll_101
L_pollok_102:
  s_barrier
  s_barrier
  s_barrier
  s_barrier
  s_barrier
  s_barrier
  s_barrier
  s_barrier
  s_barrier
  s_barrier
  s_barrier
  s_barrier
  s_barrier
  s_barrier
  s_barrier
  s_endpgm
L_cQ:
L_cQ_init:
  v_lshrrev_b32 v2, 4, v0
  v_bfe_u32 v3, v0, 2, 2
  v_and_b32 v4, 3, v0
  v_and_b32 v5, 1, v2
  v_lshl_add_u32 v6, v2, 3, v3
  v_mul_u32_u24 v6, 576, v6
  v_lshl_add_u32 v14, v4, 3, v6
  v_lshlrev_b32 v15, 1, v5
  v_and_b32 v3, 15, v0
  v_lshrrev_b32 v4, 1, v3
  v_xor_b32 v4, v4, v2
  v_lshlrev_b32 v4, 4, v4
  v_lshl_add_u32 v4, v3, 7, v4
  s_lshl_b32 s27, s24, 12
  s_add_u32 s27, s27, 94208
  v_add_u32 v6, s27, v4
  v_xor_b32 v7, 64, v6
  v_add_u32 v8, 92160, v4
  v_xor_b32 v9, 64, v8
  v_cmp_eq_u32 vcc, 0, v3
  s_nop 2
  s_not_b64 s[42:43], vcc
  v_mov_b32 v200, 0x3f803f80
  v_mov_b32 v201, 0x3f803f80
  v_mov_b32 v202, 0x3f803f80
  v_mov_b32 v203, 0x3f803f80
  v_mov_b32 v212, 0x3f803f80
  v_mov_b32 v213, 0x3f803f80
  v_mov_b32 v214, 0x3f803f80
  v_mov_b32 v215, 0x3f803f80
  s_cmp_ge_u32 0, s35
  s_cselect_b32 s27, 2, 0
  v_xor_b32 v13, s27, v15
  v_lshl_add_u32 v1, v13, 4, v14
  s_cmp_ge_u32 2, s35
  s_cselect_b32 s27, 4, 2
  v_xor_b32 v13, s27, v15
  v_lshl_add_u32 v2, v13, 4, v14
  s_cmp_ge_u32 4, s35
  s_cselect_b32 s27, 6, 4
  v_xor_b32 v13, s27, v15
  v_lshl_add_u32 v3, v13, 4, v14
  s_cmp_ge_u32 6, s35
  s_cselect_b32 s27, 8, 6
  v_xor_b32 v13, s27, v15
  v_lshl_add_u32 v4, v13, 4, v14
  s_cmp_ge_u32 8, s35
  s_cselect_b32 s27, 10, 8
  v_xor_b32 v13, s27, v15
  v_lshl_add_u32 v5, v13, 4, v14
  v_mov_b32 v16, 0
  v_mov_b32 v17, 0
  v_mov_b32 v18, 0
  v_mov_b32 v19, 0
  v_mov_b32 v20, 0
  v_mov_b32 v21, 0
  v_mov_b32 v22, 0
  v_mov_b32 v23, 0
  v_mov_b32 v24, 0
  v_mov_b32 v25, 0
  v_mov_b32 v26, 0
  v_mov_b32 v27, 0
  v_mov_b32 v28, 0
  v_mov_b32 v29, 0
  v_mov_b32 v30, 0
  v_mov_b32 v31, 0
  v_mov_b32 v32, 0
  v_mov_b32 v33, 0
  v_mov_b32 v34, 0
  v_mov_b32 v35, 0
  v_mov_b32 v36, 0
  v_mov_b32 v37, 0
  v_mov_b32 v38, 0
  v_mov_b32 v39, 0
  v_mov_b32 v40, 0
  v_mov_b32 v41, 0
  v_mov_b32 v42, 0
  v_mov_b32 v43, 0
  v_mov_b32 v44, 0
  v_mov_b32 v45, 0
  v_mov_b32 v46, 0
  v_mov_b32 v47, 0
  v_mov_b32 v48, 0
  v_mov_b32 v49, 0
  v_mov_b32 v50, 0
  v_mov_b32 v51, 0
  v_mov_b32 v52, 0
  v_mov_b32 v53, 0
  v_mov_b32 v54, 0
  v_mov_b32 v55, 0
  v_mov_b32 v56, 0
  v_mov_b32 v57, 0
  v_mov_b32 v58, 0
  v_mov_b32 v59, 0
  v_mov_b32 v60, 0
  v_mov_b32 v61, 0
  v_mov_b32 v62, 0
  v_mov_b32 v63, 0
  v_mov_b32 v64, 0
  v_mov_b32 v65, 0
  v_mov_b32 v66, 0
  v_mov_b32 v67, 0
  v_mov_b32 v68, 0
  v_mov_b32 v69, 0
  v_mov_b32 v70, 0
  v_mov_b32 v71, 0
  v_mov_b32 v72, 0
  v_mov_b32 v73, 0
  v_mov_b32 v74, 0
  v_mov_b32 v75, 0
  v_mov_b32 v76, 0
  v_mov_b32 v77, 0
  v_mov_b32 v78, 0
  v_mov_b32 v79, 0
  v_mov_b32 v80, 0
  v_mov_b32 v81, 0
  v_mov_b32 v82, 0
  v_mov_b32 v83, 0
  v_mov_b32 v84, 0
  v_mov_b32 v85, 0
  v_mov_b32 v86, 0
  v_mov_b32 v87, 0
  v_mov_b32 v88, 0
  v_mov_b32 v89, 0
  v_mov_b32 v90, 0
  v_mov_b32 v91, 0
  v_mov_b32 v92, 0
  v_mov_b32 v93, 0
  v_mov_b32 v94, 0
  v_mov_b32 v95, 0
  v_mov_b32 v96, 0
  v_mov_b32 v97, 0
  v_mov_b32 v98, 0
  v_mov_b32 v99, 0
  v_mov_b32 v100, 0
  v_mov_b32 v101, 0
  v_mov_b32 v102, 0
  v_mov_b32 v103, 0
  v_mov_b32 v104, 0
  v_mov_b32 v105, 0
  v_mov_b32 v106, 0
  v_mov_b32 v107, 0
  v_mov_b32 v108, 0
  v_mov_b32 v109, 0
  v_mov_b32 v110, 0
  v_mov_b32 v111, 0
  v_mov_b32 v112, 0
  v_mov_b32 v113, 0
  v_mov_b32 v114, 0
  v_mov_b32 v115, 0
  v_mov_b32 v116, 0
  v_mov_b32 v117, 0
  v_mov_b32 v118, 0
  v_mov_b32 v119, 0
  v_mov_b32 v120, 0
  v_mov_b32 v121, 0
  v_mov_b32 v122, 0
  v_mov_b32 v123, 0
  v_mov_b32 v124, 0
  v_mov_b32 v125, 0
  v_mov_b32 v126, 0
  v_mov_b32 v127, 0
  v_mov_b32 v128, 0
  v_mov_b32 v129, 0
  v_mov_b32 v130, 0
  v_mov_b32 v131, 0
  v_mov_b32 v132, 0
  v_mov_b32 v133, 0
  v_mov_b32 v134, 0
  v_mov_b32 v135, 0
  v_mov_b32 v136, 0
  v_mov_b32 v137, 0
  v_mov_b32 v138, 0
  v_mov_b32 v139, 0
  v_mov_b32 v140, 0
  v_mov_b32 v141, 0
  v_mov_b32 v142, 0
  v_mov_b32 v143, 0
  v_mov_b32 v144, 0
  v_mov_b32 v145, 0
  v_mov_b32 v146, 0
  v_mov_b32 v147, 0
  v_mov_b32 v148, 0
  v_mov_b32 v149, 0
  v_mov_b32 v150, 0
  v_mov_b32 v151, 0
  s_mov_b32 s31, 0
  s_mov_b32 s33, 0
  s_mov_b32 s52, 18432
  s_mov_b32 s50, 18432
  s_mov_b32 s53, 4294893568
  s_mov_b32 s54, 4294930432
  s_mov_b32 s30, 0
  s_waitcnt lgkmcnt(0)
  s_mov_b32 s16, s70
  s_and_b32 s17, s71, 0xffff
  s_mov_b32 s18, 268435456
  s_mov_b32 s19, 0x20000
  s_barrier
  s_cmp_eq_u32 s24, 0
  s_cbranch_scc1 L_cQ0
  s_cmp_eq_u32 s24, 1
  s_cbranch_scc1 L_cQ1
  s_cmp_eq_u32 s24, 2
  s_cbranch_scc1 L_cQ2
  s_branch L_cQ3
L_cQ0:
  ds_read_b128 v[192:195], v6 offset:0
  ds_read_b128 v[196:199], v6 offset:2048
  s_mov_b64 exec, s[42:43]
  ds_read_b128 v[200:203], v8 offset:0
  s_mov_b64 exec, -1
  ds_read_b64_tr_b16 v[152:153], v1 offset:0
  ds_read_b64_tr_b16 v[154:155], v1 offset:2304
  ds_read_b64_tr_b16 v[156:157], v2 offset:0
  ds_read_b64_tr_b16 v[158:159], v2 offset:2304
  ds_read_b64_tr_b16 v[160:161], v3 offset:0
  ds_read_b64_tr_b16 v[162:163], v3 offset:2304
  ds_read_b64_tr_b16 v[164:165], v4 offset:0
  ds_read_b64_tr_b16 v[166:167], v4 offset:2304
  ds_read_b64_tr_b16 v[168:169], v5 offset:0
  ds_read_b64_tr_b16 v[170:171], v5 offset:2304
L_cQ0_loop:
  s_waitcnt lgkmcnt(6)
  v_mfma_f32_16x16x32_bf16 v[16:19], v[152:155], v[192:195], v[16:19]
  ds_read_b64_tr_b16 v[172:173], v1 offset:192
  s_add_u32 s31, s31, 1
  v_mfma_f32_16x16x32_bf16 v[20:23], v[152:155], v[196:199], v[20:23]
  ds_read_b64_tr_b16 v[174:175], v1 offset:2496
  s_cmp_eq_u32 s31, 5
  v_mfma_f32_16x16x32_bf16 v[136:139], v[152:155], v[200:203], v[136:139]
  s_cselect_b32 s32, s53, s52
  s_cselect_b32 s31, 0, s31
  v_mfma_f32_16x16x32_bf16 v[24:27], v[156:159], v[192:195], v[24:27]
  ds_read_b64_tr_b16 v[176:177], v2 offset:192
  ds_read_b128 v[204:207], v7 offset:0
  v_mfma_f32_16x16x32_bf16 v[28:31], v[156:159], v[196:199], v[28:31]
  ds_read_b64_tr_b16 v[178:179], v2 offset:2496
  s_waitcnt lgkmcnt(7)
  v_mfma_f32_16x16x32_bf16 v[32:35], v[160:163], v[192:195], v[32:35]
  ds_read_b64_tr_b16 v[180:181], v3 offset:192
  ds_read_b128 v[208:211], v7 offset:2048
  v_mfma_f32_16x16x32_bf16 v[36:39], v[160:163], v[196:199], v[36:39]
  ds_read_b64_tr_b16 v[182:183], v3 offset:2496
  s_mov_b64 exec, s[42:43]
  ds_read_b128 v[212:215], v9 offset:0
  s_mov_b64 exec, -1
  v_mfma_f32_16x16x32_bf16 v[40:43], v[164:167], v[192:195], v[40:43]
  ds_read_b64_tr_b16 v[184:185], v4 offset:192
  v_mfma_f32_16x16x32_bf16 v[44:47], v[164:167], v[196:199], v[44:47]
  ds_read_b64_tr_b16 v[186:187], v4 offset:2496
  s_waitcnt lgkmcnt(9)
  v_mfma_f32_16x16x32_bf16 v[48:51], v[168:171], v[192:195], v[48:51]
  ds_read_b64_tr_b16 v[188:189], v5 offset:192
  v_mfma_f32_16x16x32_bf16 v[52:55], v[168:171], v[196:199], v[52:55]
  ds_read_b64_tr_b16 v[190:191], v5 offset:2496
  v_mfma_f32_16x16x32_bf16 v[148:151], v[168:171], v[200:203], v[148:151]
  v_mfma_f32_16x16x32_bf16 v[56:59], v[172:175], v[192:195], v[56:59]
  ds_read_b64_tr_b16 v[152:153], v1 offset:384
  v_mfma_f32_16x16x32_bf16 v[60:63], v[172:175], v[196:199], v[60:63]
  ds_read_b64_tr_b16 v[154:155], v1 offset:2688
  v_mfma_f32_16x16x32_bf16 v[140:143], v[172:175], v[200:203], v[140:143]
  s_waitcnt lgkmcnt(7)
  v_mfma_f32_16x16x32_bf16 v[64:67], v[176:179], v[192:195], v[64:67]
  ds_read_b64_tr_b16 v[156:157], v2 offset:384
  v_add_u32 v1, s32, v1
  v_mfma_f32_16x16x32_bf16 v[68:71], v[176:179], v[196:199], v[68:71]
  ds_read_b64_tr_b16 v[158:159], v2 offset:2688
  v_mfma_f32_16x16x32_bf16 v[72:75], v[180:183], v[192:195], v[72:75]
  ds_read_b64_tr_b16 v[160:161], v3 offset:384
  v_add_u32 v2, s32, v2
  v_mfma_f32_16x16x32_bf16 v[76:79], v[180:183], v[196:199], v[76:79]
  ds_read_b64_tr_b16 v[162:163], v3 offset:2688
  s_waitcnt lgkmcnt(6)
  v_mfma_f32_16x16x32_bf16 v[80:83], v[184:187], v[192:195], v[80:83]
  ds_read_b64_tr_b16 v[164:165], v4 offset:384
  v_add_u32 v3, s32, v3
  v_mfma_f32_16x16x32_bf16 v[84:87], v[184:187], v[196:199], v[84:87]
  ds_read_b64_tr_b16 v[166:167], v4 offset:2688
  v_mfma_f32_16x16x32_bf16 v[88:91], v[188:191], v[192:195], v[88:91]
  ds_read_b64_tr_b16 v[168:169], v5 offset:384
  v_add_u32 v4, s32, v4
  v_mfma_f32_16x16x32_bf16 v[92:95], v[188:191], v[196:199], v[92:95]
  ds_read_b64_tr_b16 v[170:171], v5 offset:2688
  s_waitcnt lgkmcnt(6)
  v_mfma_f32_16x16x32_bf16 v[96:99], v[192:195], v[152:155], v[96:99]
  ds_read_b64_tr_b16 v[172:173], v1 offset:0
  v_add_u32 v5, s32, v5
  v_mfma_f32_16x16x32_bf16 v[100:103], v[196:199], v[152:155], v[100:103]
  ds_read_b64_tr_b16 v[174:175], v1 offset:2304
  v_mfma_f32_16x16x32_bf16 v[144:147], v[200:203], v[152:155], v[144:147]
  v_mfma_f32_16x16x32_bf16 v[104:107], v[192:195], v[156:159], v[104:107]
  ds_read_b64_tr_b16 v[176:177], v2 offset:0
  v_mfma_f32_16x16x32_bf16 v[108:111], v[196:199], v[156:159], v[108:111]
  ds_read_b64_tr_b16 v[178:179], v2 offset:2304
  s_waitcnt lgkmcnt(6)
  v_mfma_f32_16x16x32_bf16 v[112:115], v[192:195], v[160:163], v[112:115]
  ds_read_b64_tr_b16 v[180:181], v3 offset:0
  v_mfma_f32_16x16x32_bf16 v[116:119], v[196:199], v[160:163], v[116:119]
  ds_read_b64_tr_b16 v[182:183], v3 offset:2304
  v_mfma_f32_16x16x32_bf16 v[120:123], v[192:195], v[164:167], v[120:123]
  ds_read_b64_tr_b16 v[184:185], v4 offset:0
  v_mfma_f32_16x16x32_bf16 v[124:127], v[196:199], v[164:167], v[124:127]
  ds_read_b64_tr_b16 v[186:187], v4 offset:2304
  s_waitcnt lgkmcnt(8)
  v_mfma_f32_16x16x32_bf16 v[128:131], v[192:195], v[168:171], v[128:131]
  ds_read_b64_tr_b16 v[188:189], v5 offset:0
  v_mfma_f32_16x16x32_bf16 v[132:135], v[196:199], v[168:171], v[132:135]
  ds_read_b64_tr_b16 v[190:191], v5 offset:2304
  s_barrier
  s_waitcnt lgkmcnt(6)
  v_mfma_f32_16x16x32_bf16 v[16:19], v[172:175], v[204:207], v[16:19]
  ds_read_b64_tr_b16 v[152:153], v1 offset:192
  s_add_u32 s33, s33, 1
  v_mfma_f32_16x16x32_bf16 v[20:23], v[172:175], v[208:211], v[20:23]
  ds_read_b64_tr_b16 v[154:155], v1 offset:2496
  s_cmp_eq_u32 s33, 3
  v_mfma_f32_16x16x32_bf16 v[136:139], v[172:175], v[212:215], v[136:139]
  s_cselect_b32 s34, s54, s50
  s_cselect_b32 s33, 0, s33
  v_mfma_f32_16x16x32_bf16 v[24:27], v[176:179], v[204:207], v[24:27]
  ds_read_b64_tr_b16 v[156:157], v2 offset:192
  s_add_u32 s31, s31, 1
  v_mfma_f32_16x16x32_bf16 v[28:31], v[176:179], v[208:211], v[28:31]
  ds_read_b64_tr_b16 v[158:159], v2 offset:2496
  s_waitcnt lgkmcnt(6)
  v_mfma_f32_16x16x32_bf16 v[32:35], v[180:183], v[204:207], v[32:35]
  ds_read_b64_tr_b16 v[160:161], v3 offset:192
  s_cmp_eq_u32 s31, 5
  v_mfma_f32_16x16x32_bf16 v[36:39], v[180:183], v[208:211], v[36:39]
  ds_read_b64_tr_b16 v[162:163], v3 offset:2496
  s_cselect_b32 s32, s53, s52
  v_mfma_f32_16x16x32_bf16 v[40:43], v[184:187], v[204:207], v[40:43]
  ds_read_b64_tr_b16 v[164:165], v4 offset:192
  s_cselect_b32 s31, 0, s31
  v_mfma_f32_16x16x32_bf16 v[44:47], v[184:187], v[208:211], v[44:47]
  ds_read_b64_tr_b16 v[166:167], v4 offset:2496
  s_waitcnt lgkmcnt(6)
  v_mfma_f32_16x16x32_bf16 v[48:51], v[188:191], v[204:207], v[48:51]
  ds_read_b64_tr_b16 v[168:169], v5 offset:192
  v_add_u32 v6, s34, v6
  v_mfma_f32_16x16x32_bf16 v[52:55], v[188:191], v[208:211], v[52:55]
  ds_read_b64_tr_b16 v[170:171], v5 offset:2496
  v_add_u32 v7, s34, v7
  v_mfma_f32_16x16x32_bf16 v[148:151], v[188:191], v[212:215], v[148:151]
  v_add_u32 v8, s34, v8
  v_add_u32 v9, s34, v9
  v_mfma_f32_16x16x32_bf16 v[56:59], v[152:155], v[204:207], v[56:59]
  ds_read_b64_tr_b16 v[172:173], v1 offset:384
  ds_read_b128 v[192:195], v6 offset:0
  v_mfma_f32_16x16x32_bf16 v[60:63], v[152:155], v[208:211], v[60:63]
  ds_read_b64_tr_b16 v[174:175], v1 offset:2688
  ds_read_b128 v[196:199], v6 offset:2048
  v_mfma_f32_16x16x32_bf16 v[140:143], v[152:155], v[212:215], v[140:143]
  s_mov_b64 exec, s[42:43]
  ds_read_b128 v[200:203], v8 offset:0
  s_mov_b64 exec, -1
  s_waitcnt lgkmcnt(9)
  v_mfma_f32_16x16x32_bf16 v[64:67], v[156:159], v[204:207], v[64:67]
  ds_read_b64_tr_b16 v[176:177], v2 offset:384
  v_add_u32 v1, s32, v1
  v_mfma_f32_16x16x32_bf16 v[68:71], v[156:159], v[208:211], v[68:71]
  ds_read_b64_tr_b16 v[178:179], v2 offset:2688
  v_mfma_f32_16x16x32_bf16 v[72:75], v[160:163], v[204:207], v[72:75]
  ds_read_b64_tr_b16 v[180:181], v3 offset:384
  v_add_u32 v2, s32, v2
  v_mfma_f32_16x16x32_bf16 v[76:79], v[160:163], v[208:211], v[76:79]
  ds_read_b64_tr_b16 v[182:183], v3 offset:2688
  s_waitcnt lgkmcnt(9)
  v_mfma_f32_16x16x32_bf16 v[80:83], v[164:167], v[204:207], v[80:83]
  ds_read_b64_tr_b16 v[184:185], v4 offset:384
  v_add_u32 v3, s32, v3
  v_mfma_f32_16x16x32_bf16 v[84:87], v[164:167], v[208:211], v[84:87]
  ds_read_b64_tr_b16 v[186:187], v4 offset:2688
  v_mfma_f32_16x16x32_bf16 v[88:91], v[168:171], v[204:207], v[88:91]
  ds_read_b64_tr_b16 v[188:189], v5 offset:384
  v_add_u32 v4, s32, v4
  v_mfma_f32_16x16x32_bf16 v[92:95], v[168:171], v[208:211], v[92:95]
  ds_read_b64_tr_b16 v[190:191], v5 offset:2688
  s_waitcnt lgkmcnt(6)
  v_mfma_f32_16x16x32_bf16 v[96:99], v[204:207], v[172:175], v[96:99]
  ds_read_b64_tr_b16 v[152:153], v1 offset:0
  v_add_u32 v5, s32, v5
  v_mfma_f32_16x16x32_bf16 v[100:103], v[208:211], v[172:175], v[100:103]
  ds_read_b64_tr_b16 v[154:155], v1 offset:2304
  v_mfma_f32_16x16x32_bf16 v[144:147], v[212:215], v[172:175], v[144:147]
  v_mfma_f32_16x16x32_bf16 v[104:107], v[204:207], v[176:179], v[104:107]
  ds_read_b64_tr_b16 v[156:157], v2 offset:0
  v_mfma_f32_16x16x32_bf16 v[108:111], v[208:211], v[176:179], v[108:111]
  ds_read_b64_tr_b16 v[158:159], v2 offset:2304
  s_waitcnt lgkmcnt(6)
  v_mfma_f32_16x16x32_bf16 v[112:115], v[204:207], v[180:183], v[112:115]
  ds_read_b64_tr_b16 v[160:161], v3 offset:0
  v_mfma_f32_16x16x32_bf16 v[116:119], v[208:211], v[180:183], v[116:119]
  ds_read_b64_tr_b16 v[162:163], v3 offset:2304
  v_mfma_f32_16x16x32_bf16 v[120:123], v[204:207], v[184:187], v[120:123]
  ds_read_b64_tr_b16 v[164:165], v4 offset:0
  v_mfma_f32_16x16x32_bf16 v[124:127], v[208:211], v[184:187], v[124:127]
  ds_read_b64_tr_b16 v[166:167], v4 offset:2304
  s_waitcnt lgkmcnt(8)
  v_mfma_f32_16x16x32_bf16 v[128:131], v[204:207], v[188:191], v[128:131]
  ds_read_b64_tr_b16 v[168:169], v5 offset:0
  v_mfma_f32_16x16x32_bf16 v[132:135], v[208:211], v[188:191], v[132:135]
  ds_read_b64_tr_b16 v[170:171], v5 offset:2304
  s_barrier
  s_add_u32 s30, s30, 1
  s_cmp_lt_u32 s30, 10
  s_cbranch_scc1 L_cQ0_loop
  s_branch L_epiQ
L_cQ1:
  ds_read_b128 v[192:195], v6 offset:0
  ds_read_b128 v[196:199], v6 offset:2048
  s_mov_b64 exec, s[42:43]
  ds_read_b128 v[200:203], v8 offset:0
  s_mov_b64 exec, -1
  ds_read_b64_tr_b16 v[152:153], v1 offset:0
  ds_read_b64_tr_b16 v[154:155], v1 offset:2304
  ds_read_b64_tr_b16 v[156:157], v2 offset:0
  ds_read_b64_tr_b16 v[158:159], v2 offset:2304
  ds_read_b64_tr_b16 v[160:161], v3 offset:0
  ds_read_b64_tr_b16 v[162:163], v3 offset:2304
  ds_read_b64_tr_b16 v[164:165], v4 offset:0
  ds_read_b64_tr_b16 v[166:167], v4 offset:2304
  ds_read_b64_tr_b16 v[168:169], v5 offset:0
  ds_read_b64_tr_b16 v[170:171], v5 offset:2304
L_cQ1_loop:
  s_waitcnt lgkmcnt(6)
  v_mfma_f32_16x16x32_bf16 v[16:19], v[152:155], v[192:195], v[16:19]
  ds_read_b64_tr_b16 v[172:173], v1 offset:192
  s_add_u32 s31, s31, 1
  v_mfma_f32_16x16x32_bf16 v[20:23], v[152:155], v[196:199], v[20:23]
  ds_read_b64_tr_b16 v[174:175], v1 offset:2496
  s_cmp_eq_u32 s31, 5
  v_mfma_f32_16x16x32_bf16 v[24:27], v[156:159], v[192:195], v[24:27]
  ds_read_b64_tr_b16 v[176:177], v2 offset:192
  s_cselect_b32 s32, s53, s52
  v_mfma_f32_16x16x32_bf16 v[28:31], v[156:159], v[196:199], v[28:31]
  ds_read_b64_tr_b16 v[178:179], v2 offset:2496
  s_cselect_b32 s31, 0, s31
  v_mfma_f32_16x16x32_bf16 v[136:139], v[156:159], v[200:203], v[136:139]
  ds_read_b128 v[204:207], v7 offset:0
  s_waitcnt lgkmcnt(7)
  v_mfma_f32_16x16x32_bf16 v[32:35], v[160:163], v[192:195], v[32:35]
  ds_read_b64_tr_b16 v[180:181], v3 offset:192
  ds_read_b128 v[208:211], v7 offset:2048
  v_mfma_f32_16x16x32_bf16 v[36:39], v[160:163], v[196:199], v[36:39]
  ds_read_b64_tr_b16 v[182:183], v3 offset:2496
  s_mov_b64 exec, s[42:43]
  ds_read_b128 v[212:215], v9 offset:0
  s_mov_b64 exec, -1
  v_mfma_f32_16x16x32_bf16 v[40:43], v[164:167], v[192:195], v[40:43]
  ds_read_b64_tr_b16 v[184:185], v4 offset:192
  v_mfma_f32_16x16x32_bf16 v[44:47], v[164:167], v[196:199], v[44:47]
  ds_read_b64_tr_b16 v[186:187], v4 offset:2496
  s_waitcnt lgkmcnt(9)
  v_mfma_f32_16x16x32_bf16 v[48:51], v[168:171], v[192:195], v[48:51]
  ds_read_b64_tr_b16 v[188:189], v5 offset:192
  v_mfma_f32_16x16x32_bf16 v[52:55], v[168:171], v[196:199], v[52:55]
  ds_read_b64_tr_b16 v[190:191], v5 offset:2496
  v_mfma_f32_16x16x32_bf16 v[56:59], v[172:175], v[192:195], v[56:59]
  ds_read_b64_tr_b16 v[152:153], v1 offset:384
  v_mfma_f32_16x16x32_bf16 v[60:63], v[172:175], v[196:199], v[60:63]
  ds_read_b64_tr_b16 v[154:155], v1 offset:2688
  s_waitcnt lgkmcnt(7)
  v_mfma_f32_16x16x32_bf16 v[64:67], v[176:179], v[192:195], v[64:67]
  ds_read_b64_tr_b16 v[156:157], v2 offset:384
  v_add_u32 v1, s32, v1
  v_mfma_f32_16x16x32_bf16 v[68:71], v[176:179], v[196:199], v[68:71]
  ds_read_b64_tr_b16 v[158:159], v2 offset:2688
  v_mfma_f32_16x16x32_bf16 v[140:143], v[176:179], v[200:203], v[140:143]
  v_mfma_f32_16x16x32_bf16 v[72:75], v[180:183], v[192:195], v[72:75]
  ds_read_b64_tr_b16 v[160:161], v3 offset:384
  v_add_u32 v2, s32, v2
  v_mfma_f32_16x16x32_bf16 v[76:79], v[180:183], v[196:199], v[76:79]
  ds_read_b64_tr_b16 v[162:163], v3 offset:2688
  s_waitcnt lgkmcnt(6)
  v_mfma_f32_16x16x32_bf16 v[80:83], v[184:187], v[192:195], v[80:83]
  ds_read_b64_tr_b16 v[164:165], v4 offset:384
  v_add_u32 v3, s32, v3
  v_mfma_f32_16x16x32_bf16 v[84:87], v[184:187], v[196:199], v[84:87]
  ds_read_b64_tr_b16 v[166:167], v4 offset:2688
  v_mfma_f32_16x16x32_bf16 v[88:91], v[188:191], v[192:195], v[88:91]
  ds_read_b64_tr_b16 v[168:169], v5 offset:384
  v_add_u32 v4, s32, v4
  v_mfma_f32_16x16x32_bf16 v[92:95], v[188:191], v[196:199], v[92:95]
  ds_read_b64_tr_b16 v[170:171], v5 offset:2688
  v_mfma_f32_16x16x32_bf16 v[148:151], v[188:191], v[200:203], v[148:151]
  s_waitcnt lgkmcnt(6)
  v_mfma_f32_16x16x32_bf16 v[96:99], v[192:195], v[152:155], v[96:99]
  ds_read_b64_tr_b16 v[172:173], v1 offset:0
  v_add_u32 v5, s32, v5
  v_mfma_f32_16x16x32_bf16 v[100:103], v[196:199], v[152:155], v[100:103]
  ds_read_b64_tr_b16 v[174:175], v1 offset:2304
  v_mfma_f32_16x16x32_bf16 v[104:107], v[192:195], v[156:159], v[104:107]
  ds_read_b64_tr_b16 v[176:177], v2 offset:0
  v_mfma_f32_16x16x32_bf16 v[108:111], v[196:199], v[156:159], v[108:111]
  ds_read_b64_tr_b16 v[178:179], v2 offset:2304
  v_mfma_f32_16x16x32_bf16 v[144:147], v[200:203], v[156:159], v[144:147]
  s_waitcnt lgkmcnt(6)
  v_mfma_f32_16x16x32_bf16 v[112:115], v[192:195], v[160:163], v[112:115]
  ds_read_b64_tr_b16 v[180:181], v3 offset:0
  v_mfma_f32_16x16x32_bf16 v[116:119], v[196:199], v[160:163], v[116:119]
  ds_read_b64_tr_b16 v[182:183], v3 offset:2304
  v_mfma_f32_16x16x32_bf16 v[120:123], v[192:195], v[164:167], v[120:123]
  ds_read_b64_tr_b16 v[184:185], v4 offset:0
  v_mfma_f32_16x16x32_bf16 v[124:127], v[196:199], v[164:167], v[124:127]
  ds_read_b64_tr_b16 v[186:187], v4 offset:2304
  s_waitcnt lgkmcnt(8)
  v_mfma_f32_16x16x32_bf16 v[128:131], v[192:195], v[168:171], v[128:131]
  ds_read_b64_tr_b16 v[188:189], v5 offset:0
  v_mfma_f32_16x16x32_bf16 v[132:135], v[196:199], v[168:171], v[132:135]
  ds_read_b64_tr_b16 v[190:191], v5 offset:2304
  s_barrier
  s_waitcnt lgkmcnt(6)
  v_mfma_f32_16x16x32_bf16 v[16:19], v[172:175], v[204:207], v[16:19]
  ds_read_b64_tr_b16 v[152:153], v1 offset:192
  s_add_u32 s33, s33, 1
  v_mfma_f32_16x16x32_bf16 v[20:23], v[172:175], v[208:211], v[20:23]
  ds_read_b64_tr_b16 v[154:155], v1 offset:2496
  s_cmp_eq_u32 s33, 3
  v_mfma_f32_16x16x32_bf16 v[24:27], v[176:179], v[204:207], v[24:27]
  ds_read_b64_tr_b16 v[156:157], v2 offset:192
  s_cselect_b32 s34, s54, s50
  v_mfma_f32_16x16x32_bf16 v[28:31], v[176:179], v[208:211], v[28:31]
  ds_read_b64_tr_b16 v[158:159], v2 offset:2496
  s_cselect_b32 s33, 0, s33
  v_mfma_f32_16x16x32_bf16 v[136:139], v[176:179], v[212:215], v[136:139]
  s_add_u32 s31, s31, 1
  s_waitcnt lgkmcnt(6)
  v_mfma_f32_16x16x32_bf16 v[32:35], v[180:183], v[204:207], v[32:35]
  ds_read_b64_tr_b16 v[160:161], v3 offset:192
  s_cmp_eq_u32 s31, 5
  v_mfma_f32_16x16x32_bf16 v[36:39], v[180:183], v[208:211], v[36:39]
  ds_read_b64_tr_b16 v[162:163], v3 offset:2496
  s_cselect_b32 s32, s53, s52
  v_mfma_f32_16x16x32_bf16 v[40:43], v[184:187], v[204:207], v[40:43]
  ds_read_b64_tr_b16 v[164:165], v4 offset:192
  s_cselect_b32 s31, 0, s31
  v_mfma_f32_16x16x32_bf16 v[44:47], v[184:187], v[208:211], v[44:47]
  ds_read_b64_tr_b16 v[166:167], v4 offset:2496
  s_waitcnt lgkmcnt(6)
  v_mfma_f32_16x16x32_bf16 v[48:51], v[188:191], v[204:207], v[48:51]
  ds_read_b64_tr_b16 v[168:169], v5 offset:192
  v_add_u32 v6, s34, v6
  v_mfma_f32_16x16x32_bf16 v[52:55], v[188:191], v[208:211], v[52:55]
  ds_read_b64_tr_b16 v[170:171], v5 offset:2496
  v_add_u32 v7, s34, v7
  v_mfma_f32_16x16x32_bf16 v[56:59], v[152:155], v[204:207], v[56:59]
  ds_read_b64_tr_b16 v[172:173], v1 offset:384
  v_add_u32 v8, s34, v8
  v_mfma_f32_16x16x32_bf16 v[60:63], v[152:155], v[208:211], v[60:63]
  ds_read_b64_tr_b16 v[174:175], v1 offset:2688
  s_waitcnt lgkmcnt(6)
  v_mfma_f32_16x16x32_bf16 v[64:67], v[156:159], v[204:207], v[64:67]
  ds_read_b64_tr_b16 v[176:177], v2 offset:384
  v_add_u32 v1, s32, v1
  v_mfma_f32_16x16x32_bf16 v[68:71], v[156:159], v[208:211], v[68:71]
  ds_read_b64_tr_b16 v[178:179], v2 offset:2688
  v_add_u32 v9, s34, v9
  v_mfma_f32_16x16x32_bf16 v[140:143], v[156:159], v[212:215], v[140:143]
  ds_read_b128 v[192:195], v6 offset:0
  ds_read_b128 v[196:199], v6 offset:2048
  v_mfma_f32_16x16x32_bf16 v[72:75], v[160:163], v[204:207], v[72:75]
  ds_read_b64_tr_b16 v[180:181], v3 offset:384
  v_add_u32 v2, s32, v2
  v_mfma_f32_16x16x32_bf16 v[76:79], v[160:163], v[208:211], v[76:79]
  ds_read_b64_tr_b16 v[182:183], v3 offset:2688
  s_waitcnt lgkmcnt(8)
  v_mfma_f32_16x16x32_bf16 v[80:83], v[164:167], v[204:207], v[80:83]
  ds_read_b64_tr_b16 v[184:185], v4 offset:384
  v_add_u32 v3, s32, v3
  v_mfma_f32_16x16x32_bf16 v[84:87], v[164:167], v[208:211], v[84:87]
  ds_read_b64_tr_b16 v[186:187], v4 offset:2688
  s_mov_b64 exec, s[42:43]
  ds_read_b128 v[200:203], v8 offset:0
  s_mov_b64 exec, -1
  v_mfma_f32_16x16x32_bf16 v[88:91], v[168:171], v[204:207], v[88:91]
  ds_read_b64_tr_b16 v[188:189], v5 offset:384
  v_add_u32 v4, s32, v4
  v_mfma_f32_16x16x32_bf16 v[92:95], v[168:171], v[208:211], v[92:95]
  ds_read_b64_tr_b16 v[190:191], v5 offset:2688
  v_mfma_f32_16x16x32_bf16 v[148:151], v[168:171], v[212:215], v[148:151]
  s_waitcnt lgkmcnt(9)
  v_mfma_f32_16x16x32_bf16 v[96:99], v[204:207], v[172:175], v[96:99]
  ds_read_b64_tr_b16 v[152:153], v1 offset:0
  v_add_u32 v5, s32, v5
  v_mfma_f32_16x16x32_bf16 v[100:103], v[208:211], v[172:175], v[100:103]
  ds_read_b64_tr_b16 v[154:155], v1 offset:2304
  v_mfma_f32_16x16x32_bf16 v[104:107], v[204:207], v[176:179], v[104:107]
  ds_read_b64_tr_b16 v[156:157], v2 offset:0
  v_mfma_f32_16x16x32_bf16 v[108:111], v[208:211], v[176:179], v[108:111]
  ds_read_b64_tr_b16 v[158:159], v2 offset:2304
  v_mfma_f32_16x16x32_bf16 v[144:147], v[212:215], v[176:179], v[144:147]
  s_waitcnt lgkmcnt(7)
  v_mfma_f32_16x16x32_bf16 v[112:115], v[204:207], v[180:183], v[112:115]
  ds_read_b64_tr_b16 v[160:161], v3 offset:0
  v_mfma_f32_16x16x32_bf16 v[116:119], v[208:211], v[180:183], v[116:119]
  ds_read_b64_tr_b16 v[162:163], v3 offset:2304
  v_mfma_f32_16x16x32_bf16 v[120:123], v[204:207], v[184:187], v[120:123]
  ds_read_b64_tr_b16 v[164:165], v4 offset:0
  v_mfma_f32_16x16x32_bf16 v[124:127], v[208:211], v[184:187], v[124:127]
  ds_read_b64_tr_b16 v[166:167], v4 offset:2304
  s_waitcnt lgkmcnt(8)
  v_mfma_f32_16x16x32_bf16 v[128:131], v[204:207], v[188:191], v[128:131]
  ds_read_b64_tr_b16 v[168:169], v5 offset:0
  v_mfma_f32_16x16x32_bf16 v[132:135], v[208:211], v[188:191], v[132:135]
  ds_read_b64_tr_b16 v[170:171], v5 offset:2304
  s_barrier
  s_add_u32 s30, s30, 1
  s_cmp_lt_u32 s30, 10
  s_cbranch_scc1 L_cQ1_loop
  s_branch L_epiQ
L_cQ2:
  ds_read_b128 v[192:195], v6 offset:0
  ds_read_b128 v[196:199], v6 offset:2048
  s_mov_b64 exec, s[42:43]
  ds_read_b128 v[200:203], v8 offset:0
  s_mov_b64 exec, -1
  ds_read_b64_tr_b16 v[152:153], v1 offset:0
  ds_read_b64_tr_b16 v[154:155], v1 offset:2304
  ds_read_b64_tr_b16 v[156:157], v2 offset:0
  ds_read_b64_tr_b16 v[158:159], v2 offset:2304
  ds_read_b64_tr_b16 v[160:161], v3 offset:0
  ds_read_b64_tr_b16 v[162:163], v3 offset:2304
  ds_read_b64_tr_b16 v[164:165], v4 offset:0
  ds_read_b64_tr_b16 v[166:167], v4 offset:2304
  ds_read_b64_tr_b16 v[168:169], v5 offset:0
  ds_read_b64_tr_b16 v[170:171], v5 offset:2304
L_cQ2_loop:
  s_waitcnt lgkmcnt(6)
  v_mfma_f32_16x16x32_bf16 v[16:19], v[152:155], v[192:195], v[16:19]
  ds_read_b64_tr_b16 v[172:173], v1 offset:192
  s_add_u32 s31, s31, 1
  v_mfma_f32_16x16x32_bf16 v[20:23], v[152:155], v[196:199], v[20:23]
  ds_read_b64_tr_b16 v[174:175], v1 offset:2496
  s_cmp_eq_u32 s31, 5
  v_mfma_f32_16x16x32_bf16 v[24:27], v[156:159], v[192:195], v[24:27]
  ds_read_b64_tr_b16 v[176:177], v2 offset:192
  s_cselect_b32 s32, s53, s52
  v_mfma_f32_16x16x32_bf16 v[28:31], v[156:159], v[196:199], v[28:31]
  ds_read_b64_tr_b16 v[178:179], v2 offset:2496
  s_waitcnt lgkmcnt(6)
  v_mfma_f32_16x16x32_bf16 v[32:35], v[160:163], v[192:195], v[32:35]
  ds_read_b64_tr_b16 v[180:181], v3 offset:192
  s_cselect_b32 s31, 0, s31
  v_mfma_f32_16x16x32_bf16 v[36:39], v[160:163], v[196:199], v[36:39]
  ds_read_b64_tr_b16 v[182:183], v3 offset:2496
  ds_read_b128 v[204:207], v7 offset:0
  v_mfma_f32_16x16x32_bf16 v[136:139], v[160:163], v[200:203], v[136:139]
  ds_read_b128 v[208:211], v7 offset:2048
  s_mov_b64 exec, s[42:43]
  ds_read_b128 v[212:215], v9 offset:0
  s_mov_b64 exec, -1
  v_mfma_f32_16x16x32_bf16 v[40:43], v[164:167], v[192:195], v[40:43]
  ds_read_b64_tr_b16 v[184:185], v4 offset:192
  v_mfma_f32_16x16x32_bf16 v[44:47], v[164:167], v[196:199], v[44:47]
  ds_read_b64_tr_b16 v[186:187], v4 offset:2496
  s_waitcnt lgkmcnt(9)
  v_mfma_f32_16x16x32_bf16 v[48:51], v[168:171], v[192:195], v[48:51]
  ds_read_b64_tr_b16 v[188:189], v5 offset:192
  v_mfma_f32_16x16x32_bf16 v[52:55], v[168:171], v[196:199], v[52:55]
  ds_read_b64_tr_b16 v[190:191], v5 offset:2496
  v_mfma_f32_16x16x32_bf16 v[56:59], v[172:175], v[192:195], v[56:59]
  ds_read_b64_tr_b16 v[152:153], v1 offset:384
  v_mfma_f32_16x16x32_bf16 v[60:63], v[172:175], v[196:199], v[60:63]
  ds_read_b64_tr_b16 v[154:155], v1 offset:2688
  s_waitcnt lgkmcnt(9)
  v_mfma_f32_16x16x32_bf16 v[64:67], v[176:179], v[192:195], v[64:67]
  ds_read_b64_tr_b16 v[156:157], v2 offset:384
  v_add_u32 v1, s32, v1
  v_mfma_f32_16x16x32_bf16 v[68:71], v[176:179], v[196:199], v[68:71]
  ds_read_b64_tr_b16 v[158:159], v2 offset:2688
  v_mfma_f32_16x16x32_bf16 v[72:75], v[180:183], v[192:195], v[72:75]
  ds_read_b64_tr_b16 v[160:161], v3 offset:384
  v_add_u32 v2, s32, v2
  v_mfma_f32_16x16x32_bf16 v[76:79], v[180:183], v[196:199], v[76:79]
  ds_read_b64_tr_b16 v[162:163], v3 offset:2688
  v_mfma_f32_16x16x32_bf16 v[140:143], v[180:183], v[200:203], v[140:143]
  s_waitcnt lgkmcnt(6)
  v_mfma_f32_16x16x32_bf16 v[80:83], v[184:187], v[192:195], v[80:83]
  ds_read_b64_tr_b16 v[164:165], v4 offset:384
  v_add_u32 v3, s32, v3
  v_mfma_f32_16x16x32_bf16 v[84:87], v[184:187], v[196:199], v[84:87]
  ds_read_b64_tr_b16 v[166:167], v4 offset:2688
  v_mfma_f32_16x16x32_bf16 v[88:91], v[188:191], v[192:195], v[88:91]
  ds_read_b64_tr_b16 v[168:169], v5 offset:384
  v_add_u32 v4, s32, v4
  v_mfma_f32_16x16x32_bf16 v[92:95], v[188:191], v[196:199], v[92:95]
  ds_read_b64_tr_b16 v[170:171], v5 offset:2688
  s_waitcnt lgkmcnt(6)
  v_mfma_f32_16x16x32_bf16 v[96:99], v[192:195], v[152:155], v[96:99]
  ds_read_b64_tr_b16 v[172:173], v1 offset:0
  v_add_u32 v5, s32, v5
  v_mfma_f32_16x16x32_bf16 v[100:103], v[196:199], v[152:155], v[100:103]
  ds_read_b64_tr_b16 v[174:175], v1 offset:2304
  v_mfma_f32_16x16x32_bf16 v[104:107], v[192:195], v[156:159], v[104:107]
  ds_read_b64_tr_b16 v[176:177], v2 offset:0
  v_mfma_f32_16x16x32_bf16 v[108:111], v[196:199], v[156:159], v[108:111]
  ds_read_b64_tr_b16 v[178:179], v2 offset:2304
  s_waitcnt lgkmcnt(6)
  v_mfma_f32_16x16x32_bf16 v[112:115], v[192:195], v[160:163], v[112:115]
  ds_read_b64_tr_b16 v[180:181], v3 offset:0
  v_mfma_f32_16x16x32_bf16 v[116:119], v[196:199], v[160:163], v[116:119]
  ds_read_b64_tr_b16 v[182:183], v3 offset:2304
  v_mfma_f32_16x16x32_bf16 v[144:147], v[200:203], v[160:163], v[144:147]
  v_mfma_f32_16x16x32_bf16 v[120:123], v[192:195], v[164:167], v[120:123]
  ds_read_b64_tr_b16 v[184:185], v4 offset:0
  v_mfma_f32_16x16x32_bf16 v[124:127], v[196:199], v[164:167], v[124:127]
  ds_read_b64_tr_b16 v[186:187], v4 offset:2304
  s_waitcnt lgkmcnt(8)
  v_mfma_f32_16x16x32_bf16 v[128:131], v[192:195], v[168:171], v[128:131]
  ds_read_b64_tr_b16 v[188:189], v5 offset:0
  v_mfma_f32_16x16x32_bf16 v[132:135], v[196:199], v[168:171], v[132:135]
  ds_read_b64_tr_b16 v[190:191], v5 offset:2304
  v_mfma_f32_16x16x32_bf16 v[148:151], v[200:203], v[168:171], v[148:151]
  s_barrier
  s_waitcnt lgkmcnt(6)
  v_mfma_f32_16x16x32_bf16 v[16:19], v[172:175], v[204:207], v[16:19]
  ds_read_b64_tr_b16 v[152:153], v1 offset:192
  s_add_u32 s33, s33, 1
  v_mfma_f32_16x16x32_bf16 v[20:23], v[172:175], v[208:211], v[20:23]
  ds_read_b64_tr_b16 v[154:155], v1 offset:2496
  s_cmp_eq_u32 s33, 3
  v_mfma_f32_16x16x32_bf16 v[24:27], v[176:179], v[204:207], v[24:27]
  ds_read_b64_tr_b16 v[156:157], v2 offset:192
  s_cselect_b32 s34, s54, s50
  v_mfma_f32_16x16x32_bf16 v[28:31], v[176:179], v[208:211], v[28:31]
  ds_read_b64_tr_b16 v[158:159], v2 offset:2496
  s_waitcnt lgkmcnt(6)
  v_mfma_f32_16x16x32_bf16 v[32:35], v[180:183], v[204:207], v[32:35]
  ds_read_b64_tr_b16 v[160:161], v3 offset:192
  s_cselect_b32 s33, 0, s33
  v_mfma_f32_16x16x32_bf16 v[36:39], v[180:183], v[208:211], v[36:39]
  ds_read_b64_tr_b16 v[162:163], v3 offset:2496
  s_add_u32 s31, s31, 1
  v_mfma_f32_16x16x32_bf16 v[136:139], v[180:183], v[212:215], v[136:139]
  s_cmp_eq_u32 s31, 5
  s_cselect_b32 s32, s53, s52
  v_mfma_f32_16x16x32_bf16 v[40:43], v[184:187], v[204:207], v[40:43]
  ds_read_b64_tr_b16 v[164:165], v4 offset:192
  s_cselect_b32 s31, 0, s31
  v_mfma_f32_16x16x32_bf16 v[44:47], v[184:187], v[208:211], v[44:47]
  ds_read_b64_tr_b16 v[166:167], v4 offset:2496
  s_waitcnt lgkmcnt(6)
  v_mfma_f32_16x16x32_bf16 v[48:51], v[188:191], v[204:207], v[48:51]
  ds_read_b64_tr_b16 v[168:169], v5 offset:192
  v_add_u32 v6, s34, v6
  v_mfma_f32_16x16x32_bf16 v[52:55], v[188:191], v[208:211], v[52:55]
  ds_read_b64_tr_b16 v[170:171], v5 offset:2496
  v_add_u32 v7, s34, v7
  v_mfma_f32_16x16x32_bf16 v[56:59], v[152:155], v[204:207], v[56:59]
  ds_read_b64_tr_b16 v[172:173], v1 offset:384
  v_add_u32 v8, s34, v8
  v_mfma_f32_16x16x32_bf16 v[60:63], v[152:155], v[208:211], v[60:63]
  ds_read_b64_tr_b16 v[174:175], v1 offset:2688
  s_waitcnt lgkmcnt(6)
  v_mfma_f32_16x16x32_bf16 v[64:67], v[156:159], v[204:207], v[64:67]
  ds_read_b64_tr_b16 v[176:177], v2 offset:384
  v_add_u32 v1, s32, v1
  v_mfma_f32_16x16x32_bf16 v[68:71], v[156:159], v[208:211], v[68:71]
  ds_read_b64_tr_b16 v[178:179], v2 offset:2688
  v_add_u32 v9, s34, v9
  v_mfma_f32_16x16x32_bf16 v[72:75], v[160:163], v[204:207], v[72:75]
  ds_read_b64_tr_b16 v[180:181], v3 offset:384
  v_add_u32 v2, s32, v2
  v_mfma_f32_16x16x32_bf16 v[76:79], v[160:163], v[208:211], v[76:79]
  ds_read_b64_tr_b16 v[182:183], v3 offset:2688
  ds_read_b128 v[192:195], v6 offset:0
  v_mfma_f32_16x16x32_bf16 v[140:143], v[160:163], v[212:215], v[140:143]
  ds_read_b128 v[196:199], v6 offset:2048
  s_waitcnt lgkmcnt(8)
  v_mfma_f32_16x16x32_bf16 v[80:83], v[164:167], v[204:207], v[80:83]
  ds_read_b64_tr_b16 v[184:185], v4 offset:384
  v_add_u32 v3, s32, v3
  v_mfma_f32_16x16x32_bf16 v[84:87], v[164:167], v[208:211], v[84:87]
  ds_read_b64_tr_b16 v[186:187], v4 offset:2688
  s_mov_b64 exec, s[42:43]
  ds_read_b128 v[200:203], v8 offset:0
  s_mov_b64 exec, -1
  v_mfma_f32_16x16x32_bf16 v[88:91], v[168:171], v[204:207], v[88:91]
  ds_read_b64_tr_b16 v[188:189], v5 offset:384
  v_add_u32 v4, s32, v4
  v_mfma_f32_16x16x32_bf16 v[92:95], v[168:171], v[208:211], v[92:95]
  ds_read_b64_tr_b16 v[190:191], v5 offset:2688
  s_waitcnt lgkmcnt(9)
  v_mfma_f32_16x16x32_bf16 v[96:99], v[204:207], v[172:175], v[96:99]
  ds_read_b64_tr_b16 v[152:153], v1 offset:0
  v_add_u32 v5, s32, v5
  v_mfma_f32_16x16x32_bf16 v[100:103], v[208:211], v[172:175], v[100:103]
  ds_read_b64_tr_b16 v[154:155], v1 offset:2304
  v_mfma_f32_16x16x32_bf16 v[104:107], v[204:207], v[176:179], v[104:107]
  ds_read_b64_tr_b16 v[156:157], v2 offset:0
  v_mfma_f32_16x16x32_bf16 v[108:111], v[208:211], v[176:179], v[108:111]
  ds_read_b64_tr_b16 v[158:159], v2 offset:2304
  s_waitcnt lgkmcnt(7)
  v_mfma_f32_16x16x32_bf16 v[112:115], v[204:207], v[180:183], v[112:115]
  ds_read_b64_tr_b16 v[160:161], v3 offset:0
  v_mfma_f32_16x16x32_bf16 v[116:119], v[208:211], v[180:183], v[116:119]
  ds_read_b64_tr_b16 v[162:163], v3 offset:2304
  v_mfma_f32_16x16x32_bf16 v[144:147], v[212:215], v[180:183], v[144:147]
  v_mfma_f32_16x16x32_bf16 v[120:123], v[204:207], v[184:187], v[120:123]
  ds_read_b64_tr_b16 v[164:165], v4 offset:0
  v_mfma_f32_16x16x32_bf16 v[124:127], v[208:211], v[184:187], v[124:127]
  ds_read_b64_tr_b16 v[166:167], v4 offset:2304
  s_waitcnt lgkmcnt(8)
  v_mfma_f32_16x16x32_bf16 v[128:131], v[204:207], v[188:191], v[128:131]
  ds_read_b64_tr_b16 v[168:169], v5 offset:0
  v_mfma_f32_16x16x32_bf16 v[132:135], v[208:211], v[188:191], v[132:135]
  ds_read_b64_tr_b16 v[170:171], v5 offset:2304
  v_mfma_f32_16x16x32_bf16 v[148:151], v[212:215], v[188:191], v[148:151]
  s_barrier
  s_add_u32 s30, s30, 1
  s_cmp_lt_u32 s30, 10
  s_cbranch_scc1 L_cQ2_loop
  s_branch L_epiQ
L_cQ3:
  ds_read_b128 v[192:195], v6 offset:0
  ds_read_b128 v[196:199], v6 offset:2048
  s_mov_b64 exec, s[42:43]
  ds_read_b128 v[200:203], v8 offset:0
  s_mov_b64 exec, -1
  ds_read_b64_tr_b16 v[152:153], v1 offset:0
  ds_read_b64_tr_b16 v[154:155], v1 offset:2304
  ds_read_b64_tr_b16 v[156:157], v2 offset:0
  ds_read_b64_tr_b16 v[158:159], v2 offset:2304
  ds_read_b64_tr_b16 v[160:161], v3 offset:0
  ds_read_b64_tr_b16 v[162:163], v3 offset:2304
  ds_read_b64_tr_b16 v[164:165], v4 offset:0
  ds_read_b64_tr_b16 v[166:167], v4 offset:2304
  ds_read_b64_tr_b16 v[168:169], v5 offset:0
  ds_read_b64_tr_b16 v[170:171], v5 offset:2304
L_cQ3_loop:
  s_waitcnt lgkmcnt(6)
  v_mfma_f32_16x16x32_bf16 v[16:19], v[152:155], v[192:195], v[16:19]
  ds_read_b64_tr_b16 v[172:173], v1 offset:192
  s_add_u32 s31, s31, 1
  v_mfma_f32_16x16x32_bf16 v[20:23], v[152:155], v[196:199], v[20:23]
  ds_read_b64_tr_b16 v[174:175], v1 offset:2496
  s_cmp_eq_u32 s31, 5
  v_mfma_f32_16x16x32_bf16 v[24:27], v[156:159], v[192:195], v[24:27]
  ds_read_b64_tr_b16 v[176:177], v2 offset:192
  s_cselect_b32 s32, s53, s52
  v_mfma_f32_16x16x32_bf16 v[28:31], v[156:159], v[196:199], v[28:31]
  ds_read_b64_tr_b16 v[178:179], v2 offset:2496
  s_waitcnt lgkmcnt(6)
  v_mfma_f32_16x16x32_bf16 v[32:35], v[160:163], v[192:195], v[32:35]
  ds_read_b64_tr_b16 v[180:181], v3 offset:192
  s_cselect_b32 s31, 0, s31
  v_mfma_f32_16x16x32_bf16 v[36:39], v[160:163], v[196:199], v[36:39]
  ds_read_b64_tr_b16 v[182:183], v3 offset:2496
  ds_read_b128 v[204:207], v7 offset:0
  v_mfma_f32_16x16x32_bf16 v[40:43], v[164:167], v[192:195], v[40:43]
  ds_read_b64_tr_b16 v[184:185], v4 offset:192
  ds_read_b128 v[208:211], v7 offset:2048
  v_mfma_f32_16x16x32_bf16 v[44:47], v[164:167], v[196:199], v[44:47]
  ds_read_b64_tr_b16 v[186:187], v4 offset:2496
  s_mov_b64 exec, s[42:43]
  ds_read_b128 v[212:215], v9 offset:0
  s_mov_b64 exec, -1
  v_mfma_f32_16x16x32_bf16 v[136:139], v[164:167], v[200:203], v[136:139]
  s_waitcnt lgkmcnt(9)
  v_mfma_f32_16x16x32_bf16 v[48:51], v[168:171], v[192:195], v[48:51]
  ds_read_b64_tr_b16 v[188:189], v5 offset:192
  v_mfma_f32_16x16x32_bf16 v[52:55], v[168:171], v[196:199], v[52:55]
  ds_read_b64_tr_b16 v[190:191], v5 offset:2496
  v_mfma_f32_16x16x32_bf16 v[56:59], v[172:175], v[192:195], v[56:59]
  ds_read_b64_tr_b16 v[152:153], v1 offset:384
  v_mfma_f32_16x16x32_bf16 v[60:63], v[172:175], v[196:199], v[60:63]
  ds_read_b64_tr_b16 v[154:155], v1 offset:2688
  s_waitcnt lgkmcnt(9)
  v_mfma_f32_16x16x32_bf16 v[64:67], v[176:179], v[192:195], v[64:67]
  ds_read_b64_tr_b16 v[156:157], v2 offset:384
  v_add_u32 v1, s32, v1
  v_mfma_f32_16x16x32_bf16 v[68:71], v[176:179], v[196:199], v[68:71]
  ds_read_b64_tr_b16 v[158:159], v2 offset:2688
  v_mfma_f32_16x16x32_bf16 v[72:75], v[180:183], v[192:195], v[72:75]
  ds_read_b64_tr_b16 v[160:161], v3 offset:384
  v_add_u32 v2, s32, v2
  v_mfma_f32_16x16x32_bf16 v[76:79], v[180:183], v[196:199], v[76:79]
  ds_read_b64_tr_b16 v[162:163], v3 offset:2688
  s_waitcnt lgkmcnt(6)
  v_mfma_f32_16x16x32_bf16 v[80:83], v[184:187], v[192:195], v[80:83]
  ds_read_b64_tr_b16 v[164:165], v4 offset:384
  v_add_u32 v3, s32, v3
  v_mfma_f32_16x16x32_bf16 v[84:87], v[184:187], v[196:199], v[84:87]
  ds_read_b64_tr_b16 v[166:167], v4 offset:2688
  v_mfma_f32_16x16x32_bf16 v[140:143], v[184:187], v[200:203], v[140:143]
  v_mfma_f32_16x16x32_bf16 v[88:91], v[188:191], v[192:195], v[88:91]
  ds_read_b64_tr_b16 v[168:169], v5 offset:384
  v_add_u32 v4, s32, v4
  v_mfma_f32_16x16x32_bf16 v[92:95], v[188:191], v[196:199], v[92:95]
  ds_read_b64_tr_b16 v[170:171], v5 offset:2688
  s_waitcnt lgkmcnt(6)
  v_mfma_f32_16x16x32_bf16 v[96:99], v[192:195], v[152:155], v[96:99]
  ds_read_b64_tr_b16 v[172:173], v1 offset:0
  v_add_u32 v5, s32, v5
  v_mfma_f32_16x16x32_bf16 v[100:103], v[196:199], v[152:155], v[100:103]
  ds_read_b64_tr_b16 v[174:175], v1 offset:2304
  v_mfma_f32_16x16x32_bf16 v[104:107], v[192:195], v[156:159], v[104:107]
  ds_read_b64_tr_b16 v[176:177], v2 offset:0
  v_mfma_f32_16x16x32_bf16 v[108:111], v[196:199], v[156:159], v[108:111]
  ds_read_b64_tr_b16 v[178:179], v2 offset:2304
  s_waitcnt lgkmcnt(6)
  v_mfma_f32_16x16x32_bf16 v[112:115], v[192:195], v[160:163], v[112:115]
  ds_read_b64_tr_b16 v[180:181], v3 offset:0
  v_mfma_f32_16x16x32_bf16 v[116:119], v[196:199], v[160:163], v[116:119]
  ds_read_b64_tr_b16 v[182:183], v3 offset:2304
  v_mfma_f32_16x16x32_bf16 v[120:123], v[192:195], v[164:167], v[120:123]
  ds_read_b64_tr_b16 v[184:185], v4 offset:0
  v_mfma_f32_16x16x32_bf16 v[124:127], v[196:199], v[164:167], v[124:127]
  ds_read_b64_tr_b16 v[186:187], v4 offset:2304
  v_mfma_f32_16x16x32_bf16 v[144:147], v[200:203], v[164:167], v[144:147]
  s_waitcnt lgkmcnt(8)
  v_mfma_f32_16x16x32_bf16 v[128:131], v[192:195], v[168:171], v[128:131]
  ds_read_b64_tr_b16 v[188:189], v5 offset:0
  v_mfma_f32_16x16x32_bf16 v[132:135], v[196:199], v[168:171], v[132:135]
  ds_read_b64_tr_b16 v[190:191], v5 offset:2304
  s_barrier
  s_waitcnt lgkmcnt(6)
  v_mfma_f32_16x16x32_bf16 v[16:19], v[172:175], v[204:207], v[16:19]
  ds_read_b64_tr_b16 v[152:153], v1 offset:192
  s_add_u32 s33, s33, 1
  v_mfma_f32_16x16x32_bf16 v[20:23], v[172:175], v[208:211], v[20:23]
  ds_read_b64_tr_b16 v[154:155], v1 offset:2496
  s_cmp_eq_u32 s33, 3
  v_mfma_f32_16x16x32_bf16 v[24:27], v[176:179], v[204:207], v[24:27]
  ds_read_b64_tr_b16 v[156:157], v2 offset:192
  s_cselect_b32 s34, s54, s50
  v_mfma_f32_16x16x32_bf16 v[28:31], v[176:179], v[208:211], v[28:31]
  ds_read_b64_tr_b16 v[158:159], v2 offset:2496
  s_waitcnt lgkmcnt(6)
  v_mfma_f32_16x16x32_bf16 v[32:35], v[180:183], v[204:207], v[32:35]
  ds_read_b64_tr_b16 v[160:161], v3 offset:192
  s_cselect_b32 s33, 0, s33
  v_mfma_f32_16x16x32_bf16 v[36:39], v[180:183], v[208:211], v[36:39]
  ds_read_b64_tr_b16 v[162:163], v3 offset:2496
  s_add_u32 s31, s31, 1
  v_mfma_f32_16x16x32_bf16 v[40:43], v[184:187], v[204:207], v[40:43]
  ds_read_b64_tr_b16 v[164:165], v4 offset:192
  s_cmp_eq_u32 s31, 5
  v_mfma_f32_16x16x32_bf16 v[44:47], v[184:187], v[208:211], v[44:47]
  ds_read_b64_tr_b16 v[166:167], v4 offset:2496
  s_cselect_b32 s32, s53, s52
  v_mfma_f32_16x16x32_bf16 v[136:139], v[184:187], v[212:215], v[136:139]
  s_cselect_b32 s31, 0, s31
  s_waitcnt lgkmcnt(6)
  v_mfma_f32_16x16x32_bf16 v[48:51], v[188:191], v[204:207], v[48:51]
  ds_read_b64_tr_b16 v[168:169], v5 offset:192
  v_add_u32 v6, s34, v6
  v_mfma_f32_16x16x32_bf16 v[52:55], v[188:191], v[208:211], v[52:55]
  ds_read_b64_tr_b16 v[170:171], v5 offset:2496
  v_add_u32 v7, s34, v7
  v_mfma_f32_16x16x32_bf16 v[56:59], v[152:155], v[204:207], v[56:59]
  ds_read_b64_tr_b16 v[172:173], v1 offset:384
  v_add_u32 v8, s34, v8
  v_mfma_f32_16x16x32_bf16 v[60:63], v[152:155], v[208:211], v[60:63]
  ds_read_b64_tr_b16 v[174:175], v1 offset:2688
  s_waitcnt lgkmcnt(6)
  v_mfma_f32_16x16x32_bf16 v[64:67], v[156:159], v[204:207], v[64:67]
  ds_read_b64_tr_b16 v[176:177], v2 offset:384
  v_add_u32 v1, s32, v1
  v_mfma_f32_16x16x32_bf16 v[68:71], v[156:159], v[208:211], v[68:71]
  ds_read_b64_tr_b16 v[178:179], v2 offset:2688
  v_add_u32 v9, s34, v9
  v_mfma_f32_16x16x32_bf16 v[72:75], v[160:163], v[204:207], v[72:75]
  ds_read_b64_tr_b16 v[180:181], v3 offset:384
  v_add_u32 v2, s32, v2
  v_mfma_f32_16x16x32_bf16 v[76:79], v[160:163], v[208:211], v[76:79]
  ds_read_b64_tr_b16 v[182:183], v3 offset:2688
  s_waitcnt lgkmcnt(6)
  v_mfma_f32_16x16x32_bf16 v[80:83], v[164:167], v[204:207], v[80:83]
  ds_read_b64_tr_b16 v[184:185], v4 offset:384
  v_add_u32 v3, s32, v3
  v_mfma_f32_16x16x32_bf16 v[84:87], v[164:167], v[208:211], v[84:87]
  ds_read_b64_tr_b16 v[186:187], v4 offset:2688
  ds_read_b128 v[192:195], v6 offset:0
  v_mfma_f32_16x16x32_bf16 v[140:143], v[164:167], v[212:215], v[140:143]
  ds_read_b128 v[196:199], v6 offset:2048
  s_mov_b64 exec, s[42:43]
  ds_read_b128 v[200:203], v8 offset:0
  s_mov_b64 exec, -1
  v_mfma_f32_16x16x32_bf16 v[88:91], v[168:171], v[204:207], v[88:91]
  ds_read_b64_tr_b16 v[188:189], v5 offset:384
  v_add_u32 v4, s32, v4
  v_mfma_f32_16x16x32_bf16 v[92:95], v[168:171], v[208:211], v[92:95]
  ds_read_b64_tr_b16 v[190:191], v5 offset:2688
  s_waitcnt lgkmcnt(9)
  v_mfma_f32_16x16x32_bf16 v[96:99], v[204:207], v[172:175], v[96:99]
  ds_read_b64_tr_b16 v[152:153], v1 offset:0
  v_add_u32 v5, s32, v5
  v_mfma_f32_16x16x32_bf16 v[100:103], v[208:211], v[172:175], v[100:103]
  ds_read_b64_tr_b16 v[154:155], v1 offset:2304
  v_mfma_f32_16x16x32_bf16 v[104:107], v[204:207], v[176:179], v[104:107]
  ds_read_b64_tr_b16 v[156:157], v2 offset:0
  v_mfma_f32_16x16x32_bf16 v[108:111], v[208:211], v[176:179], v[108:111]
  ds_read_b64_tr_b16 v[158:159], v2 offset:2304
  s_waitcnt lgkmcnt(9)
  v_mfma_f32_16x16x32_bf16 v[112:115], v[204:207], v[180:183], v[112:115]
  ds_read_b64_tr_b16 v[160:161], v3 offset:0
  v_mfma_f32_16x16x32_bf16 v[116:119], v[208:211], v[180:183], v[116:119]
  ds_read_b64_tr_b16 v[162:163], v3 offset:2304
  v_mfma_f32_16x16x32_bf16 v[120:123], v[204:207], v[184:187], v[120:123]
  ds_read_b64_tr_b16 v[164:165], v4 offset:0
  v_mfma_f32_16x16x32_bf16 v[124:127], v[208:211], v[184:187], v[124:127]
  ds_read_b64_tr_b16 v[166:167], v4 offset:2304
  v_mfma_f32_16x16x32_bf16 v[144:147], v[212:215], v[184:187], v[144:147]
  s_waitcnt lgkmcnt(8)
  v_mfma_f32_16x16x32_bf16 v[128:131], v[204:207], v[188:191], v[128:131]
  ds_read_b64_tr_b16 v[168:169], v5 offset:0
  v_mfma_f32_16x16x32_bf16 v[132:135], v[208:211], v[188:191], v[132:135]
  ds_read_b64_tr_b16 v[170:171], v5 offset:2304
  s_barrier
  s_add_u32 s30, s30, 1
  s_cmp_lt_u32 s30, 10
  s_cbranch_scc1 L_cQ3_loop
  s_branch L_epiQ
L_epiQ:
  v_lshrrev_b32 v2, 4, v0
  v_and_b32 v3, 15, v0
  v_lshlrev_b32 v4, 4, v2
  v_lshlrev_b32 v5, 2, v3
  v_lshlrev_b32 v6, 3, v0
  v_add_u32 v6, 92160, v6
  s_lshl_b32 s27, s24, 7
  s_add_u32 s27, s27, 147520
  v_add_u32 v14, s27, v5
  v_add_u32 v15, s27, v4
  v_add_u32 v10, 147456, v5
  v_add_u32 v11, 147456, v4
  v_add_u32 v4, 148992, v4
  v_add_u32 v5, 148992, v5
  s_lshl_b32 s28, s24, 6
  v_add_u32 v12, s28, v4
  v_add_u32 v13, s28, v5
  s_mul_i32 s29, s24, 320
  v_add_u32 v8, s29, v4
  s_not_b64 s[42:43], s[42:43]
  s_mov_b32 s68, 0xfff0ffff
  s_mov_b32 s69, 0xf000ff00
  s_mov_b32 s70, 0xffc0fffc
  s_mov_b32 s71, 0xc000fc00
  s_cmp_lt_u32 s24, 2
  s_cselect_b64 s[74:75], s[42:43], 0
  s_cmp_eq_u32 s24, 2
  s_cselect_b64 s[72:73], -1, 0
  s_and_b64 s[76:77], s[72:73], 0xffff
  s_waitcnt lgkmcnt(0)
  s_mov_b64 exec, s[42:43]
  ds_write_b128 v12, v[136:139] offset:0
  ds_write_b128 v12, v[140:143] offset:320
  s_mov_b64 exec, s[74:75]
  ds_write_b128 v8, v[148:151] offset:256
  s_mov_b64 exec, 0xffff
  ds_write_b32 v13, v144 offset:640
  s_mov_b64 exec, s[76:77]
  ds_write_b32 v5, v148 offset:896
  s_mov_b64 exec, -1
  v_and_b32 v8, 1, v0
  v_lshl_add_u32 v8, v8, 2, v15
  v_cndmask_b32 v9, 64, 0, s[68:69]
  v_sub_u32 v9, v8, v9
  v_cndmask_b32 v7, 64, 0, s[70:71]
  v_sub_u32 v7, v8, v7
  s_waitcnt lgkmcnt(0)
  s_barrier
  ds_read_b32 v232, v14
  s_lshl_b32 s27, s24, 9
  ds_read_b32 v233, v14 offset:64
  s_cmp_eq_u32 s24, 1
  ds_read_b128 v[192:195], v4 offset:320
  s_movk_i32 s29, 25600
  ds_read_b128 v[196:199], v4 offset:384
  s_cselect_b32 s29, 2048, s29
  ds_read_b128 v[200:203], v4 offset:448
  s_mul_i32 s28, s24, 5120
  ds_read_b128 v[204:207], v4 offset:512
  s_cmp_eq_u32 s24, 2
  ds_read_b128 v[208:211], v4 offset:576
  s_cselect_b32 s29, 4608, s29
  ds_read_b128 v[236:239], v15
  ds_read_b128 v[240:243], v15 offset:64
  ds_read_b32 v152, v5 offset:640
  ds_read_b32 v153, v5 offset:704
  ds_read_b32 v154, v5 offset:768
  ds_read_b32 v155, v5 offset:832
  ds_read_b32 v156, v5 offset:896
  s_waitcnt lgkmcnt(7)
  ds_read_b32 v248, v10
  v_pk_fma_f32 v[60:61], v[192:193], v[232:233], v[60:61] op_sel:[0,1,0] op_sel_hi:[1,1,1] neg_lo:[0,1,0] neg_hi:[0,1,0]
  ds_read_b128 v[250:253], v11
  v_pk_fma_f32 v[62:63], v[194:195], v[232:233], v[62:63] op_sel:[0,1,0] op_sel_hi:[1,1,1] neg_lo:[0,1,0] neg_hi:[0,1,0]
  ds_read_b128 v[158:161], v12 offset:320
  v_cvt_pk_bf16_f32 v172, v60, v61
  ds_read_b32 v157, v13 offset:640
  v_pk_fma_f32 v[68:69], v[196:197], v[232:233], v[68:69] op_sel:[0,1,0] op_sel_hi:[1,1,1] neg_lo:[0,1,0] neg_hi:[0,1,0]
  v_cvt_pk_bf16_f32 v173, v62, v63
  v_add_u32 v12, s27, v6
  v_cvt_pk_bf16_f32 v174, v68, v69
  v_add_u32 v13, s28, v6
  v_add_u32 v6, s29, v6
  v_pk_fma_f32 v[70:71], v[198:199], v[232:233], v[70:71] op_sel:[0,1,0] op_sel_hi:[1,1,1] neg_lo:[0,1,0] neg_hi:[0,1,0]
  v_pk_fma_f32 v[56:57], v[192:193], v[232:233], v[56:57] op_sel:[0,0,0] op_sel_hi:[1,0,1] neg_lo:[0,1,0] neg_hi:[0,1,0]
  v_cvt_pk_bf16_f32 v175, v70, v71
  v_pk_fma_f32 v[76:77], v[200:201], v[232:233], v[76:77] op_sel:[0,1,0] op_sel_hi:[1,1,1] neg_lo:[0,1,0] neg_hi:[0,1,0]
  v_pk_fma_f32 v[78:79], v[202:203], v[232:233], v[78:79] op_sel:[0,1,0] op_sel_hi:[1,1,1] neg_lo:[0,1,0] neg_hi:[0,1,0]
  v_cvt_pk_bf16_f32 v176, v76, v77
  v_cvt_pk_bf16_f32 v177, v78, v79
  v_pk_fma_f32 v[66:67], v[198:199], v[232:233], v[66:67] op_sel:[0,0,0] op_sel_hi:[1,0,1] neg_lo:[0,1,0] neg_hi:[0,1,0]
  v_pk_fma_f32 v[84:85], v[204:205], v[232:233], v[84:85] op_sel:[0,1,0] op_sel_hi:[1,1,1] neg_lo:[0,1,0] neg_hi:[0,1,0]
  v_pk_fma_f32 v[86:87], v[206:207], v[232:233], v[86:87] op_sel:[0,1,0] op_sel_hi:[1,1,1] neg_lo:[0,1,0] neg_hi:[0,1,0]
  v_cvt_pk_bf16_f32 v178, v84, v85
  v_cvt_pk_bf16_f32 v179, v86, v87
  v_pk_fma_f32 v[80:81], v[204:205], v[232:233], v[80:81] op_sel:[0,0,0] op_sel_hi:[1,0,1] neg_lo:[0,1,0] neg_hi:[0,1,0]
  v_pk_fma_f32 v[92:93], v[208:209], v[232:233], v[92:93] op_sel:[0,1,0] op_sel_hi:[1,1,1] neg_lo:[0,1,0] neg_hi:[0,1,0]
  v_pk_fma_f32 v[94:95], v[210:211], v[232:233], v[94:95] op_sel:[0,1,0] op_sel_hi:[1,1,1] neg_lo:[0,1,0] neg_hi:[0,1,0]
  v_cvt_pk_bf16_f32 v180, v92, v93
  v_cvt_pk_bf16_f32 v181, v94, v95
  v_pk_fma_f32 v[90:91], v[210:211], v[232:233], v[90:91] op_sel:[0,0,0] op_sel_hi:[1,0,1] neg_lo:[0,1,0] neg_hi:[0,1,0]
  v_pk_fma_f32 v[58:59], v[194:195], v[232:233], v[58:59] op_sel:[0,0,0] op_sel_hi:[1,0,1] neg_lo:[0,1,0] neg_hi:[0,1,0]
  v_pk_fma_f32 v[64:65], v[196:197], v[232:233], v[64:65] op_sel:[0,0,0] op_sel_hi:[1,0,1] neg_lo:[0,1,0] neg_hi:[0,1,0]
  v_pk_fma_f32 v[72:73], v[200:201], v[232:233], v[72:73] op_sel:[0,0,0] op_sel_hi:[1,0,1] neg_lo:[0,1,0] neg_hi:[0,1,0]
  v_pk_fma_f32 v[74:75], v[202:203], v[232:233], v[74:75] op_sel:[0,0,0] op_sel_hi:[1,0,1] neg_lo:[0,1,0] neg_hi:[0,1,0]
  v_pk_fma_f32 v[82:83], v[206:207], v[232:233], v[82:83] op_sel:[0,0,0] op_sel_hi:[1,0,1] neg_lo:[0,1,0] neg_hi:[0,1,0]
  v_pk_fma_f32 v[88:89], v[208:209], v[232:233], v[88:89] op_sel:[0,0,0] op_sel_hi:[1,0,1] neg_lo:[0,1,0] neg_hi:[0,1,0]
  v_cvt_pk_bf16_f32 v162, v56, v57
  v_cvt_pk_bf16_f32 v163, v58, v59
  v_cvt_pk_bf16_f32 v164, v64, v65
  v_cvt_pk_bf16_f32 v165, v66, v67
  s_waitcnt lgkmcnt(4)
  ds_read_b128 v[212:215], v4 offset:0
  v_pk_fma_f32 v[132:133], v[240:241], v[156:157], v[132:133] op_sel:[0,0,0] op_sel_hi:[1,0,1] neg_lo:[1,0,0] neg_hi:[1,0,0]
  ds_read_b128 v[216:219], v4 offset:64
  v_pk_fma_f32 v[134:135], v[242:243], v[156:157], v[134:135] op_sel:[0,0,0] op_sel_hi:[1,0,1] neg_lo:[1,0,0] neg_hi:[1,0,0]
  ds_read_b128 v[220:223], v4 offset:128
  v_pk_fma_f32 v[128:129], v[236:237], v[156:157], v[128:129] op_sel:[0,0,0] op_sel_hi:[1,0,1] neg_lo:[1,0,0] neg_hi:[1,0,0]
  ds_read_b128 v[224:227], v4 offset:192
  v_pk_fma_f32 v[130:131], v[238:239], v[156:157], v[130:131] op_sel:[0,0,0] op_sel_hi:[1,0,1] neg_lo:[1,0,0] neg_hi:[1,0,0]
  ds_read_b128 v[228:231], v4 offset:256
  v_pk_fma_f32 v[100:101], v[240:241], v[152:153], v[100:101] op_sel:[0,0,0] op_sel_hi:[1,0,1] neg_lo:[1,0,0] neg_hi:[1,0,0]
  v_pk_fma_f32 v[102:103], v[242:243], v[152:153], v[102:103] op_sel:[0,0,0] op_sel_hi:[1,0,1] neg_lo:[1,0,0] neg_hi:[1,0,0]
  v_cvt_pk_bf16_f32 v186, v100, v101
  v_cvt_pk_bf16_f32 v187, v102, v103
  v_pk_fma_f32 v[108:109], v[240:241], v[152:153], v[108:109] op_sel:[0,1,0] op_sel_hi:[1,1,1] neg_lo:[1,0,0] neg_hi:[1,0,0]
  v_pk_fma_f32 v[110:111], v[242:243], v[152:153], v[110:111] op_sel:[0,1,0] op_sel_hi:[1,1,1] neg_lo:[1,0,0] neg_hi:[1,0,0]
  v_cvt_pk_bf16_f32 v192, v108, v109
  v_cvt_pk_bf16_f32 v193, v110, v111
  v_pk_fma_f32 v[116:117], v[240:241], v[154:155], v[116:117] op_sel:[0,0,0] op_sel_hi:[1,0,1] neg_lo:[1,0,0] neg_hi:[1,0,0]
  v_pk_fma_f32 v[118:119], v[242:243], v[154:155], v[118:119] op_sel:[0,0,0] op_sel_hi:[1,0,1] neg_lo:[1,0,0] neg_hi:[1,0,0]
  v_cvt_pk_bf16_f32 v198, v116, v117
  v_cvt_pk_bf16_f32 v199, v118, v119
  v_pk_fma_f32 v[124:125], v[240:241], v[154:155], v[124:125] op_sel:[0,1,0] op_sel_hi:[1,1,1] neg_lo:[1,0,0] neg_hi:[1,0,0]
  v_pk_fma_f32 v[126:127], v[242:243], v[154:155], v[126:127] op_sel:[0,1,0] op_sel_hi:[1,1,1] neg_lo:[1,0,0] neg_hi:[1,0,0]
  v_cvt_pk_bf16_f32 v204, v124, v125
  v_cvt_pk_bf16_f32 v205, v126, v127
  v_pk_fma_f32 v[96:97], v[236:237], v[152:153], v[96:97] op_sel:[0,0,0] op_sel_hi:[1,0,1] neg_lo:[1,0,0] neg_hi:[1,0,0]
  v_pk_fma_f32 v[98:99], v[238:239], v[152:153], v[98:99] op_sel:[0,0,0] op_sel_hi:[1,0,1] neg_lo:[1,0,0] neg_hi:[1,0,0]
  v_pk_fma_f32 v[104:105], v[236:237], v[152:153], v[104:105] op_sel:[0,1,0] op_sel_hi:[1,1,1] neg_lo:[1,0,0] neg_hi:[1,0,0]
  v_pk_fma_f32 v[106:107], v[238:239], v[152:153], v[106:107] op_sel:[0,1,0] op_sel_hi:[1,1,1] neg_lo:[1,0,0] neg_hi:[1,0,0]
  v_pk_fma_f32 v[112:113], v[236:237], v[154:155], v[112:113] op_sel:[0,0,0] op_sel_hi:[1,0,1] neg_lo:[1,0,0] neg_hi:[1,0,0]
  v_pk_fma_f32 v[114:115], v[238:239], v[154:155], v[114:115] op_sel:[0,0,0] op_sel_hi:[1,0,1] neg_lo:[1,0,0] neg_hi:[1,0,0]
  v_pk_fma_f32 v[120:121], v[236:237], v[154:155], v[120:121] op_sel:[0,1,0] op_sel_hi:[1,1,1] neg_lo:[1,0,0] neg_hi:[1,0,0]
  v_pk_fma_f32 v[122:123], v[238:239], v[154:155], v[122:123] op_sel:[0,1,0] op_sel_hi:[1,1,1] neg_lo:[1,0,0] neg_hi:[1,0,0]
  v_cvt_pk_bf16_f32 v166, v72, v73
  v_cvt_pk_bf16_f32 v167, v74, v75
  v_cvt_pk_bf16_f32 v168, v80, v81
  v_cvt_pk_bf16_f32 v169, v82, v83
  v_cvt_pk_bf16_f32 v170, v88, v89
  v_cvt_pk_bf16_f32 v171, v90, v91
  v_cvt_pk_bf16_f32 v184, v96, v97
  v_cvt_pk_bf16_f32 v185, v98, v99
  v_cvt_pk_bf16_f32 v190, v104, v105
  v_cvt_pk_bf16_f32 v191, v106, v107
  s_waitcnt lgkmcnt(5)
  ds_read_b32 v234, v14 offset:576
  v_pk_fma_f32 v[140:141], v[158:159], v[248:249], v[140:141] op_sel:[0,0,0] op_sel_hi:[1,0,1] neg_lo:[0,1,0] neg_hi:[0,1,0]
  ds_read_b32 v235, v14 offset:640
  v_pk_fma_f32 v[142:143], v[160:161], v[248:249], v[142:143] op_sel:[0,0,0] op_sel_hi:[1,0,1] neg_lo:[0,1,0] neg_hi:[0,1,0]
  ds_read_b32 v244, v9 offset:576
  v_pk_fma_f32 v[144:145], v[250:251], v[156:157], v[144:145] op_sel:[0,1,0] op_sel_hi:[1,1,1] neg_lo:[1,0,0] neg_hi:[1,0,0]
  ds_read_b32 v245, v9 offset:640
  v_pk_fma_f32 v[146:147], v[252:253], v[156:157], v[146:147] op_sel:[0,1,0] op_sel_hi:[1,1,1] neg_lo:[1,0,0] neg_hi:[1,0,0]
  ds_read_b32 v246, v7 offset:584
  v_cvt_pk_bf16_f32 v60, v140, v141
  ds_read_b32 v247, v7 offset:648
  v_cvt_pk_bf16_f32 v61, v142, v143
  v_cndmask_b32 v136, v208, v250, s[72:73]
  v_cndmask_b32 v137, v209, v251, s[72:73]
  v_cndmask_b32 v138, v210, v252, s[72:73]
  v_cndmask_b32 v139, v211, v253, s[72:73]
  v_cndmask_b32 v2, v248, v156, s[72:73]
  v_pk_fma_f32 v[148:149], v[136:137], v[2:3], v[148:149] op_sel:[0,0,0] op_sel_hi:[1,0,1] neg_lo:[1,0,0] neg_hi:[1,0,0]
  v_pk_fma_f32 v[150:151], v[138:139], v[2:3], v[150:151] op_sel:[0,0,0] op_sel_hi:[1,0,1] neg_lo:[1,0,0] neg_hi:[1,0,0]
  v_cvt_pk_bf16_f32 v62, v144, v145
  v_cvt_pk_bf16_f32 v63, v146, v147
  ds_write_b64 v12, v[60:61] offset:0
  v_cvt_pk_bf16_f32 v68, v148, v149
  v_cvt_pk_bf16_f32 v69, v150, v151
  ds_write_b64 v12, v[62:63] offset:2560
  v_cvt_pk_bf16_f32 v210, v132, v133
  ds_write_b64 v6, v[68:69] offset:0
  v_cvt_pk_bf16_f32 v211, v134, v135
  ds_write_b64 v13, v[172:173] offset:5120
  v_cvt_pk_bf16_f32 v196, v112, v113
  ds_write_b64 v13, v[186:187] offset:7680
  v_cvt_pk_bf16_f32 v197, v114, v115
  ds_write_b64 v13, v[174:175] offset:5632
  v_cvt_pk_bf16_f32 v202, v120, v121
  ds_write_b64 v13, v[192:193] offset:8192
  v_cvt_pk_bf16_f32 v203, v122, v123
  ds_write_b64 v13, v[176:177] offset:6144
  v_cvt_pk_bf16_f32 v208, v128, v129
  ds_write_b64 v13, v[198:199] offset:8704
  v_cvt_pk_bf16_f32 v209, v130, v131
  ds_write_b64 v13, v[178:179] offset:6656
  ds_write_b64 v13, v[204:205] offset:9216
  ds_write_b64 v13, v[180:181] offset:7168
  ds_write_b64 v13, v[210:211] offset:9728
  s_waitcnt lgkmcnt(13)
  v_pk_fma_f32 v[16:17], v[212:213], v[232:233], v[16:17] op_sel:[0,0,0] op_sel_hi:[1,0,1] neg_lo:[0,1,0] neg_hi:[0,1,0]
  v_pk_fma_f32 v[18:19], v[214:215], v[232:233], v[18:19] op_sel:[0,0,0] op_sel_hi:[1,0,1] neg_lo:[0,1,0] neg_hi:[0,1,0]
  v_pk_fma_f32 v[20:21], v[212:213], v[232:233], v[20:21] op_sel:[0,1,0] op_sel_hi:[1,1,1] neg_lo:[0,1,0] neg_hi:[0,1,0]
  v_pk_fma_f32 v[22:23], v[214:215], v[232:233], v[22:23] op_sel:[0,1,0] op_sel_hi:[1,1,1] neg_lo:[0,1,0] neg_hi:[0,1,0]
  v_pk_fma_f32 v[24:25], v[216:217], v[232:233], v[24:25] op_sel:[0,0,0] op_sel_hi:[1,0,1] neg_lo:[0,1,0] neg_hi:[0,1,0]
  v_pk_fma_f32 v[26:27], v[218:219], v[232:233], v[26:27] op_sel:[0,0,0] op_sel_hi:[1,0,1] neg_lo:[0,1,0] neg_hi:[0,1,0]
  v_pk_fma_f32 v[28:29], v[216:217], v[232:233], v[28:29] op_sel:[0,1,0] op_sel_hi:[1,1,1] neg_lo:[0,1,0] neg_hi:[0,1,0]
  v_pk_fma_f32 v[30:31], v[218:219], v[232:233], v[30:31] op_sel:[0,1,0] op_sel_hi:[1,1,1] neg_lo:[0,1,0] neg_hi:[0,1,0]
  v_pk_fma_f32 v[32:33], v[220:221], v[232:233], v[32:33] op_sel:[0,0,0] op_sel_hi:[1,0,1] neg_lo:[0,1,0] neg_hi:[0,1,0]
  v_pk_fma_f32 v[34:35], v[222:223], v[232:233], v[34:35] op_sel:[0,0,0] op_sel_hi:[1,0,1] neg_lo:[0,1,0] neg_hi:[0,1,0]
  v_pk_fma_f32 v[36:37], v[220:221], v[232:233], v[36:37] op_sel:[0,1,0] op_sel_hi:[1,1,1] neg_lo:[0,1,0] neg_hi:[0,1,0]
  v_pk_fma_f32 v[38:39], v[222:223], v[232:233], v[38:39] op_sel:[0,1,0] op_sel_hi:[1,1,1] neg_lo:[0,1,0] neg_hi:[0,1,0]
  v_pk_fma_f32 v[40:41], v[224:225], v[232:233], v[40:41] op_sel:[0,0,0] op_sel_hi:[1,0,1] neg_lo:[0,1,0] neg_hi:[0,1,0]
  v_pk_fma_f32 v[42:43], v[226:227], v[232:233], v[42:43] op_sel:[0,0,0] op_sel_hi:[1,0,1] neg_lo:[0,1,0] neg_hi:[0,1,0]
  v_pk_fma_f32 v[44:45], v[224:225], v[232:233], v[44:45] op_sel:[0,1,0] op_sel_hi:[1,1,1] neg_lo:[0,1,0] neg_hi:[0,1,0]
  v_pk_fma_f32 v[46:47], v[226:227], v[232:233], v[46:47] op_sel:[0,1,0] op_sel_hi:[1,1,1] neg_lo:[0,1,0] neg_hi:[0,1,0]
  v_pk_fma_f32 v[48:49], v[228:229], v[232:233], v[48:49] op_sel:[0,0,0] op_sel_hi:[1,0,1] neg_lo:[0,1,0] neg_hi:[0,1,0]
  v_pk_fma_f32 v[50:51], v[230:231], v[232:233], v[50:51] op_sel:[0,0,0] op_sel_hi:[1,0,1] neg_lo:[0,1,0] neg_hi:[0,1,0]
  v_pk_fma_f32 v[52:53], v[228:229], v[232:233], v[52:53] op_sel:[0,1,0] op_sel_hi:[1,1,1] neg_lo:[0,1,0] neg_hi:[0,1,0]
  v_pk_fma_f32 v[54:55], v[230:231], v[232:233], v[54:55] op_sel:[0,1,0] op_sel_hi:[1,1,1] neg_lo:[0,1,0] neg_hi:[0,1,0]
  v_cvt_pk_bf16_f32 v212, v16, v17
  v_cvt_pk_bf16_f32 v213, v18, v19
  v_cvt_pk_bf16_f32 v222, v20, v21
  v_cvt_pk_bf16_f32 v223, v22, v23
  v_cvt_pk_bf16_f32 v214, v24, v25
  v_cvt_pk_bf16_f32 v215, v26, v27
  v_cvt_pk_bf16_f32 v224, v28, v29
  v_cvt_pk_bf16_f32 v225, v30, v31
  v_cvt_pk_bf16_f32 v216, v32, v33
  v_cvt_pk_bf16_f32 v217, v34, v35
  v_cvt_pk_bf16_f32 v226, v36, v37
  v_cvt_pk_bf16_f32 v227, v38, v39
  v_cvt_pk_bf16_f32 v218, v40, v41
  v_cvt_pk_bf16_f32 v219, v42, v43
  v_cvt_pk_bf16_f32 v228, v44, v45
  v_cvt_pk_bf16_f32 v229, v46, v47
  v_cvt_pk_bf16_f32 v220, v48, v49
  v_cvt_pk_bf16_f32 v221, v50, v51
  v_cvt_pk_bf16_f32 v230, v52, v53
  v_cvt_pk_bf16_f32 v231, v54, v55
  s_waitcnt lgkmcnt(0)
  s_barrier
  ds_read_b64 v[152:153], v13 offset:0
  s_mov_b32 s72, 0xffff0000
  ds_read_b64 v[154:155], v13 offset:512
  s_mov_b32 s73, 0xffffffff
  ds_read_b64 v[156:157], v13 offset:1024
  s_mov_b32 s74, 0x0
  ds_read_b64 v[158:159], v13 offset:1536
  s_mov_b32 s75, 0xffffffff
  ds_read_b64 v[160:161], v13 offset:2048
  s_mov_b32 s76, 0x0
  ds_read_b64 v[182:183], v13 offset:2560
  s_mov_b32 s77, 0xffff0000
  ds_read_b64 v[188:189], v13 offset:3072
  s_mov_b32 s78, 0xffff
  ds_read_b64 v[194:195], v13 offset:3584
  s_mov_b32 s79, 0x0
  ds_read_b64 v[200:201], v13 offset:4096
  s_mov_b32 s80, 0xffffffff
  ds_read_b64 v[206:207], v13 offset:4608
  s_mov_b32 s81, 0x0
  s_mov_b32 s82, 0xffffffff
  s_mov_b32 s83, 0xffff
  v_mov_b32 v16, v212
  v_mov_b32 v17, v213
  v_cndmask_b32 v18, 0, v214, s[78:79]
  v_cndmask_b32 v19, 0, v215, s[78:79]
  v_cndmask_b32 v20, 0, v214, s[72:73]
  v_cndmask_b32 v21, 0, v215, s[72:73]
  v_cndmask_b32 v22, 0, v216, s[80:81]
  v_cndmask_b32 v23, 0, v217, s[80:81]
  v_cndmask_b32 v24, 0, v216, s[74:75]
  v_cndmask_b32 v25, 0, v217, s[74:75]
  v_cndmask_b32 v26, 0, v218, s[82:83]
  v_cndmask_b32 v27, 0, v219, s[82:83]
  v_cndmask_b32 v28, 0, v218, s[76:77]
  v_cndmask_b32 v29, 0, v219, s[76:77]
  v_mov_b32 v30, v220
  v_mov_b32 v31, v221
  v_mov_b32 v32, v222
  v_mov_b32 v33, v223
  v_cndmask_b32 v34, 0, v224, s[78:79]
  v_cndmask_b32 v35, 0, v225, s[78:79]
  v_cndmask_b32 v36, 0, v224, s[72:73]
  v_cndmask_b32 v37, 0, v225, s[72:73]
  v_cndmask_b32 v38, 0, v226, s[80:81]
  v_cndmask_b32 v39, 0, v227, s[80:81]
  v_cndmask_b32 v40, 0, v226, s[74:75]
  v_cndmask_b32 v41, 0, v227, s[74:75]
  v_cndmask_b32 v42, 0, v228, s[82:83]
  v_cndmask_b32 v43, 0, v229, s[82:83]
  v_cndmask_b32 v44, 0, v228, s[76:77]
  v_cndmask_b32 v45, 0, v229, s[76:77]
  v_mov_b32 v46, v230
  v_mov_b32 v47, v231
  s_waitcnt lgkmcnt(5)
  v_mfma_f32_16x16x32_bf16 v[80:83], v[172:175], v[32:35], 0
  s_or_b32 s27, s25, s24
  s_cmp_eq_u32 s27, 0
  s_mov_b32 s66, 0xaaaaaaaa
  v_mfma_f32_16x16x32_bf16 v[96:99], v[162:165], v[32:35], 0
  s_mov_b32 s67, 0xaaaaaaaa
  s_cselect_b32 s27, 0xf149f2ca, 0
  v_mul_f32 v136, 0x3ea52b5c, v234
  v_mfma_f32_16x16x32_bf16 v[84:87], v[174:177], v[36:39], 0
  v_mul_f32 v138, 0x3ea52b5c, v235
  v_mov_b32 v149, s27
  v_mul_f32 v137, v136, v246
  v_mfma_f32_16x16x32_bf16 v[100:103], v[164:167], v[36:39], 0
  v_mul_f32 v139, v138, v247
  v_cndmask_b32 v80, v80, v81, s[66:67]
  v_cndmask_b32 v82, v82, v83, s[66:67]
  v_mfma_f32_16x16x32_bf16 v[88:91], v[176:179], v[40:43], 0
  v_cndmask_b32 v96, v96, v97, s[66:67]
  v_cndmask_b32 v98, v98, v99, s[66:67]
  v_cndmask_b32 v84, v84, v85, s[66:67]
  v_mfma_f32_16x16x32_bf16 v[104:107], v[166:169], v[40:43], 0
  v_cndmask_b32 v86, v86, v87, s[66:67]
  v_cndmask_b32 v100, v100, v101, s[66:67]
  v_cndmask_b32 v102, v102, v103, s[66:67]
  v_mfma_f32_16x16x32_bf16 v[92:95], v[178:181], v[44:47], 0
  v_cndmask_b32 v140, v149, 0, s[68:69]
  v_cndmask_b32 v88, v88, v89, s[66:67]
  v_cndmask_b32 v90, v90, v91, s[66:67]
  v_mfma_f32_16x16x32_bf16 v[108:111], v[168:171], v[44:47], 0
  v_cndmask_b32 v141, v149, 0, s[70:71]
  v_cndmask_b32 v104, v104, v105, s[66:67]
  v_cndmask_b32 v106, v106, v107, s[66:67]
  v_mfma_f32_16x16x32_bf16 v[48:51], v[162:165], v[16:19], 0
  v_mul_f32 v136, v136, v244
  v_cndmask_b32 v92, v92, v93, s[66:67]
  v_cndmask_b32 v94, v94, v95, s[66:67]
  v_mfma_f32_16x16x32_bf16 v[64:67], v[152:155], v[16:19], 0
  v_mul_f32 v138, v138, v245
  v_cndmask_b32 v108, v108, v109, s[66:67]
  v_cndmask_b32 v110, v110, v111, s[66:67]
  v_mfma_f32_16x16x32_bf16 v[52:55], v[164:167], v[20:23], 0
  v_cndmask_b32 v120, v96, v80, s[68:69]
  v_cndmask_b32 v48, v48, v49, s[66:67]
  v_cndmask_b32 v50, v50, v51, s[66:67]
  v_mfma_f32_16x16x32_bf16 v[68:71], v[154:157], v[20:23], 0
  v_cndmask_b32 v121, v98, v82, s[70:71]
  v_cndmask_b32 v64, v64, v65, s[66:67]
  v_cndmask_b32 v66, v66, v67, s[66:67]
  v_mfma_f32_16x16x32_bf16 v[56:59], v[166:169], v[24:27], 0
  v_cndmask_b32 v122, v100, v84, s[68:69]
  v_cndmask_b32 v52, v52, v53, s[66:67]
  v_cndmask_b32 v54, v54, v55, s[66:67]
  v_mfma_f32_16x16x32_bf16 v[72:75], v[156:159], v[24:27], 0
  v_cndmask_b32 v123, v102, v86, s[70:71]
  v_cndmask_b32 v68, v68, v69, s[66:67]
  v_cndmask_b32 v70, v70, v71, s[66:67]
  v_mfma_f32_16x16x32_bf16 v[60:63], v[168:171], v[28:31], 0
  v_cndmask_b32 v124, v104, v88, s[68:69]
  v_cndmask_b32 v56, v56, v57, s[66:67]
  v_cndmask_b32 v58, v58, v59, s[66:67]
  v_mfma_f32_16x16x32_bf16 v[76:79], v[158:161], v[28:31], 0
  v_cndmask_b32 v125, v106, v90, s[70:71]
  v_cndmask_b32 v72, v72, v73, s[66:67]
  v_cndmask_b32 v74, v74, v75, s[66:67]
  v_cndmask_b32 v126, v108, v92, s[68:69]
  v_cndmask_b32 v127, v110, v94, s[70:71]
  v_cndmask_b32 v60, v60, v61, s[66:67]
  v_cndmask_b32 v62, v62, v63, s[66:67]
  v_cndmask_b32 v112, v64, v48, s[68:69]
  v_cndmask_b32 v113, v66, v50, s[70:71]
  v_cndmask_b32 v76, v76, v77, s[66:67]
  v_cndmask_b32 v78, v78, v79, s[66:67]
  v_cndmask_b32 v114, v68, v52, s[68:69]
  v_cndmask_b32 v115, v70, v54, s[70:71]
  v_cndmask_b32 v116, v72, v56, s[68:69]
  v_cndmask_b32 v117, v74, v58, s[70:71]
  v_cndmask_b32 v118, v76, v60, s[68:69]
  v_cndmask_b32 v119, v78, v62, s[70:71]
  v_pk_mul_f32 v[120:121], v[120:121], v[138:139]
  v_pk_mul_f32 v[122:123], v[122:123], v[138:139]
  v_pk_mul_f32 v[124:125], v[124:125], v[138:139]
  v_pk_mul_f32 v[126:127], v[126:127], v[138:139]
  v_pk_fma_f32 v[112:113], v[112:113], v[136:137], v[140:141]
  v_pk_fma_f32 v[114:115], v[114:115], v[136:137], v[140:141]
  v_pk_fma_f32 v[116:117], v[116:117], v[136:137], v[140:141]
  v_pk_fma_f32 v[118:119], v[118:119], v[136:137], v[140:141]
  v_max_f32 v132, v120, v121
  v_max_f32 v133, v122, v123
  v_max_f32 v134, v124, v125
  v_max_f32 v135, v126, v127
  v_max_f32 v128, v112, v113
  v_max_f32 v129, v114, v115
  v_max_f32 v130, v116, v117
  v_max_f32 v131, v118, v119
  v_permlane32_swap_b32 v132, v134
  v_permlane32_swap_b32 v133, v135
  v_permlane32_swap_b32 v128, v130
  v_permlane32_swap_b32 v129, v131
  v_max_f32 v132, v132, v134
  v_max_f32 v133, v133, v135
  v_max_f32 v128, v128, v130
  v_max_f32 v129, v129, v131
  v_permlane16_swap_b32 v132, v133
  s_nop 0
  v_permlane16_swap_b32 v128, v129
  v_max_f32 v132, v132, v133
  v_max_f32 v128, v128, v129
  v_mov_b32 v133, v132
  v_mov_b32 v129, v128
  v_mov_b32 v146, 0x0c0c0100
  v_permlane16_swap_b32 v132, v133
  v_permlane16_swap_b32 v128, v129
  v_mov_b32 v134, v132
  v_mov_b32 v135, v133
  v_mov_b32 v130, v128
  v_mov_b32 v131, v129
  v_permlane32_swap_b32 v132, v134
  v_permlane32_swap_b32 v133, v135
  v_permlane32_swap_b32 v128, v130
  v_permlane32_swap_b32 v129, v131
  v_pk_add_f32 v[120:121], v[120:121], v[132:133] op_sel:[0,0] op_sel_hi:[1,0] neg_lo:[0,1] neg_hi:[0,1]
  v_pk_add_f32 v[124:125], v[124:125], v[134:135] op_sel:[0,0] op_sel_hi:[1,0] neg_lo:[0,1] neg_hi:[0,1]
  v_pk_add_f32 v[112:113], v[112:113], v[128:129] op_sel:[0,0] op_sel_hi:[1,0] neg_lo:[0,1] neg_hi:[0,1]
  v_pk_add_f32 v[116:117], v[116:117], v[130:131] op_sel:[0,0] op_sel_hi:[1,0] neg_lo:[0,1] neg_hi:[0,1]
  v_exp_f32 v120, v120
  v_exp_f32 v121, v121
  v_exp_f32 v124, v124
  v_exp_f32 v125, v125
  v_exp_f32 v112, v112
  v_exp_f32 v113, v113
  v_exp_f32 v116, v116
  v_exp_f32 v117, v117
  v_add_f32 v132, v120, v121
  v_add_f32 v134, v124, v125
  v_add_f32 v128, v112, v113
  v_add_f32 v130, v116, v117
  v_pk_add_f32 v[122:123], v[122:123], v[132:133] op_sel:[0,1] op_sel_hi:[1,1] neg_lo:[0,1] neg_hi:[0,1]
  v_pk_add_f32 v[126:127], v[126:127], v[134:135] op_sel:[0,1] op_sel_hi:[1,1] neg_lo:[0,1] neg_hi:[0,1]
  v_pk_add_f32 v[114:115], v[114:115], v[128:129] op_sel:[0,1] op_sel_hi:[1,1] neg_lo:[0,1] neg_hi:[0,1]
  v_pk_add_f32 v[118:119], v[118:119], v[130:131] op_sel:[0,1] op_sel_hi:[1,1] neg_lo:[0,1] neg_hi:[0,1]
  v_exp_f32 v122, v122
  v_exp_f32 v123, v123
  v_exp_f32 v126, v126
  v_exp_f32 v127, v127
  v_exp_f32 v114, v114
  v_exp_f32 v115, v115
  v_exp_f32 v118, v118
  v_exp_f32 v119, v119
  v_add_f32 v133, v122, v123
  v_add_f32 v135, v126, v127
  v_add_f32 v129, v114, v115
  v_add_f32 v131, v118, v119
  v_permlane32_swap_b32 v132, v134
  v_permlane32_swap_b32 v133, v135
  v_permlane32_swap_b32 v128, v130
  v_permlane32_swap_b32 v129, v131
  v_add_f32 v132, v132, v134
  v_add_f32 v133, v133, v135
  v_add_f32 v128, v128, v130
  v_add_f32 v129, v129, v131
  v_permlane16_swap_b32 v132, v133
  s_nop 0
  v_permlane16_swap_b32 v128, v129
  v_add_f32 v132, v132, v133
  v_add_f32 v128, v128, v129
  v_rcp_f32 v132, v132
  v_rcp_f32 v128, v128
  v_mov_b32 v133, v132
  v_mov_b32 v129, v128
  v_mov_b32 v147, 0x01000c0c
  v_permlane16_swap_b32 v132, v133
  v_permlane16_swap_b32 v128, v129
  v_mov_b32 v134, v132
  v_mov_b32 v135, v133
  v_mov_b32 v130, v128
  v_mov_b32 v131, v129
  v_mov_b32 v142, v244
  v_mov_b32 v143, v246
  v_mov_b32 v144, v245
  v_mov_b32 v145, v247
  v_cndmask_b32 v146, v146, v147, s[66:67]
  v_permlane32_swap_b32 v132, v134
  v_permlane32_swap_b32 v133, v135
  v_permlane32_swap_b32 v128, v130
  v_permlane32_swap_b32 v129, v131
  v_pk_mul_f32 v[120:121], v[120:121], v[144:145]
  v_pk_mul_f32 v[122:123], v[122:123], v[144:145]
  v_pk_mul_f32 v[124:125], v[124:125], v[144:145]
  v_pk_mul_f32 v[126:127], v[126:127], v[144:145]
  v_pk_mul_f32 v[112:113], v[112:113], v[142:143]
  v_pk_mul_f32 v[114:115], v[114:115], v[142:143]
  v_pk_mul_f32 v[116:117], v[116:117], v[142:143]
  v_pk_mul_f32 v[118:119], v[118:119], v[142:143]
  v_mov_b32 v147, 0x0c0c0302
  v_mov_b32 v148, 0x03020c0c
  v_cndmask_b32 v147, v147, v148, s[66:67]
  v_pk_mul_f32 v[120:121], v[120:121], v[132:133] op_sel:[0,0] op_sel_hi:[1,0]
  v_pk_mul_f32 v[122:123], v[122:123], v[132:133] op_sel:[0,1] op_sel_hi:[1,1]
  v_pk_mul_f32 v[124:125], v[124:125], v[134:135] op_sel:[0,0] op_sel_hi:[1,0]
  v_pk_mul_f32 v[126:127], v[126:127], v[134:135] op_sel:[0,1] op_sel_hi:[1,1]
  v_pk_mul_f32 v[112:113], v[112:113], v[128:129] op_sel:[0,0] op_sel_hi:[1,0]
  v_pk_mul_f32 v[114:115], v[114:115], v[128:129] op_sel:[0,1] op_sel_hi:[1,1]
  v_pk_mul_f32 v[116:117], v[116:117], v[130:131] op_sel:[0,0] op_sel_hi:[1,0]
  v_pk_mul_f32 v[118:119], v[118:119], v[130:131] op_sel:[0,1] op_sel_hi:[1,1]
  v_mov_b32 v148, 0x0c0c0c0c
  v_cvt_pk_bf16_f32 v120, v120, v121
  v_cvt_pk_bf16_f32 v122, v122, v123
  v_cvt_pk_bf16_f32 v124, v124, v125
  v_cvt_pk_bf16_f32 v126, v126, v127
  v_cvt_pk_bf16_f32 v112, v112, v113
  v_cvt_pk_bf16_f32 v114, v114, v115
  v_cvt_pk_bf16_f32 v116, v116, v117
  v_cvt_pk_bf16_f32 v118, v118, v119
  v_cndmask_b32 v9, v148, v146, s[68:69]
  v_cndmask_b32 v8, v146, v148, s[68:69]
  v_cndmask_b32 v11, v148, v147, s[70:71]
  v_cndmask_b32 v10, v147, v148, s[70:71]
  v_perm_b32 v32, v120, v120, v8
  v_perm_b32 v33, v120, v120, v10
  v_perm_b32 v34, v120, v120, v9
  v_perm_b32 v35, v120, v120, v11
  v_perm_b32 v36, v122, v122, v8
  v_perm_b32 v37, v122, v122, v10
  v_perm_b32 v38, v122, v122, v9
  v_perm_b32 v39, v122, v122, v11
  v_perm_b32 v40, v124, v124, v8
  v_perm_b32 v41, v124, v124, v10
  v_perm_b32 v42, v124, v124, v9
  v_perm_b32 v43, v124, v124, v11
  v_perm_b32 v44, v126, v126, v8
  v_perm_b32 v45, v126, v126, v10
  v_perm_b32 v46, v126, v126, v9
  v_perm_b32 v47, v126, v126, v11
  v_perm_b32 v16, v112, v112, v8
  v_perm_b32 v17, v112, v112, v10
  v_perm_b32 v18, v112, v112, v9
  v_perm_b32 v19, v112, v112, v11
  v_perm_b32 v20, v114, v114, v8
  v_perm_b32 v21, v114, v114, v10
  v_perm_b32 v22, v114, v114, v9
  v_perm_b32 v23, v114, v114, v11
  v_perm_b32 v24, v116, v116, v8
  v_perm_b32 v25, v116, v116, v10
  v_perm_b32 v26, v116, v116, v9
  v_perm_b32 v27, v116, v116, v11
  v_perm_b32 v28, v118, v118, v8
  v_perm_b32 v29, v118, v118, v10
  v_perm_b32 v30, v118, v118, v9
  v_perm_b32 v31, v118, v118, v11
  s_lshl_b32 s27, s25, 1
  s_waitcnt lgkmcnt(0)
  s_lshr_b32 s28, s24, 1
  v_mfma_f32_16x16x32_bf16 v[96:99], v[190:193], v[32:35], 0
  s_add_u32 s27, s27, s28
  s_mul_i32 s29, s26, 5
  s_mul_i32 s27, s27, 74
  v_mfma_f32_16x16x32_bf16 v[84:87], v[190:193], v[36:39], 0
  s_lshr_b32 s29, s29, 1
  s_add_u32 s27, s27, s29
  s_lshl_b32 s27, s27, 12
  v_mfma_f32_16x16x32_bf16 v[100:103], v[196:199], v[36:39], 0
  s_and_b32 s28, s24, 1
  s_lshl_b32 s28, s28, 11
  s_add_u32 s55, s27, s28
  v_mfma_f32_16x16x32_bf16 v[88:91], v[196:199], v[40:43], 0
  v_lshlrev_b32 v7, 4, v0
  v_cndmask_b32 v84, v96, v84, s[72:73]
  v_cndmask_b32 v85, v97, v85, s[72:73]
  v_mfma_f32_16x16x32_bf16 v[104:107], v[202:205], v[40:43], 0
  v_cndmask_b32 v86, v98, v86, s[72:73]
  v_cndmask_b32 v87, v99, v87, s[72:73]
  v_cvt_pk_bf16_f32 v224, v84, v85
  v_mfma_f32_16x16x32_bf16 v[92:95], v[202:205], v[44:47], 0
  v_cvt_pk_bf16_f32 v225, v86, v87
  v_cndmask_b32 v88, v100, v88, s[74:75]
  v_cndmask_b32 v89, v101, v89, s[74:75]
  v_mfma_f32_16x16x32_bf16 v[64:67], v[188:191], v[16:19], 0
  v_cndmask_b32 v90, v102, v90, s[74:75]
  v_cndmask_b32 v91, v103, v91, s[74:75]
  v_cvt_pk_bf16_f32 v226, v88, v89
  v_mfma_f32_16x16x32_bf16 v[52:55], v[188:191], v[20:23], 0
  v_cvt_pk_bf16_f32 v227, v90, v91
  v_cndmask_b32 v92, v104, v92, s[76:77]
  v_cndmask_b32 v93, v105, v93, s[76:77]
  v_mfma_f32_16x16x32_bf16 v[68:71], v[194:197], v[20:23], 0
  v_cndmask_b32 v94, v106, v94, s[76:77]
  v_cndmask_b32 v95, v107, v95, s[76:77]
  v_cvt_pk_bf16_f32 v228, v92, v93
  v_mfma_f32_16x16x32_bf16 v[56:59], v[194:197], v[24:27], 0
  v_cvt_pk_bf16_f32 v229, v94, v95
  v_cndmask_b32 v52, v64, v52, s[72:73]
  v_cndmask_b32 v53, v65, v53, s[72:73]
  v_mfma_f32_16x16x32_bf16 v[72:75], v[200:203], v[24:27], 0
  v_cndmask_b32 v54, v66, v54, s[72:73]
  v_cndmask_b32 v55, v67, v55, s[72:73]
  v_cvt_pk_bf16_f32 v214, v52, v53
  v_mfma_f32_16x16x32_bf16 v[60:63], v[200:203], v[28:31], 0
  v_cvt_pk_bf16_f32 v215, v54, v55
  v_cndmask_b32 v56, v68, v56, s[74:75]
  v_cndmask_b32 v57, v69, v57, s[74:75]
  v_mfma_f32_16x16x32_bf16 v[80:83], v[184:187], v[32:35], 0
  v_cndmask_b32 v58, v70, v58, s[74:75]
  v_cndmask_b32 v59, v71, v59, s[74:75]
  v_cvt_pk_bf16_f32 v216, v56, v57
  v_mfma_f32_16x16x32_bf16 v[108:111], v[208:211], v[44:47], 0
  v_cvt_pk_bf16_f32 v217, v58, v59
  v_cndmask_b32 v60, v72, v60, s[76:77]
  v_cndmask_b32 v61, v73, v61, s[76:77]
  v_mfma_f32_16x16x32_bf16 v[48:51], v[182:185], v[16:19], 0
  v_cndmask_b32 v62, v74, v62, s[76:77]
  v_cndmask_b32 v63, v75, v63, s[76:77]
  v_cvt_pk_bf16_f32 v222, v80, v81
  v_mfma_f32_16x16x32_bf16 v[76:79], v[206:209], v[28:31], 0
  v_cvt_pk_bf16_f32 v223, v82, v83
  v_cvt_pk_bf16_f32 v230, v108, v109
  v_cvt_pk_bf16_f32 v231, v110, v111
  v_cvt_pk_bf16_f32 v218, v60, v61
  v_cvt_pk_bf16_f32 v219, v62, v63
  v_cvt_pk_bf16_f32 v212, v48, v49
  v_cvt_pk_bf16_f32 v213, v50, v51
  s_nop 0
  v_cvt_pk_bf16_f32 v220, v76, v77
  v_cvt_pk_bf16_f32 v221, v78, v79
  s_mov_b32 s83, s55
  s_branch L2_c
L_cH:
L_cH_init:
  v_lshrrev_b32 v2, 4, v0
  v_bfe_u32 v3, v0, 2, 2
  v_and_b32 v4, 3, v0
  v_and_b32 v5, 1, v2
  v_lshl_add_u32 v6, v2, 3, v3
  v_mul_u32_u24 v6, 448, v6
  v_lshl_add_u32 v14, v4, 3, v6
  v_lshlrev_b32 v15, 1, v5
  v_and_b32 v3, 15, v0
  v_lshrrev_b32 v4, 1, v3
  v_xor_b32 v4, v4, v2
  v_lshlrev_b32 v4, 4, v4
  v_lshl_add_u32 v4, v3, 7, v4
  s_lshl_b32 s27, s24, 12
  s_add_u32 s27, s27, 76800
  v_add_u32 v6, s27, v4
  v_xor_b32 v7, 64, v6
  v_add_u32 v8, 76800, v4
  v_xor_b32 v9, 64, v8
  v_cmp_eq_u32 vcc, 0, v3
  s_nop 2
  s_not_b64 s[42:43], vcc
  v_mov_b32 v13, 0x3f803f80
  v_cndmask_b32 v200, 0, v13, vcc
  v_cndmask_b32 v201, 0, v13, vcc
  v_cndmask_b32 v202, 0, v13, vcc
  v_cndmask_b32 v203, 0, v13, vcc
  v_lshl_add_u32 v1, v15, 4, v14
  v_lshlrev_b32 v13, 4, v15
  v_sub_u32 v2, v14, v13
  v_mov_b32 v16, 0
  v_mov_b32 v17, 0
  v_mov_b32 v18, 0
  v_mov_b32 v19, 0
  v_mov_b32 v20, 0
  v_mov_b32 v21, 0
  v_mov_b32 v22, 0
  v_mov_b32 v23, 0
  v_mov_b32 v24, 0
  v_mov_b32 v25, 0
  v_mov_b32 v26, 0
  v_mov_b32 v27, 0
  v_mov_b32 v28, 0
  v_mov_b32 v29, 0
  v_mov_b32 v30, 0
  v_mov_b32 v31, 0
  v_mov_b32 v32, 0
  v_mov_b32 v33, 0
  v_mov_b32 v34, 0
  v_mov_b32 v35, 0
  v_mov_b32 v36, 0
  v_mov_b32 v37, 0
  v_mov_b32 v38, 0
  v_mov_b32 v39, 0
  v_mov_b32 v40, 0
  v_mov_b32 v41, 0
  v_mov_b32 v42, 0
  v_mov_b32 v43, 0
  v_mov_b32 v44, 0
  v_mov_b32 v45, 0
  v_mov_b32 v46, 0
  v_mov_b32 v47, 0
  v_mov_b32 v48, 0
  v_mov_b32 v49, 0
  v_mov_b32 v50, 0
  v_mov_b32 v51, 0
  v_mov_b32 v52, 0
  v_mov_b32 v53, 0
  v_mov_b32 v54, 0
  v_mov_b32 v55, 0
  v_mov_b32 v56, 0
  v_mov_b32 v57, 0
  v_mov_b32 v58, 0
  v_mov_b32 v59, 0
  v_mov_b32 v60, 0
  v_mov_b32 v61, 0
  v_mov_b32 v62, 0
  v_mov_b32 v63, 0
  v_mov_b32 v64, 0
  v_mov_b32 v65, 0
  v_mov_b32 v66, 0
  v_mov_b32 v67, 0
  v_mov_b32 v68, 0
  v_mov_b32 v69, 0
  v_mov_b32 v70, 0
  v_mov_b32 v71, 0
  v_mov_b32 v72, 0
  v_mov_b32 v73, 0
  v_mov_b32 v74, 0
  v_mov_b32 v75, 0
  v_mov_b32 v76, 0
  v_mov_b32 v77, 0
  v_mov_b32 v78, 0
  v_mov_b32 v79, 0
  v_mov_b32 v80, 0
  v_mov_b32 v81, 0
  v_mov_b32 v82, 0
  v_mov_b32 v83, 0
  v_mov_b32 v84, 0
  v_mov_b32 v85, 0
  v_mov_b32 v86, 0
  v_mov_b32 v87, 0
  v_mov_b32 v88, 0
  v_mov_b32 v89, 0
  v_mov_b32 v90, 0
  v_mov_b32 v91, 0
  v_mov_b32 v92, 0
  v_mov_b32 v93, 0
  v_mov_b32 v94, 0
  v_mov_b32 v95, 0
  v_mov_b32 v96, 0
  v_mov_b32 v97, 0
  v_mov_b32 v98, 0
  v_mov_b32 v99, 0
  v_mov_b32 v100, 0
  v_mov_b32 v101, 0
  v_mov_b32 v102, 0
  v_mov_b32 v103, 0
  v_mov_b32 v104, 0
  v_mov_b32 v105, 0
  v_mov_b32 v106, 0
  v_mov_b32 v107, 0
  v_mov_b32 v108, 0
  v_mov_b32 v109, 0
  v_mov_b32 v110, 0
  v_mov_b32 v111, 0
  v_mov_b32 v112, 0
  v_mov_b32 v113, 0
  v_mov_b32 v114, 0
  v_mov_b32 v115, 0
  v_mov_b32 v116, 0
  v_mov_b32 v117, 0
  v_mov_b32 v118, 0
  v_mov_b32 v119, 0
  v_mov_b32 v120, 0
  v_mov_b32 v121, 0
  v_mov_b32 v122, 0
  v_mov_b32 v123, 0
  v_mov_b32 v124, 0
  v_mov_b32 v125, 0
  v_mov_b32 v126, 0
  v_mov_b32 v127, 0
  v_mov_b32 v136, 0
  v_mov_b32 v137, 0
  v_mov_b32 v138, 0
  v_mov_b32 v139, 0
  v_mov_b32 v140, 0
  v_mov_b32 v141, 0
  v_mov_b32 v142, 0
  v_mov_b32 v143, 0
  v_mov_b32 v144, 0
  v_mov_b32 v145, 0
  v_mov_b32 v146, 0
  v_mov_b32 v147, 0
  v_mov_b32 v148, 0
  v_mov_b32 v149, 0
  v_mov_b32 v150, 0
  v_mov_b32 v151, 0
  s_mov_b32 s31, 0
  s_mov_b32 s33, 0
  s_mov_b32 s52, 15360
  s_mov_b32 s50, 18432
  s_mov_b32 s53, 4294905856
  s_mov_b32 s54, 4294930432
  s_mov_b32 s30, 0
  s_waitcnt lgkmcnt(0)
  s_mov_b32 s16, s70
  s_and_b32 s17, s71, 0xffff
  s_mov_b32 s18, 268435456
  s_mov_b32 s19, 0x20000
  s_barrier
  s_cmp_eq_u32 s24, 0
  s_cbranch_scc1 L_cH0
  s_cmp_eq_u32 s24, 1
  s_cbranch_scc1 L_cH1
  s_cmp_eq_u32 s24, 2
  s_cbranch_scc1 L_cH2
  s_branch L_cH3
L_cH0:
  ds_read_b128 v[192:195], v6 offset:0
  ds_read_b128 v[196:199], v6 offset:2048
  ds_read_b64_tr_b16 v[152:153], v1 offset:0
  ds_read_b64_tr_b16 v[154:155], v1 offset:1792
  ds_read_b64_tr_b16 v[156:157], v2 offset:32
  ds_read_b64_tr_b16 v[158:159], v2 offset:1824
  ds_read_b64_tr_b16 v[160:161], v1 offset:64
  ds_read_b64_tr_b16 v[162:163], v1 offset:1856
  ds_read_b64_tr_b16 v[164:165], v2 offset:96
  ds_read_b64_tr_b16 v[166:167], v2 offset:1888
  ds_read_b64_tr_b16 v[168:169], v1 offset:128
  ds_read_b64_tr_b16 v[170:171], v1 offset:1920
L_cH0_loop:
  s_waitcnt lgkmcnt(6)
  v_mfma_f32_16x16x32_bf16 v[16:19], v[152:155], v[192:195], v[16:19]
  ds_read_b64_tr_b16 v[172:173], v2 offset:160
  s_add_u32 s31, s31, 1
  v_mfma_f32_16x16x32_bf16 v[20:23], v[152:155], v[196:199], v[20:23]
  ds_read_b64_tr_b16 v[174:175], v2 offset:1952
  s_cmp_eq_u32 s31, 5
  v_mfma_f32_16x16x32_bf16 v[136:139], v[152:155], v[200:203], v[136:139]
  s_cselect_b32 s32, s53, s52
  s_cselect_b32 s31, 0, s31
  v_mfma_f32_16x16x32_bf16 v[24:27], v[156:159], v[192:195], v[24:27]
  ds_read_b64_tr_b16 v[176:177], v1 offset:192
  ds_read_b128 v[204:207], v7 offset:0
  v_mfma_f32_16x16x32_bf16 v[28:31], v[156:159], v[196:199], v[28:31]
  ds_read_b64_tr_b16 v[178:179], v1 offset:1984
  s_waitcnt lgkmcnt(7)
  v_mfma_f32_16x16x32_bf16 v[32:35], v[160:163], v[192:195], v[32:35]
  ds_read_b64_tr_b16 v[152:153], v2 offset:224
  ds_read_b128 v[208:211], v7 offset:2048
  v_mfma_f32_16x16x32_bf16 v[36:39], v[160:163], v[196:199], v[36:39]
  ds_read_b64_tr_b16 v[154:155], v2 offset:2016
  v_mfma_f32_16x16x32_bf16 v[40:43], v[164:167], v[192:195], v[40:43]
  ds_read_b64_tr_b16 v[156:157], v1 offset:256
  v_mfma_f32_16x16x32_bf16 v[44:47], v[164:167], v[196:199], v[44:47]
  ds_read_b64_tr_b16 v[158:159], v1 offset:2048
  s_waitcnt lgkmcnt(8)
  v_mfma_f32_16x16x32_bf16 v[48:51], v[168:171], v[192:195], v[48:51]
  ds_read_b64_tr_b16 v[160:161], v2 offset:288
  v_mfma_f32_16x16x32_bf16 v[52:55], v[168:171], v[196:199], v[52:55]
  ds_read_b64_tr_b16 v[162:163], v2 offset:2080
  v_mfma_f32_16x16x32_bf16 v[140:143], v[168:171], v[200:203], v[140:143]
  v_mfma_f32_16x16x32_bf16 v[56:59], v[172:175], v[192:195], v[56:59]
  ds_read_b64_tr_b16 v[164:165], v1 offset:320
  v_mfma_f32_16x16x32_bf16 v[60:63], v[172:175], v[196:199], v[60:63]
  ds_read_b64_tr_b16 v[166:167], v1 offset:2112
  s_waitcnt lgkmcnt(6)
  v_mfma_f32_16x16x32_bf16 v[64:67], v[176:179], v[192:195], v[64:67]
  ds_read_b64_tr_b16 v[168:169], v2 offset:352
  v_mfma_f32_16x16x32_bf16 v[68:71], v[176:179], v[196:199], v[68:71]
  ds_read_b64_tr_b16 v[170:171], v2 offset:2144
  v_mfma_f32_16x16x32_bf16 v[72:75], v[152:155], v[192:195], v[72:75]
  ds_read_b64_tr_b16 v[172:173], v1 offset:384
  v_mfma_f32_16x16x32_bf16 v[76:79], v[152:155], v[196:199], v[76:79]
  ds_read_b64_tr_b16 v[174:175], v1 offset:2176
  s_waitcnt lgkmcnt(6)
  v_mfma_f32_16x16x32_bf16 v[80:83], v[156:159], v[192:195], v[80:83]
  ds_read_b64_tr_b16 v[176:177], v2 offset:416
  v_add_u32 v1, s32, v1
  v_mfma_f32_16x16x32_bf16 v[84:87], v[156:159], v[196:199], v[84:87]
  ds_read_b64_tr_b16 v[178:179], v2 offset:2208
  v_mfma_f32_16x16x32_bf16 v[144:147], v[156:159], v[200:203], v[144:147]
  v_mfma_f32_16x16x32_bf16 v[88:91], v[160:163], v[192:195], v[88:91]
  ds_read_b64_tr_b16 v[152:153], v1 offset:0
  v_add_u32 v2, s32, v2
  v_mfma_f32_16x16x32_bf16 v[92:95], v[160:163], v[196:199], v[92:95]
  ds_read_b64_tr_b16 v[154:155], v1 offset:1792
  s_waitcnt lgkmcnt(6)
  v_mfma_f32_16x16x32_bf16 v[96:99], v[164:167], v[192:195], v[96:99]
  ds_read_b64_tr_b16 v[156:157], v2 offset:32
  v_mfma_f32_16x16x32_bf16 v[100:103], v[164:167], v[196:199], v[100:103]
  ds_read_b64_tr_b16 v[158:159], v2 offset:1824
  v_mfma_f32_16x16x32_bf16 v[104:107], v[168:171], v[192:195], v[104:107]
  ds_read_b64_tr_b16 v[160:161], v1 offset:64
  v_mfma_f32_16x16x32_bf16 v[108:111], v[168:171], v[196:199], v[108:111]
  ds_read_b64_tr_b16 v[162:163], v1 offset:1856
  s_waitcnt lgkmcnt(6)
  v_mfma_f32_16x16x32_bf16 v[112:115], v[172:175], v[192:195], v[112:115]
  ds_read_b64_tr_b16 v[164:165], v2 offset:96
  v_mfma_f32_16x16x32_bf16 v[116:119], v[172:175], v[196:199], v[116:119]
  ds_read_b64_tr_b16 v[166:167], v2 offset:1888
  v_mfma_f32_16x16x32_bf16 v[148:151], v[172:175], v[200:203], v[148:151]
  v_mfma_f32_16x16x32_bf16 v[120:123], v[176:179], v[192:195], v[120:123]
  ds_read_b64_tr_b16 v[168:169], v1 offset:128
  v_mfma_f32_16x16x32_bf16 v[124:127], v[176:179], v[196:199], v[124:127]
  ds_read_b64_tr_b16 v[170:171], v1 offset:1920
  s_barrier
  s_waitcnt lgkmcnt(6)
  v_mfma_f32_16x16x32_bf16 v[16:19], v[152:155], v[204:207], v[16:19]
  ds_read_b64_tr_b16 v[172:173], v2 offset:160
  s_add_u32 s33, s33, 1
  v_mfma_f32_16x16x32_bf16 v[20:23], v[152:155], v[208:211], v[20:23]
  ds_read_b64_tr_b16 v[174:175], v2 offset:1952
  s_cmp_eq_u32 s33, 3
  v_mfma_f32_16x16x32_bf16 v[136:139], v[152:155], v[200:203], v[136:139]
  s_cselect_b32 s34, s54, s50
  s_cselect_b32 s33, 0, s33
  v_mfma_f32_16x16x32_bf16 v[24:27], v[156:159], v[204:207], v[24:27]
  ds_read_b64_tr_b16 v[176:177], v1 offset:192
  s_add_u32 s31, s31, 1
  v_mfma_f32_16x16x32_bf16 v[28:31], v[156:159], v[208:211], v[28:31]
  ds_read_b64_tr_b16 v[178:179], v1 offset:1984
  s_waitcnt lgkmcnt(6)
  v_mfma_f32_16x16x32_bf16 v[32:35], v[160:163], v[204:207], v[32:35]
  ds_read_b64_tr_b16 v[152:153], v2 offset:224
  s_cmp_eq_u32 s31, 5
  v_mfma_f32_16x16x32_bf16 v[36:39], v[160:163], v[208:211], v[36:39]
  ds_read_b64_tr_b16 v[154:155], v2 offset:2016
  s_cselect_b32 s32, s53, s52
  v_mfma_f32_16x16x32_bf16 v[40:43], v[164:167], v[204:207], v[40:43]
  ds_read_b64_tr_b16 v[156:157], v1 offset:256
  s_cselect_b32 s31, 0, s31
  v_mfma_f32_16x16x32_bf16 v[44:47], v[164:167], v[208:211], v[44:47]
  ds_read_b64_tr_b16 v[158:159], v1 offset:2048
  s_waitcnt lgkmcnt(6)
  v_mfma_f32_16x16x32_bf16 v[48:51], v[168:171], v[204:207], v[48:51]
  ds_read_b64_tr_b16 v[160:161], v2 offset:288
  v_add_u32 v6, s34, v6
  v_mfma_f32_16x16x32_bf16 v[52:55], v[168:171], v[208:211], v[52:55]
  ds_read_b64_tr_b16 v[162:163], v2 offset:2080
  v_add_u32 v7, s34, v7
  v_mfma_f32_16x16x32_bf16 v[140:143], v[168:171], v[200:203], v[140:143]
  ds_read_b128 v[192:195], v6 offset:0
  ds_read_b128 v[196:199], v6 offset:2048
  v_mfma_f32_16x16x32_bf16 v[56:59], v[172:175], v[204:207], v[56:59]
  ds_read_b64_tr_b16 v[164:165], v1 offset:320
  v_mfma_f32_16x16x32_bf16 v[60:63], v[172:175], v[208:211], v[60:63]
  ds_read_b64_tr_b16 v[166:167], v1 offset:2112
  s_waitcnt lgkmcnt(8)
  v_mfma_f32_16x16x32_bf16 v[64:67], v[176:179], v[204:207], v[64:67]
  ds_read_b64_tr_b16 v[168:169], v2 offset:352
  v_mfma_f32_16x16x32_bf16 v[68:71], v[176:179], v[208:211], v[68:71]
  ds_read_b64_tr_b16 v[170:171], v2 offset:2144
  v_mfma_f32_16x16x32_bf16 v[72:75], v[152:155], v[204:207], v[72:75]
  ds_read_b64_tr_b16 v[172:173], v1 offset:384
  v_mfma_f32_16x16x32_bf16 v[76:79], v[152:155], v[208:211], v[76:79]
  ds_read_b64_tr_b16 v[174:175], v1 offset:2176
  s_waitcnt lgkmcnt(8)
  v_mfma_f32_16x16x32_bf16 v[80:83], v[156:159], v[204:207], v[80:83]
  ds_read_b64_tr_b16 v[176:177], v2 offset:416
  v_add_u32 v1, s32, v1
  v_mfma_f32_16x16x32_bf16 v[84:87], v[156:159], v[208:211], v[84:87]
  ds_read_b64_tr_b16 v[178:179], v2 offset:2208
  v_mfma_f32_16x16x32_bf16 v[144:147], v[156:159], v[200:203], v[144:147]
  v_mfma_f32_16x16x32_bf16 v[88:91], v[160:163], v[204:207], v[88:91]
  ds_read_b64_tr_b16 v[152:153], v1 offset:0
  v_add_u32 v2, s32, v2
  v_mfma_f32_16x16x32_bf16 v[92:95], v[160:163], v[208:211], v[92:95]
  ds_read_b64_tr_b16 v[154:155], v1 offset:1792
  s_waitcnt lgkmcnt(6)
  v_mfma_f32_16x16x32_bf16 v[96:99], v[164:167], v[204:207], v[96:99]
  ds_read_b64_tr_b16 v[156:157], v2 offset:32
  v_mfma_f32_16x16x32_bf16 v[100:103], v[164:167], v[208:211], v[100:103]
  ds_read_b64_tr_b16 v[158:159], v2 offset:1824
  v_mfma_f32_16x16x32_bf16 v[104:107], v[168:171], v[204:207], v[104:107]
  ds_read_b64_tr_b16 v[160:161], v1 offset:64
  v_mfma_f32_16x16x32_bf16 v[108:111], v[168:171], v[208:211], v[108:111]
  ds_read_b64_tr_b16 v[162:163], v1 offset:1856
  s_waitcnt lgkmcnt(6)
  v_mfma_f32_16x16x32_bf16 v[112:115], v[172:175], v[204:207], v[112:115]
  ds_read_b64_tr_b16 v[164:165], v2 offset:96
  v_mfma_f32_16x16x32_bf16 v[116:119], v[172:175], v[208:211], v[116:119]
  ds_read_b64_tr_b16 v[166:167], v2 offset:1888
  v_mfma_f32_16x16x32_bf16 v[148:151], v[172:175], v[200:203], v[148:151]
  v_mfma_f32_16x16x32_bf16 v[120:123], v[176:179], v[204:207], v[120:123]
  ds_read_b64_tr_b16 v[168:169], v1 offset:128
  v_mfma_f32_16x16x32_bf16 v[124:127], v[176:179], v[208:211], v[124:127]
  ds_read_b64_tr_b16 v[170:171], v1 offset:1920
  s_barrier
  s_add_u32 s30, s30, 1
  s_cmp_lt_u32 s30, 10
  s_cbranch_scc1 L_cH0_loop
  s_branch L_epiH
L_cH1:
  ds_read_b128 v[192:195], v6 offset:0
  ds_read_b128 v[196:199], v6 offset:2048
  ds_read_b64_tr_b16 v[152:153], v1 offset:0
  ds_read_b64_tr_b16 v[154:155], v1 offset:1792
  ds_read_b64_tr_b16 v[156:157], v2 offset:32
  ds_read_b64_tr_b16 v[158:159], v2 offset:1824
  ds_read_b64_tr_b16 v[160:161], v1 offset:64
  ds_read_b64_tr_b16 v[162:163], v1 offset:1856
  ds_read_b64_tr_b16 v[164:165], v2 offset:96
  ds_read_b64_tr_b16 v[166:167], v2 offset:1888
  ds_read_b64_tr_b16 v[168:169], v1 offset:128
  ds_read_b64_tr_b16 v[170:171], v1 offset:1920
L_cH1_loop:
  s_waitcnt lgkmcnt(6)
  v_mfma_f32_16x16x32_bf16 v[16:19], v[152:155], v[192:195], v[16:19]
  ds_read_b64_tr_b16 v[172:173], v2 offset:160
  s_add_u32 s31, s31, 1
  v_mfma_f32_16x16x32_bf16 v[20:23], v[152:155], v[196:199], v[20:23]
  ds_read_b64_tr_b16 v[174:175], v2 offset:1952
  s_cmp_eq_u32 s31, 5
  v_mfma_f32_16x16x32_bf16 v[24:27], v[156:159], v[192:195], v[24:27]
  ds_read_b64_tr_b16 v[176:177], v1 offset:192
  s_cselect_b32 s32, s53, s52
  v_mfma_f32_16x16x32_bf16 v[28:31], v[156:159], v[196:199], v[28:31]
  ds_read_b64_tr_b16 v[178:179], v1 offset:1984
  s_cselect_b32 s31, 0, s31
  v_mfma_f32_16x16x32_bf16 v[136:139], v[156:159], v[200:203], v[136:139]
  ds_read_b128 v[204:207], v7 offset:0
  s_waitcnt lgkmcnt(7)
  v_mfma_f32_16x16x32_bf16 v[32:35], v[160:163], v[192:195], v[32:35]
  ds_read_b64_tr_b16 v[152:153], v2 offset:224
  ds_read_b128 v[208:211], v7 offset:2048
  v_mfma_f32_16x16x32_bf16 v[36:39], v[160:163], v[196:199], v[36:39]
  ds_read_b64_tr_b16 v[154:155], v2 offset:2016
  v_mfma_f32_16x16x32_bf16 v[40:43], v[164:167], v[192:195], v[40:43]
  ds_read_b64_tr_b16 v[156:157], v1 offset:256
  v_mfma_f32_16x16x32_bf16 v[44:47], v[164:167], v[196:199], v[44:47]
  ds_read_b64_tr_b16 v[158:159], v1 offset:2048
  s_waitcnt lgkmcnt(8)
  v_mfma_f32_16x16x32_bf16 v[48:51], v[168:171], v[192:195], v[48:51]
  ds_read_b64_tr_b16 v[160:161], v2 offset:288
  v_mfma_f32_16x16x32_bf16 v[52:55], v[168:171], v[196:199], v[52:55]
  ds_read_b64_tr_b16 v[162:163], v2 offset:2080
  v_mfma_f32_16x16x32_bf16 v[56:59], v[172:175], v[192:195], v[56:59]
  ds_read_b64_tr_b16 v[164:165], v1 offset:320
  v_mfma_f32_16x16x32_bf16 v[60:63], v[172:175], v[196:199], v[60:63]
  ds_read_b64_tr_b16 v[166:167], v1 offset:2112
  v_mfma_f32_16x16x32_bf16 v[140:143], v[172:175], v[200:203], v[140:143]
  s_waitcnt lgkmcnt(6)
  v_mfma_f32_16x16x32_bf16 v[64:67], v[176:179], v[192:195], v[64:67]
  ds_read_b64_tr_b16 v[168:169], v2 offset:352
  v_mfma_f32_16x16x32_bf16 v[68:71], v[176:179], v[196:199], v[68:71]
  ds_read_b64_tr_b16 v[170:171], v2 offset:2144
  v_mfma_f32_16x16x32_bf16 v[72:75], v[152:155], v[192:195], v[72:75]
  ds_read_b64_tr_b16 v[172:173], v1 offset:384
  v_mfma_f32_16x16x32_bf16 v[76:79], v[152:155], v[196:199], v[76:79]
  ds_read_b64_tr_b16 v[174:175], v1 offset:2176
  s_waitcnt lgkmcnt(6)
  v_mfma_f32_16x16x32_bf16 v[80:83], v[156:159], v[192:195], v[80:83]
  ds_read_b64_tr_b16 v[176:177], v2 offset:416
  v_add_u32 v1, s32, v1
  v_mfma_f32_16x16x32_bf16 v[84:87], v[156:159], v[196:199], v[84:87]
  ds_read_b64_tr_b16 v[178:179], v2 offset:2208
  v_mfma_f32_16x16x32_bf16 v[88:91], v[160:163], v[192:195], v[88:91]
  ds_read_b64_tr_b16 v[152:153], v1 offset:0
  v_add_u32 v2, s32, v2
  v_mfma_f32_16x16x32_bf16 v[92:95], v[160:163], v[196:199], v[92:95]
  ds_read_b64_tr_b16 v[154:155], v1 offset:1792
  v_mfma_f32_16x16x32_bf16 v[144:147], v[160:163], v[200:203], v[144:147]
  s_waitcnt lgkmcnt(6)
  v_mfma_f32_16x16x32_bf16 v[96:99], v[164:167], v[192:195], v[96:99]
  ds_read_b64_tr_b16 v[156:157], v2 offset:32
  v_mfma_f32_16x16x32_bf16 v[100:103], v[164:167], v[196:199], v[100:103]
  ds_read_b64_tr_b16 v[158:159], v2 offset:1824
  v_mfma_f32_16x16x32_bf16 v[104:107], v[168:171], v[192:195], v[104:107]
  ds_read_b64_tr_b16 v[160:161], v1 offset:64
  v_mfma_f32_16x16x32_bf16 v[108:111], v[168:171], v[196:199], v[108:111]
  ds_read_b64_tr_b16 v[162:163], v1 offset:1856
  s_waitcnt lgkmcnt(6)
  v_mfma_f32_16x16x32_bf16 v[112:115], v[172:175], v[192:195], v[112:115]
  ds_read_b64_tr_b16 v[164:165], v2 offset:96
  v_mfma_f32_16x16x32_bf16 v[116:119], v[172:175], v[196:199], v[116:119]
  ds_read_b64_tr_b16 v[166:167], v2 offset:1888
  v_mfma_f32_16x16x32_bf16 v[120:123], v[176:179], v[192:195], v[120:123]
  ds_read_b64_tr_b16 v[168:169], v1 offset:128
  v_mfma_f32_16x16x32_bf16 v[124:127], v[176:179], v[196:199], v[124:127]
  ds_read_b64_tr_b16 v[170:171], v1 offset:1920
  v_mfma_f32_16x16x32_bf16 v[148:151], v[176:179], v[200:203], v[148:151]
  s_barrier
  s_waitcnt lgkmcnt(6)
  v_mfma_f32_16x16x32_bf16 v[16:19], v[152:155], v[204:207], v[16:19]
  ds_read_b64_tr_b16 v[172:173], v2 offset:160
  s_add_u32 s33, s33, 1
  v_mfma_f32_16x16x32_bf16 v[20:23], v[152:155], v[208:211], v[20:23]
  ds_read_b64_tr_b16 v[174:175], v2 offset:1952
  s_cmp_eq_u32 s33, 3
  v_mfma_f32_16x16x32_bf16 v[24:27], v[156:159], v[204:207], v[24:27]
  ds_read_b64_tr_b16 v[176:177], v1 offset:192
  s_cselect_b32 s34, s54, s50
  v_mfma_f32_16x16x32_bf16 v[28:31], v[156:159], v[208:211], v[28:31]
  ds_read_b64_tr_b16 v[178:179], v1 offset:1984
  s_cselect_b32 s33, 0, s33
  v_mfma_f32_16x16x32_bf16 v[136:139], v[156:159], v[200:203], v[136:139]
  s_add_u32 s31, s31, 1
  s_waitcnt lgkmcnt(6)
  v_mfma_f32_16x16x32_bf16 v[32:35], v[160:163], v[204:207], v[32:35]
  ds_read_b64_tr_b16 v[152:153], v2 offset:224
  s_cmp_eq_u32 s31, 5
  v_mfma_f32_16x16x32_bf16 v[36:39], v[160:163], v[208:211], v[36:39]
  ds_read_b64_tr_b16 v[154:155], v2 offset:2016
  s_cselect_b32 s32, s53, s52
  v_mfma_f32_16x16x32_bf16 v[40:43], v[164:167], v[204:207], v[40:43]
  ds_read_b64_tr_b16 v[156:157], v1 offset:256
  s_cselect_b32 s31, 0, s31
  v_mfma_f32_16x16x32_bf16 v[44:47], v[164:167], v[208:211], v[44:47]
  ds_read_b64_tr_b16 v[158:159], v1 offset:2048
  s_waitcnt lgkmcnt(6)
  v_mfma_f32_16x16x32_bf16 v[48:51], v[168:171], v[204:207], v[48:51]
  ds_read_b64_tr_b16 v[160:161], v2 offset:288
  v_add_u32 v6, s34, v6
  v_mfma_f32_16x16x32_bf16 v[52:55], v[168:171], v[208:211], v[52:55]
  ds_read_b64_tr_b16 v[162:163], v2 offset:2080
  v_add_u32 v7, s34, v7
  v_mfma_f32_16x16x32_bf16 v[56:59], v[172:175], v[204:207], v[56:59]
  ds_read_b64_tr_b16 v[164:165], v1 offset:320
  ds_read_b128 v[192:195], v6 offset:0
  v_mfma_f32_16x16x32_bf16 v[60:63], v[172:175], v[208:211], v[60:63]
  ds_read_b64_tr_b16 v[166:167], v1 offset:2112
  ds_read_b128 v[196:199], v6 offset:2048
  v_mfma_f32_16x16x32_bf16 v[140:143], v[172:175], v[200:203], v[140:143]
  s_waitcnt lgkmcnt(8)
  v_mfma_f32_16x16x32_bf16 v[64:67], v[176:179], v[204:207], v[64:67]
  ds_read_b64_tr_b16 v[168:169], v2 offset:352
  v_mfma_f32_16x16x32_bf16 v[68:71], v[176:179], v[208:211], v[68:71]
  ds_read_b64_tr_b16 v[170:171], v2 offset:2144
  v_mfma_f32_16x16x32_bf16 v[72:75], v[152:155], v[204:207], v[72:75]
  ds_read_b64_tr_b16 v[172:173], v1 offset:384
  v_mfma_f32_16x16x32_bf16 v[76:79], v[152:155], v[208:211], v[76:79]
  ds_read_b64_tr_b16 v[174:175], v1 offset:2176
  s_waitcnt lgkmcnt(8)
  v_mfma_f32_16x16x32_bf16 v[80:83], v[156:159], v[204:207], v[80:83]
  ds_read_b64_tr_b16 v[176:177], v2 offset:416
  v_add_u32 v1, s32, v1
  v_mfma_f32_16x16x32_bf16 v[84:87], v[156:159], v[208:211], v[84:87]
  ds_read_b64_tr_b16 v[178:179], v2 offset:2208
  v_mfma_f32_16x16x32_bf16 v[88:91], v[160:163], v[204:207], v[88:91]
  ds_read_b64_tr_b16 v[152:153], v1 offset:0
  v_add_u32 v2, s32, v2
  v_mfma_f32_16x16x32_bf16 v[92:95], v[160:163], v[208:211], v[92:95]
  ds_read_b64_tr_b16 v[154:155], v1 offset:1792
  v_mfma_f32_16x16x32_bf16 v[144:147], v[160:163], v[200:203], v[144:147]
  s_waitcnt lgkmcnt(6)
  v_mfma_f32_16x16x32_bf16 v[96:99], v[164:167], v[204:207], v[96:99]
  ds_read_b64_tr_b16 v[156:157], v2 offset:32
  v_mfma_f32_16x16x32_bf16 v[100:103], v[164:167], v[208:211], v[100:103]
  ds_read_b64_tr_b16 v[158:159], v2 offset:1824
  v_mfma_f32_16x16x32_bf16 v[104:107], v[168:171], v[204:207], v[104:107]
  ds_read_b64_tr_b16 v[160:161], v1 offset:64
  v_mfma_f32_16x16x32_bf16 v[108:111], v[168:171], v[208:211], v[108:111]
  ds_read_b64_tr_b16 v[162:163], v1 offset:1856
  s_waitcnt lgkmcnt(6)
  v_mfma_f32_16x16x32_bf16 v[112:115], v[172:175], v[204:207], v[112:115]
  ds_read_b64_tr_b16 v[164:165], v2 offset:96
  v_mfma_f32_16x16x32_bf16 v[116:119], v[172:175], v[208:211], v[116:119]
  ds_read_b64_tr_b16 v[166:167], v2 offset:1888
  v_mfma_f32_16x16x32_bf16 v[120:123], v[176:179], v[204:207], v[120:123]
  ds_read_b64_tr_b16 v[168:169], v1 offset:128
  v_mfma_f32_16x16x32_bf16 v[124:127], v[176:179], v[208:211], v[124:127]
  ds_read_b64_tr_b16 v[170:171], v1 offset:1920
  v_mfma_f32_16x16x32_bf16 v[148:151], v[176:179], v[200:203], v[148:151]
  s_barrier
  s_add_u32 s30, s30, 1
  s_cmp_lt_u32 s30, 10
  s_cbranch_scc1 L_cH1_loop
  s_branch L_epiH
L_cH2:
  ds_read_b128 v[192:195], v6 offset:0
  ds_read_b128 v[196:199], v6 offset:2048
  ds_read_b64_tr_b16 v[152:153], v1 offset:0
  ds_read_b64_tr_b16 v[154:155], v1 offset:1792
  ds_read_b64_tr_b16 v[156:157], v2 offset:32
  ds_read_b64_tr_b16 v[158:159], v2 offset:1824
  ds_read_b64_tr_b16 v[160:161], v1 offset:64
  ds_read_b64_tr_b16 v[162:163], v1 offset:1856
  ds_read_b64_tr_b16 v[164:165], v2 offset:96
  ds_read_b64_tr_b16 v[166:167], v2 offset:1888
  ds_read_b64_tr_b16 v[168:169], v1 offset:128
  ds_read_b64_tr_b16 v[170:171], v1 offset:1920
L_cH2_loop:
  s_waitcnt lgkmcnt(6)
  v_mfma_f32_16x16x32_bf16 v[16:19], v[152:155], v[192:195], v[16:19]
  ds_read_b64_tr_b16 v[172:173], v2 offset:160
  s_add_u32 s31, s31, 1
  v_mfma_f32_16x16x32_bf16 v[20:23], v[152:155], v[196:199], v[20:23]
  ds_read_b64_tr_b16 v[174:175], v2 offset:1952
  s_cmp_eq_u32 s31, 5
  v_mfma_f32_16x16x32_bf16 v[24:27], v[156:159], v[192:195], v[24:27]
  ds_read_b64_tr_b16 v[176:177], v1 offset:192
  s_cselect_b32 s32, s53, s52
  v_mfma_f32_16x16x32_bf16 v[28:31], v[156:159], v[196:199], v[28:31]
  ds_read_b64_tr_b16 v[178:179], v1 offset:1984
  s_waitcnt lgkmcnt(6)
  v_mfma_f32_16x16x32_bf16 v[32:35], v[160:163], v[192:195], v[32:35]
  ds_read_b64_tr_b16 v[152:153], v2 offset:224
  s_cselect_b32 s31, 0, s31
  v_mfma_f32_16x16x32_bf16 v[36:39], v[160:163], v[196:199], v[36:39]
  ds_read_b64_tr_b16 v[154:155], v2 offset:2016
  ds_read_b128 v[204:207], v7 offset:0
  v_mfma_f32_16x16x32_bf16 v[136:139], v[160:163], v[200:203], v[136:139]
  ds_read_b128 v[208:211], v7 offset:2048
  v_mfma_f32_16x16x32_bf16 v[40:43], v[164:167], v[192:195], v[40:43]
  ds_read_b64_tr_b16 v[156:157], v1 offset:256
  v_mfma_f32_16x16x32_bf16 v[44:47], v[164:167], v[196:199], v[44:47]
  ds_read_b64_tr_b16 v[158:159], v1 offset:2048
  s_waitcnt lgkmcnt(8)
  v_mfma_f32_16x16x32_bf16 v[48:51], v[168:171], v[192:195], v[48:51]
  ds_read_b64_tr_b16 v[160:161], v2 offset:288
  v_mfma_f32_16x16x32_bf16 v[52:55], v[168:171], v[196:199], v[52:55]
  ds_read_b64_tr_b16 v[162:163], v2 offset:2080
  v_mfma_f32_16x16x32_bf16 v[56:59], v[172:175], v[192:195], v[56:59]
  ds_read_b64_tr_b16 v[164:165], v1 offset:320
  v_mfma_f32_16x16x32_bf16 v[60:63], v[172:175], v[196:199], v[60:63]
  ds_read_b64_tr_b16 v[166:167], v1 offset:2112
  s_waitcnt lgkmcnt(8)
  v_mfma_f32_16x16x32_bf16 v[64:67], v[176:179], v[192:195], v[64:67]
  ds_read_b64_tr_b16 v[168:169], v2 offset:352
  v_mfma_f32_16x16x32_bf16 v[68:71], v[176:179], v[196:199], v[68:71]
  ds_read_b64_tr_b16 v[170:171], v2 offset:2144
  v_mfma_f32_16x16x32_bf16 v[140:143], v[176:179], v[200:203], v[140:143]
  v_mfma_f32_16x16x32_bf16 v[72:75], v[152:155], v[192:195], v[72:75]
  ds_read_b64_tr_b16 v[172:173], v1 offset:384
  v_mfma_f32_16x16x32_bf16 v[76:79], v[152:155], v[196:199], v[76:79]
  ds_read_b64_tr_b16 v[174:175], v1 offset:2176
  s_waitcnt lgkmcnt(6)
  v_mfma_f32_16x16x32_bf16 v[80:83], v[156:159], v[192:195], v[80:83]
  ds_read_b64_tr_b16 v[176:177], v2 offset:416
  v_add_u32 v1, s32, v1
  v_mfma_f32_16x16x32_bf16 v[84:87], v[156:159], v[196:199], v[84:87]
  ds_read_b64_tr_b16 v[178:179], v2 offset:2208
  v_mfma_f32_16x16x32_bf16 v[88:91], v[160:163], v[192:195], v[88:91]
  ds_read_b64_tr_b16 v[152:153], v1 offset:0
  v_add_u32 v2, s32, v2
  v_mfma_f32_16x16x32_bf16 v[92:95], v[160:163], v[196:199], v[92:95]
  ds_read_b64_tr_b16 v[154:155], v1 offset:1792
  s_waitcnt lgkmcnt(6)
  v_mfma_f32_16x16x32_bf16 v[96:99], v[164:167], v[192:195], v[96:99]
  ds_read_b64_tr_b16 v[156:157], v2 offset:32
  v_mfma_f32_16x16x32_bf16 v[100:103], v[164:167], v[196:199], v[100:103]
  ds_read_b64_tr_b16 v[158:159], v2 offset:1824
  v_mfma_f32_16x16x32_bf16 v[144:147], v[164:167], v[200:203], v[144:147]
  v_mfma_f32_16x16x32_bf16 v[104:107], v[168:171], v[192:195], v[104:107]
  ds_read_b64_tr_b16 v[160:161], v1 offset:64
  v_mfma_f32_16x16x32_bf16 v[108:111], v[168:171], v[196:199], v[108:111]
  ds_read_b64_tr_b16 v[162:163], v1 offset:1856
  s_waitcnt lgkmcnt(6)
  v_mfma_f32_16x16x32_bf16 v[112:115], v[172:175], v[192:195], v[112:115]
  ds_read_b64_tr_b16 v[164:165], v2 offset:96
  v_mfma_f32_16x16x32_bf16 v[116:119], v[172:175], v[196:199], v[116:119]
  ds_read_b64_tr_b16 v[166:167], v2 offset:1888
  v_mfma_f32_16x16x32_bf16 v[120:123], v[176:179], v[192:195], v[120:123]
  ds_read_b64_tr_b16 v[168:169], v1 offset:128
  v_mfma_f32_16x16x32_bf16 v[124:127], v[176:179], v[196:199], v[124:127]
  ds_read_b64_tr_b16 v[170:171], v1 offset:1920
  s_barrier
  s_waitcnt lgkmcnt(6)
  v_mfma_f32_16x16x32_bf16 v[16:19], v[152:155], v[204:207], v[16:19]
  ds_read_b64_tr_b16 v[172:173], v2 offset:160
  s_add_u32 s33, s33, 1
  v_mfma_f32_16x16x32_bf16 v[20:23], v[152:155], v[208:211], v[20:23]
  ds_read_b64_tr_b16 v[174:175], v2 offset:1952
  s_cmp_eq_u32 s33, 3
  v_mfma_f32_16x16x32_bf16 v[24:27], v[156:159], v[204:207], v[24:27]
  ds_read_b64_tr_b16 v[176:177], v1 offset:192
  s_cselect_b32 s34, s54, s50
  v_mfma_f32_16x16x32_bf16 v[28:31], v[156:159], v[208:211], v[28:31]
  ds_read_b64_tr_b16 v[178:179], v1 offset:1984
  s_waitcnt lgkmcnt(6)
  v_mfma_f32_16x16x32_bf16 v[32:35], v[160:163], v[204:207], v[32:35]
  ds_read_b64_tr_b16 v[152:153], v2 offset:224
  s_cselect_b32 s33, 0, s33
  v_mfma_f32_16x16x32_bf16 v[36:39], v[160:163], v[208:211], v[36:39]
  ds_read_b64_tr_b16 v[154:155], v2 offset:2016
  s_add_u32 s31, s31, 1
  v_mfma_f32_16x16x32_bf16 v[136:139], v[160:163], v[200:203], v[136:139]
  s_cmp_eq_u32 s31, 5
  s_cselect_b32 s32, s53, s52
  v_mfma_f32_16x16x32_bf16 v[40:43], v[164:167], v[204:207], v[40:43]
  ds_read_b64_tr_b16 v[156:157], v1 offset:256
  s_cselect_b32 s31, 0, s31
  v_mfma_f32_16x16x32_bf16 v[44:47], v[164:167], v[208:211], v[44:47]
  ds_read_b64_tr_b16 v[158:159], v1 offset:2048
  s_waitcnt lgkmcnt(6)
  v_mfma_f32_16x16x32_bf16 v[48:51], v[168:171], v[204:207], v[48:51]
  ds_read_b64_tr_b16 v[160:161], v2 offset:288
  v_add_u32 v6, s34, v6
  v_mfma_f32_16x16x32_bf16 v[52:55], v[168:171], v[208:211], v[52:55]
  ds_read_b64_tr_b16 v[162:163], v2 offset:2080
  v_add_u32 v7, s34, v7
  v_mfma_f32_16x16x32_bf16 v[56:59], v[172:175], v[204:207], v[56:59]
  ds_read_b64_tr_b16 v[164:165], v1 offset:320
  ds_read_b128 v[192:195], v6 offset:0
  v_mfma_f32_16x16x32_bf16 v[60:63], v[172:175], v[208:211], v[60:63]
  ds_read_b64_tr_b16 v[166:167], v1 offset:2112
  s_waitcnt lgkmcnt(7)
  v_mfma_f32_16x16x32_bf16 v[64:67], v[176:179], v[204:207], v[64:67]
  ds_read_b64_tr_b16 v[168:169], v2 offset:352
  ds_read_b128 v[196:199], v6 offset:2048
  v_mfma_f32_16x16x32_bf16 v[68:71], v[176:179], v[208:211], v[68:71]
  ds_read_b64_tr_b16 v[170:171], v2 offset:2144
  v_mfma_f32_16x16x32_bf16 v[140:143], v[176:179], v[200:203], v[140:143]
  v_mfma_f32_16x16x32_bf16 v[72:75], v[152:155], v[204:207], v[72:75]
  ds_read_b64_tr_b16 v[172:173], v1 offset:384
  v_mfma_f32_16x16x32_bf16 v[76:79], v[152:155], v[208:211], v[76:79]
  ds_read_b64_tr_b16 v[174:175], v1 offset:2176
  s_waitcnt lgkmcnt(8)
  v_mfma_f32_16x16x32_bf16 v[80:83], v[156:159], v[204:207], v[80:83]
  ds_read_b64_tr_b16 v[176:177], v2 offset:416
  v_add_u32 v1, s32, v1
  v_mfma_f32_16x16x32_bf16 v[84:87], v[156:159], v[208:211], v[84:87]
  ds_read_b64_tr_b16 v[178:179], v2 offset:2208
  v_mfma_f32_16x16x32_bf16 v[88:91], v[160:163], v[204:207], v[88:91]
  ds_read_b64_tr_b16 v[152:153], v1 offset:0
  v_add_u32 v2, s32, v2
  v_mfma_f32_16x16x32_bf16 v[92:95], v[160:163], v[208:211], v[92:95]
  ds_read_b64_tr_b16 v[154:155], v1 offset:1792
  s_waitcnt lgkmcnt(6)
  v_mfma_f32_16x16x32_bf16 v[96:99], v[164:167], v[204:207], v[96:99]
  ds_read_b64_tr_b16 v[156:157], v2 offset:32
  v_mfma_f32_16x16x32_bf16 v[100:103], v[164:167], v[208:211], v[100:103]
  ds_read_b64_tr_b16 v[158:159], v2 offset:1824
  v_mfma_f32_16x16x32_bf16 v[144:147], v[164:167], v[200:203], v[144:147]
  v_mfma_f32_16x16x32_bf16 v[104:107], v[168:171], v[204:207], v[104:107]
  ds_read_b64_tr_b16 v[160:161], v1 offset:64
  v_mfma_f32_16x16x32_bf16 v[108:111], v[168:171], v[208:211], v[108:111]
  ds_read_b64_tr_b16 v[162:163], v1 offset:1856
  s_waitcnt lgkmcnt(6)
  v_mfma_f32_16x16x32_bf16 v[112:115], v[172:175], v[204:207], v[112:115]
  ds_read_b64_tr_b16 v[164:165], v2 offset:96
  v_mfma_f32_16x16x32_bf16 v[116:119], v[172:175], v[208:211], v[116:119]
  ds_read_b64_tr_b16 v[166:167], v2 offset:1888
  v_mfma_f32_16x16x32_bf16 v[120:123], v[176:179], v[204:207], v[120:123]
  ds_read_b64_tr_b16 v[168:169], v1 offset:128
  v_mfma_f32_16x16x32_bf16 v[124:127], v[176:179], v[208:211], v[124:127]
  ds_read_b64_tr_b16 v[170:171], v1 offset:1920
  s_barrier
  s_add_u32 s30, s30, 1
  s_cmp_lt_u32 s30, 10
  s_cbranch_scc1 L_cH2_loop
  s_branch L_epiH
L_cH3:
  ds_read_b128 v[192:195], v6 offset:0
  ds_read_b128 v[196:199], v6 offset:2048
  ds_read_b64_tr_b16 v[152:153], v1 offset:0
  ds_read_b64_tr_b16 v[154:155], v1 offset:1792
  ds_read_b64_tr_b16 v[156:157], v2 offset:32
  ds_read_b64_tr_b16 v[158:159], v2 offset:1824
  ds_read_b64_tr_b16 v[160:161], v1 offset:64
  ds_read_b64_tr_b16 v[162:163], v1 offset:1856
  ds_read_b64_tr_b16 v[164:165], v2 offset:96
  ds_read_b64_tr_b16 v[166:167], v2 offset:1888
  ds_read_b64_tr_b16 v[168:169], v1 offset:128
  ds_read_b64_tr_b16 v[170:171], v1 offset:1920
L_cH3_loop:
  s_waitcnt lgkmcnt(6)
  v_mfma_f32_16x16x32_bf16 v[16:19], v[152:155], v[192:195], v[16:19]
  ds_read_b64_tr_b16 v[172:173], v2 offset:160
  s_add_u32 s31, s31, 1
  v_mfma_f32_16x16x32_bf16 v[20:23], v[152:155], v[196:199], v[20:23]
  ds_read_b64_tr_b16 v[174:175], v2 offset:1952
  s_cmp_eq_u32 s31, 5
  v_mfma_f32_16x16x32_bf16 v[24:27], v[156:159], v[192:195], v[24:27]
  ds_read_b64_tr_b16 v[176:177], v1 offset:192
  s_cselect_b32 s32, s53, s52
  v_mfma_f32_16x16x32_bf16 v[28:31], v[156:159], v[196:199], v[28:31]
  ds_read_b64_tr_b16 v[178:179], v1 offset:1984
  s_waitcnt lgkmcnt(6)
  v_mfma_f32_16x16x32_bf16 v[32:35], v[160:163], v[192:195], v[32:35]
  ds_read_b64_tr_b16 v[152:153], v2 offset:224
  s_cselect_b32 s31, 0, s31
  v_mfma_f32_16x16x32_bf16 v[36:39], v[160:163], v[196:199], v[36:39]
  ds_read_b64_tr_b16 v[154:155], v2 offset:2016
  ds_read_b128 v[204:207], v7 offset:0
  v_mfma_f32_16x16x32_bf16 v[40:43], v[164:167], v[192:195], v[40:43]
  ds_read_b64_tr_b16 v[156:157], v1 offset:256
  ds_read_b128 v[208:211], v7 offset:2048
  v_mfma_f32_16x16x32_bf16 v[44:47], v[164:167], v[196:199], v[44:47]
  ds_read_b64_tr_b16 v[158:159], v1 offset:2048
  v_mfma_f32_16x16x32_bf16 v[136:139], v[164:167], v[200:203], v[136:139]
  s_waitcnt lgkmcnt(8)
  v_mfma_f32_16x16x32_bf16 v[48:51], v[168:171], v[192:195], v[48:51]
  ds_read_b64_tr_b16 v[160:161], v2 offset:288
  v_mfma_f32_16x16x32_bf16 v[52:55], v[168:171], v[196:199], v[52:55]
  ds_read_b64_tr_b16 v[162:163], v2 offset:2080
  v_mfma_f32_16x16x32_bf16 v[56:59], v[172:175], v[192:195], v[56:59]
  ds_read_b64_tr_b16 v[164:165], v1 offset:320
  v_mfma_f32_16x16x32_bf16 v[60:63], v[172:175], v[196:199], v[60:63]
  ds_read_b64_tr_b16 v[166:167], v1 offset:2112
  s_waitcnt lgkmcnt(8)
  v_mfma_f32_16x16x32_bf16 v[64:67], v[176:179], v[192:195], v[64:67]
  ds_read_b64_tr_b16 v[168:169], v2 offset:352
  v_mfma_f32_16x16x32_bf16 v[68:71], v[176:179], v[196:199], v[68:71]
  ds_read_b64_tr_b16 v[170:171], v2 offset:2144
  v_mfma_f32_16x16x32_bf16 v[72:75], v[152:155], v[192:195], v[72:75]
  ds_read_b64_tr_b16 v[172:173], v1 offset:384
  v_mfma_f32_16x16x32_bf16 v[76:79], v[152:155], v[196:199], v[76:79]
  ds_read_b64_tr_b16 v[174:175], v1 offset:2176
  v_mfma_f32_16x16x32_bf16 v[140:143], v[152:155], v[200:203], v[140:143]
  s_waitcnt lgkmcnt(6)
  v_mfma_f32_16x16x32_bf16 v[80:83], v[156:159], v[192:195], v[80:83]
  ds_read_b64_tr_b16 v[176:177], v2 offset:416
  v_add_u32 v1, s32, v1
  v_mfma_f32_16x16x32_bf16 v[84:87], v[156:159], v[196:199], v[84:87]
  ds_read_b64_tr_b16 v[178:179], v2 offset:2208
  v_mfma_f32_16x16x32_bf16 v[88:91], v[160:163], v[192:195], v[88:91]
  ds_read_b64_tr_b16 v[152:153], v1 offset:0
  v_add_u32 v2, s32, v2
  v_mfma_f32_16x16x32_bf16 v[92:95], v[160:163], v[196:199], v[92:95]
  ds_read_b64_tr_b16 v[154:155], v1 offset:1792
  s_waitcnt lgkmcnt(6)
  v_mfma_f32_16x16x32_bf16 v[96:99], v[164:167], v[192:195], v[96:99]
  ds_read_b64_tr_b16 v[156:157], v2 offset:32
  v_mfma_f32_16x16x32_bf16 v[100:103], v[164:167], v[196:199], v[100:103]
  ds_read_b64_tr_b16 v[158:159], v2 offset:1824
  v_mfma_f32_16x16x32_bf16 v[104:107], v[168:171], v[192:195], v[104:107]
  ds_read_b64_tr_b16 v[160:161], v1 offset:64
  v_mfma_f32_16x16x32_bf16 v[108:111], v[168:171], v[196:199], v[108:111]
  ds_read_b64_tr_b16 v[162:163], v1 offset:1856
  v_mfma_f32_16x16x32_bf16 v[144:147], v[168:171], v[200:203], v[144:147]
  s_waitcnt lgkmcnt(6)
  v_mfma_f32_16x16x32_bf16 v[112:115], v[172:175], v[192:195], v[112:115]
  ds_read_b64_tr_b16 v[164:165], v2 offset:96
  v_mfma_f32_16x16x32_bf16 v[116:119], v[172:175], v[196:199], v[116:119]
  ds_read_b64_tr_b16 v[166:167], v2 offset:1888
  v_mfma_f32_16x16x32_bf16 v[120:123], v[176:179], v[192:195], v[120:123]
  ds_read_b64_tr_b16 v[168:169], v1 offset:128
  v_mfma_f32_16x16x32_bf16 v[124:127], v[176:179], v[196:199], v[124:127]
  ds_read_b64_tr_b16 v[170:171], v1 offset:1920
  s_barrier
  s_waitcnt lgkmcnt(6)
  v_mfma_f32_16x16x32_bf16 v[16:19], v[152:155], v[204:207], v[16:19]
  ds_read_b64_tr_b16 v[172:173], v2 offset:160
  s_add_u32 s33, s33, 1
  v_mfma_f32_16x16x32_bf16 v[20:23], v[152:155], v[208:211], v[20:23]
  ds_read_b64_tr_b16 v[174:175], v2 offset:1952
  s_cmp_eq_u32 s33, 3
  v_mfma_f32_16x16x32_bf16 v[24:27], v[156:159], v[204:207], v[24:27]
  ds_read_b64_tr_b16 v[176:177], v1 offset:192
  s_cselect_b32 s34, s54, s50
  v_mfma_f32_16x16x32_bf16 v[28:31], v[156:159], v[208:211], v[28:31]
  ds_read_b64_tr_b16 v[178:179], v1 offset:1984
  s_waitcnt lgkmcnt(6)
  v_mfma_f32_16x16x32_bf16 v[32:35], v[160:163], v[204:207], v[32:35]
  ds_read_b64_tr_b16 v[152:153], v2 offset:224
  s_cselect_b32 s33, 0, s33
  v_mfma_f32_16x16x32_bf16 v[36:39], v[160:163], v[208:211], v[36:39]
  ds_read_b64_tr_b16 v[154:155], v2 offset:2016
  s_add_u32 s31, s31, 1
  v_mfma_f32_16x16x32_bf16 v[40:43], v[164:167], v[204:207], v[40:43]
  ds_read_b64_tr_b16 v[156:157], v1 offset:256
  s_cmp_eq_u32 s31, 5
  v_mfma_f32_16x16x32_bf16 v[44:47], v[164:167], v[208:211], v[44:47]
  ds_read_b64_tr_b16 v[158:159], v1 offset:2048
  s_cselect_b32 s32, s53, s52
  v_mfma_f32_16x16x32_bf16 v[136:139], v[164:167], v[200:203], v[136:139]
  s_cselect_b32 s31, 0, s31
  s_waitcnt lgkmcnt(6)
  v_mfma_f32_16x16x32_bf16 v[48:51], v[168:171], v[204:207], v[48:51]
  ds_read_b64_tr_b16 v[160:161], v2 offset:288
  v_add_u32 v6, s34, v6
  v_mfma_f32_16x16x32_bf16 v[52:55], v[168:171], v[208:211], v[52:55]
  ds_read_b64_tr_b16 v[162:163], v2 offset:2080
  v_add_u32 v7, s34, v7
  v_mfma_f32_16x16x32_bf16 v[56:59], v[172:175], v[204:207], v[56:59]
  ds_read_b64_tr_b16 v[164:165], v1 offset:320
  ds_read_b128 v[192:195], v6 offset:0
  v_mfma_f32_16x16x32_bf16 v[60:63], v[172:175], v[208:211], v[60:63]
  ds_read_b64_tr_b16 v[166:167], v1 offset:2112
  s_waitcnt lgkmcnt(7)
  v_mfma_f32_16x16x32_bf16 v[64:67], v[176:179], v[204:207], v[64:67]
  ds_read_b64_tr_b16 v[168:169], v2 offset:352
  ds_read_b128 v[196:199], v6 offset:2048
  v_mfma_f32_16x16x32_bf16 v[68:71], v[176:179], v[208:211], v[68:71]
  ds_read_b64_tr_b16 v[170:171], v2 offset:2144
  v_mfma_f32_16x16x32_bf16 v[72:75], v[152:155], v[204:207], v[72:75]
  ds_read_b64_tr_b16 v[172:173], v1 offset:384
  v_mfma_f32_16x16x32_bf16 v[76:79], v[152:155], v[208:211], v[76:79]
  ds_read_b64_tr_b16 v[174:175], v1 offset:2176
  v_mfma_f32_16x16x32_bf16 v[140:143], v[152:155], v[200:203], v[140:143]
  s_waitcnt lgkmcnt(8)
  v_mfma_f32_16x16x32_bf16 v[80:83], v[156:159], v[204:207], v[80:83]
  ds_read_b64_tr_b16 v[176:177], v2 offset:416
  v_add_u32 v1, s32, v1
  v_mfma_f32_16x16x32_bf16 v[84:87], v[156:159], v[208:211], v[84:87]
  ds_read_b64_tr_b16 v[178:179], v2 offset:2208
  v_mfma_f32_16x16x32_bf16 v[88:91], v[160:163], v[204:207], v[88:91]
  ds_read_b64_tr_b16 v[152:153], v1 offset:0
  v_add_u32 v2, s32, v2
  v_mfma_f32_16x16x32_bf16 v[92:95], v[160:163], v[208:211], v[92:95]
  ds_read_b64_tr_b16 v[154:155], v1 offset:1792
  s_waitcnt lgkmcnt(6)
  v_mfma_f32_16x16x32_bf16 v[96:99], v[164:167], v[204:207], v[96:99]
  ds_read_b64_tr_b16 v[156:157], v2 offset:32
  v_mfma_f32_16x16x32_bf16 v[100:103], v[164:167], v[208:211], v[100:103]
  ds_read_b64_tr_b16 v[158:159], v2 offset:1824
  v_mfma_f32_16x16x32_bf16 v[104:107], v[168:171], v[204:207], v[104:107]
  ds_read_b64_tr_b16 v[160:161], v1 offset:64
  v_mfma_f32_16x16x32_bf16 v[108:111], v[168:171], v[208:211], v[108:111]
  ds_read_b64_tr_b16 v[162:163], v1 offset:1856
  v_mfma_f32_16x16x32_bf16 v[144:147], v[168:171], v[200:203], v[144:147]
  s_waitcnt lgkmcnt(6)
  v_mfma_f32_16x16x32_bf16 v[112:115], v[172:175], v[204:207], v[112:115]
  ds_read_b64_tr_b16 v[164:165], v2 offset:96
  v_mfma_f32_16x16x32_bf16 v[116:119], v[172:175], v[208:211], v[116:119]
  ds_read_b64_tr_b16 v[166:167], v2 offset:1888
  v_mfma_f32_16x16x32_bf16 v[120:123], v[176:179], v[204:207], v[120:123]
  ds_read_b64_tr_b16 v[168:169], v1 offset:128
  v_mfma_f32_16x16x32_bf16 v[124:127], v[176:179], v[208:211], v[124:127]
  ds_read_b64_tr_b16 v[170:171], v1 offset:1920
  s_barrier
  s_add_u32 s30, s30, 1
  s_cmp_lt_u32 s30, 10
  s_cbranch_scc1 L_cH3_loop
  s_branch L_epiH
L_epiH:
  v_lshrrev_b32 v2, 4, v0
  v_and_b32 v3, 15, v0
  v_lshlrev_b32 v4, 4, v2
  v_lshlrev_b32 v5, 2, v3
  v_add_u32 v4, 158208, v4
  s_lshl_b32 s27, s24, 6
  v_add_u32 v12, s27, v4
  s_lshl_b32 s27, s24, 7
  s_add_u32 s27, s27, 156672
  v_add_u32 v14, s27, v5
  s_not_b64 s[42:43], s[42:43]
  s_waitcnt lgkmcnt(0)
  s_mov_b64 exec, s[42:43]
  ds_write_b128 v12, v[136:139] offset:0
  ds_write_b128 v12, v[140:143] offset:256
  ds_write_b128 v12, v[144:147] offset:512
  ds_write_b128 v12, v[148:151] offset:768
  s_mov_b64 exec, -1
  s_waitcnt lgkmcnt(0)
  s_barrier
  ds_read_b32 v232, v14 offset:0
  s_lshl_b32 s27, s25, 1
  ds_read_b32 v233, v14 offset:64
  s_lshr_b32 s28, s24, 1
  ds_read_b32 v234, v14 offset:576
  s_add_u32 s27, s27, s28
  ds_read_b32 v235, v14 offset:640
  s_mul_i32 s27, s27, 74
  ds_read_b128 v[152:155], v4 offset:0
  s_mul_i32 s29, s26, 7
  ds_read_b128 v[156:159], v4 offset:64
  s_add_u32 s27, s27, s29
  ds_read_b128 v[160:163], v4 offset:128
  s_add_u32 s27, s27, 20
  ds_read_b128 v[164:167], v4 offset:192
  s_lshl_b32 s27, s27, 12
  ds_read_b128 v[168:171], v4 offset:256
  s_and_b32 s28, s24, 1
  ds_read_b128 v[172:175], v4 offset:320
  v_mov_b32 v8, 0
  ds_read_b128 v[176:179], v4 offset:384
  s_lshl_b32 s28, s28, 11
  s_add_u32 s55, s27, s28
  v_lshlrev_b32 v7, 4, v0
  s_cmp_eq_u32 s26, 7
  s_cselect_b32 s48, 1073741824, 0
  s_waitcnt lgkmcnt(5)
  v_pk_fma_f32 v[16:17], v[152:153], v[232:233], v[16:17] op_sel:[0,0,0] op_sel_hi:[1,0,1] neg_lo:[0,1,0] neg_hi:[0,1,0]
  v_pk_fma_f32 v[18:19], v[154:155], v[232:233], v[18:19] op_sel:[0,0,0] op_sel_hi:[1,0,1] neg_lo:[0,1,0] neg_hi:[0,1,0]
  v_pk_fma_f32 v[20:21], v[152:153], v[232:233], v[20:21] op_sel:[0,1,0] op_sel_hi:[1,1,1] neg_lo:[0,1,0] neg_hi:[0,1,0]
  v_pk_mul_f32 v[16:17], v[16:17], v[234:235] op_sel:[0,0] op_sel_hi:[1,0]
  v_pk_fma_f32 v[24:25], v[156:157], v[232:233], v[24:25] op_sel:[0,0,0] op_sel_hi:[1,0,1] neg_lo:[0,1,0] neg_hi:[0,1,0]
  v_pk_fma_f32 v[26:27], v[158:159], v[232:233], v[26:27] op_sel:[0,0,0] op_sel_hi:[1,0,1] neg_lo:[0,1,0] neg_hi:[0,1,0]
  v_pk_fma_f32 v[22:23], v[154:155], v[232:233], v[22:23] op_sel:[0,1,0] op_sel_hi:[1,1,1] neg_lo:[0,1,0] neg_hi:[0,1,0]
  v_pk_mul_f32 v[18:19], v[18:19], v[234:235] op_sel:[0,0] op_sel_hi:[1,0]
  v_pk_mul_f32 v[20:21], v[20:21], v[234:235] op_sel:[0,1] op_sel_hi:[1,1]
  v_cvt_pk_bf16_f32 v16, v16, v17
  v_pk_fma_f32 v[28:29], v[156:157], v[232:233], v[28:29] op_sel:[0,1,0] op_sel_hi:[1,1,1] neg_lo:[0,1,0] neg_hi:[0,1,0]
  v_pk_fma_f32 v[30:31], v[158:159], v[232:233], v[30:31] op_sel:[0,1,0] op_sel_hi:[1,1,1] neg_lo:[0,1,0] neg_hi:[0,1,0]
  v_pk_mul_f32 v[24:25], v[24:25], v[234:235] op_sel:[0,0] op_sel_hi:[1,0]
  v_pk_mul_f32 v[26:27], v[26:27], v[234:235] op_sel:[0,0] op_sel_hi:[1,0]
  v_pk_mul_f32 v[22:23], v[22:23], v[234:235] op_sel:[0,1] op_sel_hi:[1,1]
  v_cvt_pk_bf16_f32 v17, v18, v19
  v_cvt_pk_bf16_f32 v20, v20, v21
  v_pk_mul_f32 v[28:29], v[28:29], v[234:235] op_sel:[0,1] op_sel_hi:[1,1]
  v_pk_mul_f32 v[30:31], v[30:31], v[234:235] op_sel:[0,1] op_sel_hi:[1,1]
  v_cvt_pk_bf16_f32 v18, v24, v25
  v_cvt_pk_bf16_f32 v19, v26, v27
  v_cvt_pk_bf16_f32 v21, v22, v23
  v_cvt_pk_bf16_f32 v22, v28, v29
  v_cvt_pk_bf16_f32 v23, v30, v31
  v_pk_max_i16 v16, v16, v8
  v_pk_max_i16 v17, v17, v8
  v_pk_max_i16 v18, v18, v8
  v_pk_max_i16 v19, v19, v8
  v_pk_max_i16 v20, v20, v8
  v_pk_max_i16 v21, v21, v8
  v_pk_max_i16 v22, v22, v8
  v_pk_max_i16 v23, v23, v8
  buffer_store_dwordx4 v[16:19], v7, s[16:19], s55 offen offset:0 sc0 sc1
  buffer_store_dwordx4 v[20:23], v7, s[16:19], s55 offen offset:1024 sc0 sc1
  s_waitcnt lgkmcnt(3)
  v_pk_fma_f32 v[32:33], v[160:161], v[232:233], v[32:33] op_sel:[0,0,0] op_sel_hi:[1,0,1] neg_lo:[0,1,0] neg_hi:[0,1,0]
  v_pk_fma_f32 v[34:35], v[162:163], v[232:233], v[34:35] op_sel:[0,0,0] op_sel_hi:[1,0,1] neg_lo:[0,1,0] neg_hi:[0,1,0]
  v_pk_fma_f32 v[36:37], v[160:161], v[232:233], v[36:37] op_sel:[0,1,0] op_sel_hi:[1,1,1] neg_lo:[0,1,0] neg_hi:[0,1,0]
  v_pk_mul_f32 v[32:33], v[32:33], v[234:235] op_sel:[0,0] op_sel_hi:[1,0]
  v_pk_fma_f32 v[40:41], v[164:165], v[232:233], v[40:41] op_sel:[0,0,0] op_sel_hi:[1,0,1] neg_lo:[0,1,0] neg_hi:[0,1,0]
  v_pk_fma_f32 v[42:43], v[166:167], v[232:233], v[42:43] op_sel:[0,0,0] op_sel_hi:[1,0,1] neg_lo:[0,1,0] neg_hi:[0,1,0]
  v_pk_fma_f32 v[38:39], v[162:163], v[232:233], v[38:39] op_sel:[0,1,0] op_sel_hi:[1,1,1] neg_lo:[0,1,0] neg_hi:[0,1,0]
  v_pk_mul_f32 v[34:35], v[34:35], v[234:235] op_sel:[0,0] op_sel_hi:[1,0]
  v_pk_mul_f32 v[36:37], v[36:37], v[234:235] op_sel:[0,1] op_sel_hi:[1,1]
  v_cvt_pk_bf16_f32 v32, v32, v33
  v_pk_fma_f32 v[44:45], v[164:165], v[232:233], v[44:45] op_sel:[0,1,0] op_sel_hi:[1,1,1] neg_lo:[0,1,0] neg_hi:[0,1,0]
  v_pk_fma_f32 v[46:47], v[166:167], v[232:233], v[46:47] op_sel:[0,1,0] op_sel_hi:[1,1,1] neg_lo:[0,1,0] neg_hi:[0,1,0]
  v_pk_mul_f32 v[40:41], v[40:41], v[234:235] op_sel:[0,0] op_sel_hi:[1,0]
  v_pk_mul_f32 v[42:43], v[42:43], v[234:235] op_sel:[0,0] op_sel_hi:[1,0]
  v_pk_mul_f32 v[38:39], v[38:39], v[234:235] op_sel:[0,1] op_sel_hi:[1,1]
  v_cvt_pk_bf16_f32 v33, v34, v35
  v_cvt_pk_bf16_f32 v36, v36, v37
  v_pk_mul_f32 v[44:45], v[44:45], v[234:235] op_sel:[0,1] op_sel_hi:[1,1]
  v_pk_mul_f32 v[46:47], v[46:47], v[234:235] op_sel:[0,1] op_sel_hi:[1,1]
  v_cvt_pk_bf16_f32 v34, v40, v41
  v_cvt_pk_bf16_f32 v35, v42, v43
  v_cvt_pk_bf16_f32 v37, v38, v39
  v_cvt_pk_bf16_f32 v38, v44, v45
  v_cvt_pk_bf16_f32 v39, v46, v47
  v_pk_max_i16 v32, v32, v8
  v_pk_max_i16 v33, v33, v8
  v_pk_max_i16 v34, v34, v8
  v_pk_max_i16 v35, v35, v8
  s_add_u32 s55, s55, 4096
  ds_read_b128 v[180:183], v4 offset:448
  v_pk_max_i16 v36, v36, v8
  v_pk_max_i16 v37, v37, v8
  v_pk_max_i16 v38, v38, v8
  v_pk_max_i16 v39, v39, v8
  buffer_store_dwordx4 v[32:35], v7, s[16:19], s55 offen offset:0 sc0 sc1
  buffer_store_dwordx4 v[36:39], v7, s[16:19], s55 offen offset:1024 sc0 sc1
  s_waitcnt lgkmcnt(2)
  v_pk_fma_f32 v[48:49], v[168:169], v[232:233], v[48:49] op_sel:[0,0,0] op_sel_hi:[1,0,1] neg_lo:[0,1,0] neg_hi:[0,1,0]
  v_pk_fma_f32 v[50:51], v[170:171], v[232:233], v[50:51] op_sel:[0,0,0] op_sel_hi:[1,0,1] neg_lo:[0,1,0] neg_hi:[0,1,0]
  v_pk_fma_f32 v[52:53], v[168:169], v[232:233], v[52:53] op_sel:[0,1,0] op_sel_hi:[1,1,1] neg_lo:[0,1,0] neg_hi:[0,1,0]
  v_pk_mul_f32 v[48:49], v[48:49], v[234:235] op_sel:[0,0] op_sel_hi:[1,0]
  v_pk_fma_f32 v[56:57], v[172:173], v[232:233], v[56:57] op_sel:[0,0,0] op_sel_hi:[1,0,1] neg_lo:[0,1,0] neg_hi:[0,1,0]
  v_pk_fma_f32 v[58:59], v[174:175], v[232:233], v[58:59] op_sel:[0,0,0] op_sel_hi:[1,0,1] neg_lo:[0,1,0] neg_hi:[0,1,0]
  v_pk_fma_f32 v[54:55], v[170:171], v[232:233], v[54:55] op_sel:[0,1,0] op_sel_hi:[1,1,1] neg_lo:[0,1,0] neg_hi:[0,1,0]
  v_pk_mul_f32 v[50:51], v[50:51], v[234:235] op_sel:[0,0] op_sel_hi:[1,0]
  v_pk_mul_f32 v[52:53], v[52:53], v[234:235] op_sel:[0,1] op_sel_hi:[1,1]
  v_cvt_pk_bf16_f32 v48, v48, v49
  v_pk_fma_f32 v[60:61], v[172:173], v[232:233], v[60:61] op_sel:[0,1,0] op_sel_hi:[1,1,1] neg_lo:[0,1,0] neg_hi:[0,1,0]
  v_pk_fma_f32 v[62:63], v[174:175], v[232:233], v[62:63] op_sel:[0,1,0] op_sel_hi:[1,1,1] neg_lo:[0,1,0] neg_hi:[0,1,0]
  v_pk_mul_f32 v[56:57], v[56:57], v[234:235] op_sel:[0,0] op_sel_hi:[1,0]
  v_pk_mul_f32 v[58:59], v[58:59], v[234:235] op_sel:[0,0] op_sel_hi:[1,0]
  v_pk_mul_f32 v[54:55], v[54:55], v[234:235] op_sel:[0,1] op_sel_hi:[1,1]
  v_cvt_pk_bf16_f32 v49, v50, v51
  v_cvt_pk_bf16_f32 v52, v52, v53
  v_pk_mul_f32 v[60:61], v[60:61], v[234:235] op_sel:[0,1] op_sel_hi:[1,1]
  v_pk_mul_f32 v[62:63], v[62:63], v[234:235] op_sel:[0,1] op_sel_hi:[1,1]
  v_cvt_pk_bf16_f32 v50, v56, v57
  v_cvt_pk_bf16_f32 v51, v58, v59
  v_cvt_pk_bf16_f32 v53, v54, v55
  ds_read_b128 v[184:187], v4 offset:512
  v_cvt_pk_bf16_f32 v54, v60, v61
  v_cvt_pk_bf16_f32 v55, v62, v63
  v_pk_max_i16 v48, v48, v8
  v_pk_max_i16 v49, v49, v8
  v_pk_max_i16 v50, v50, v8
  v_pk_max_i16 v51, v51, v8
  s_add_u32 s55, s55, 4096
  ds_read_b128 v[188:191], v4 offset:576
  v_pk_max_i16 v52, v52, v8
  v_pk_max_i16 v53, v53, v8
  v_pk_max_i16 v54, v54, v8
  v_pk_max_i16 v55, v55, v8
  buffer_store_dwordx4 v[48:51], v7, s[16:19], s55 offen offset:0 sc0 sc1
  buffer_store_dwordx4 v[52:55], v7, s[16:19], s55 offen offset:1024 sc0 sc1
  s_waitcnt lgkmcnt(2)
  v_pk_fma_f32 v[64:65], v[176:177], v[232:233], v[64:65] op_sel:[0,0,0] op_sel_hi:[1,0,1] neg_lo:[0,1,0] neg_hi:[0,1,0]
  v_pk_fma_f32 v[66:67], v[178:179], v[232:233], v[66:67] op_sel:[0,0,0] op_sel_hi:[1,0,1] neg_lo:[0,1,0] neg_hi:[0,1,0]
  v_pk_fma_f32 v[68:69], v[176:177], v[232:233], v[68:69] op_sel:[0,1,0] op_sel_hi:[1,1,1] neg_lo:[0,1,0] neg_hi:[0,1,0]
  v_pk_mul_f32 v[64:65], v[64:65], v[234:235] op_sel:[0,0] op_sel_hi:[1,0]
  v_pk_fma_f32 v[72:73], v[180:181], v[232:233], v[72:73] op_sel:[0,0,0] op_sel_hi:[1,0,1] neg_lo:[0,1,0] neg_hi:[0,1,0]
  v_pk_fma_f32 v[74:75], v[182:183], v[232:233], v[74:75] op_sel:[0,0,0] op_sel_hi:[1,0,1] neg_lo:[0,1,0] neg_hi:[0,1,0]
  v_pk_fma_f32 v[70:71], v[178:179], v[232:233], v[70:71] op_sel:[0,1,0] op_sel_hi:[1,1,1] neg_lo:[0,1,0] neg_hi:[0,1,0]
  v_pk_mul_f32 v[66:67], v[66:67], v[234:235] op_sel:[0,0] op_sel_hi:[1,0]
  v_pk_mul_f32 v[68:69], v[68:69], v[234:235] op_sel:[0,1] op_sel_hi:[1,1]
  v_cvt_pk_bf16_f32 v64, v64, v65
  v_pk_fma_f32 v[76:77], v[180:181], v[232:233], v[76:77] op_sel:[0,1,0] op_sel_hi:[1,1,1] neg_lo:[0,1,0] neg_hi:[0,1,0]
  v_pk_fma_f32 v[78:79], v[182:183], v[232:233], v[78:79] op_sel:[0,1,0] op_sel_hi:[1,1,1] neg_lo:[0,1,0] neg_hi:[0,1,0]
  v_pk_mul_f32 v[72:73], v[72:73], v[234:235] op_sel:[0,0] op_sel_hi:[1,0]
  v_pk_mul_f32 v[74:75], v[74:75], v[234:235] op_sel:[0,0] op_sel_hi:[1,0]
  v_pk_mul_f32 v[70:71], v[70:71], v[234:235] op_sel:[0,1] op_sel_hi:[1,1]
  v_cvt_pk_bf16_f32 v65, v66, v67
  v_cvt_pk_bf16_f32 v68, v68, v69
  v_pk_mul_f32 v[76:77], v[76:77], v[234:235] op_sel:[0,1] op_sel_hi:[1,1]
  v_pk_mul_f32 v[78:79], v[78:79], v[234:235] op_sel:[0,1] op_sel_hi:[1,1]
  v_cvt_pk_bf16_f32 v66, v72, v73
  v_cvt_pk_bf16_f32 v67, v74, v75
  v_cvt_pk_bf16_f32 v69, v70, v71
  ds_read_b128 v[192:195], v4 offset:640
  v_cvt_pk_bf16_f32 v70, v76, v77
  v_cvt_pk_bf16_f32 v71, v78, v79
  v_pk_max_i16 v64, v64, v8
  v_pk_max_i16 v65, v65, v8
  v_pk_max_i16 v66, v66, v8
  v_pk_max_i16 v67, v67, v8
  s_add_u32 s55, s55, 4096
  ds_read_b128 v[196:199], v4 offset:704
  v_pk_max_i16 v68, v68, v8
  v_pk_max_i16 v69, v69, v8
  v_pk_max_i16 v70, v70, v8
  v_pk_max_i16 v71, v71, v8
  buffer_store_dwordx4 v[64:67], v7, s[16:19], s55 offen offset:0 sc0 sc1
  buffer_store_dwordx4 v[68:71], v7, s[16:19], s55 offen offset:1024 sc0 sc1
  s_waitcnt lgkmcnt(2)
  v_pk_fma_f32 v[80:81], v[184:185], v[232:233], v[80:81] op_sel:[0,0,0] op_sel_hi:[1,0,1] neg_lo:[0,1,0] neg_hi:[0,1,0]
  v_pk_fma_f32 v[82:83], v[186:187], v[232:233], v[82:83] op_sel:[0,0,0] op_sel_hi:[1,0,1] neg_lo:[0,1,0] neg_hi:[0,1,0]
  v_pk_fma_f32 v[84:85], v[184:185], v[232:233], v[84:85] op_sel:[0,1,0] op_sel_hi:[1,1,1] neg_lo:[0,1,0] neg_hi:[0,1,0]
  v_pk_mul_f32 v[80:81], v[80:81], v[234:235] op_sel:[0,0] op_sel_hi:[1,0]
  v_pk_fma_f32 v[88:89], v[188:189], v[232:233], v[88:89] op_sel:[0,0,0] op_sel_hi:[1,0,1] neg_lo:[0,1,0] neg_hi:[0,1,0]
  v_pk_fma_f32 v[90:91], v[190:191], v[232:233], v[90:91] op_sel:[0,0,0] op_sel_hi:[1,0,1] neg_lo:[0,1,0] neg_hi:[0,1,0]
  v_pk_fma_f32 v[86:87], v[186:187], v[232:233], v[86:87] op_sel:[0,1,0] op_sel_hi:[1,1,1] neg_lo:[0,1,0] neg_hi:[0,1,0]
  v_pk_mul_f32 v[82:83], v[82:83], v[234:235] op_sel:[0,0] op_sel_hi:[1,0]
  v_pk_mul_f32 v[84:85], v[84:85], v[234:235] op_sel:[0,1] op_sel_hi:[1,1]
  v_cvt_pk_bf16_f32 v80, v80, v81
  v_pk_fma_f32 v[92:93], v[188:189], v[232:233], v[92:93] op_sel:[0,1,0] op_sel_hi:[1,1,1] neg_lo:[0,1,0] neg_hi:[0,1,0]
  v_pk_fma_f32 v[94:95], v[190:191], v[232:233], v[94:95] op_sel:[0,1,0] op_sel_hi:[1,1,1] neg_lo:[0,1,0] neg_hi:[0,1,0]
  v_pk_mul_f32 v[88:89], v[88:89], v[234:235] op_sel:[0,0] op_sel_hi:[1,0]
  v_pk_mul_f32 v[90:91], v[90:91], v[234:235] op_sel:[0,0] op_sel_hi:[1,0]
  v_pk_mul_f32 v[86:87], v[86:87], v[234:235] op_sel:[0,1] op_sel_hi:[1,1]
  v_cvt_pk_bf16_f32 v81, v82, v83
  v_cvt_pk_bf16_f32 v84, v84, v85
  v_pk_mul_f32 v[92:93], v[92:93], v[234:235] op_sel:[0,1] op_sel_hi:[1,1]
  v_pk_mul_f32 v[94:95], v[94:95], v[234:235] op_sel:[0,1] op_sel_hi:[1,1]
  v_cvt_pk_bf16_f32 v82, v88, v89
  v_cvt_pk_bf16_f32 v83, v90, v91
  v_cvt_pk_bf16_f32 v85, v86, v87
  ds_read_b128 v[200:203], v4 offset:768
  v_cvt_pk_bf16_f32 v86, v92, v93
  v_cvt_pk_bf16_f32 v87, v94, v95
  v_pk_max_i16 v80, v80, v8
  v_pk_max_i16 v81, v81, v8
  v_pk_max_i16 v82, v82, v8
  v_pk_max_i16 v83, v83, v8
  s_add_u32 s55, s55, 4096
  ds_read_b128 v[204:207], v4 offset:832
  v_pk_max_i16 v84, v84, v8
  v_pk_max_i16 v85, v85, v8
  v_pk_max_i16 v86, v86, v8
  v_pk_max_i16 v87, v87, v8
  buffer_store_dwordx4 v[80:83], v7, s[16:19], s55 offen offset:0 sc0 sc1
  buffer_store_dwordx4 v[84:87], v7, s[16:19], s55 offen offset:1024 sc0 sc1
  s_waitcnt lgkmcnt(2)
  v_pk_fma_f32 v[96:97], v[192:193], v[232:233], v[96:97] op_sel:[0,0,0] op_sel_hi:[1,0,1] neg_lo:[0,1,0] neg_hi:[0,1,0]
  v_pk_fma_f32 v[98:99], v[194:195], v[232:233], v[98:99] op_sel:[0,0,0] op_sel_hi:[1,0,1] neg_lo:[0,1,0] neg_hi:[0,1,0]
  v_pk_fma_f32 v[100:101], v[192:193], v[232:233], v[100:101] op_sel:[0,1,0] op_sel_hi:[1,1,1] neg_lo:[0,1,0] neg_hi:[0,1,0]
  v_pk_mul_f32 v[96:97], v[96:97], v[234:235] op_sel:[0,0] op_sel_hi:[1,0]
  v_pk_fma_f32 v[104:105], v[196:197], v[232:233], v[104:105] op_sel:[0,0,0] op_sel_hi:[1,0,1] neg_lo:[0,1,0] neg_hi:[0,1,0]
  v_pk_fma_f32 v[106:107], v[198:199], v[232:233], v[106:107] op_sel:[0,0,0] op_sel_hi:[1,0,1] neg_lo:[0,1,0] neg_hi:[0,1,0]
  v_pk_fma_f32 v[102:103], v[194:195], v[232:233], v[102:103] op_sel:[0,1,0] op_sel_hi:[1,1,1] neg_lo:[0,1,0] neg_hi:[0,1,0]
  v_pk_mul_f32 v[98:99], v[98:99], v[234:235] op_sel:[0,0] op_sel_hi:[1,0]
  v_pk_mul_f32 v[100:101], v[100:101], v[234:235] op_sel:[0,1] op_sel_hi:[1,1]
  v_cvt_pk_bf16_f32 v96, v96, v97
  v_pk_fma_f32 v[108:109], v[196:197], v[232:233], v[108:109] op_sel:[0,1,0] op_sel_hi:[1,1,1] neg_lo:[0,1,0] neg_hi:[0,1,0]
  v_pk_fma_f32 v[110:111], v[198:199], v[232:233], v[110:111] op_sel:[0,1,0] op_sel_hi:[1,1,1] neg_lo:[0,1,0] neg_hi:[0,1,0]
  v_pk_mul_f32 v[104:105], v[104:105], v[234:235] op_sel:[0,0] op_sel_hi:[1,0]
  v_pk_mul_f32 v[106:107], v[106:107], v[234:235] op_sel:[0,0] op_sel_hi:[1,0]
  v_pk_mul_f32 v[102:103], v[102:103], v[234:235] op_sel:[0,1] op_sel_hi:[1,1]
  v_cvt_pk_bf16_f32 v97, v98, v99
  v_cvt_pk_bf16_f32 v100, v100, v101
  v_pk_mul_f32 v[108:109], v[108:109], v[234:235] op_sel:[0,1] op_sel_hi:[1,1]
  v_pk_mul_f32 v[110:111], v[110:111], v[234:235] op_sel:[0,1] op_sel_hi:[1,1]
  v_cvt_pk_bf16_f32 v98, v104, v105
  v_cvt_pk_bf16_f32 v99, v106, v107
  v_cvt_pk_bf16_f32 v101, v102, v103
  s_add_u32 s55, s55, 4096
  v_cvt_pk_bf16_f32 v102, v108, v109
  v_cvt_pk_bf16_f32 v103, v110, v111
  v_pk_max_i16 v96, v96, v8
  v_pk_max_i16 v97, v97, v8
  v_pk_max_i16 v98, v98, v8
  v_pk_max_i16 v99, v99, v8
  s_add_u32 s55, s55, s48
  v_pk_max_i16 v100, v100, v8
  v_pk_max_i16 v101, v101, v8
  v_pk_max_i16 v102, v102, v8
  v_pk_max_i16 v103, v103, v8
  buffer_store_dwordx4 v[96:99], v7, s[16:19], s55 offen offset:0 sc0 sc1
  buffer_store_dwordx4 v[100:103], v7, s[16:19], s55 offen offset:1024 sc0 sc1
  s_waitcnt lgkmcnt(0)
  v_pk_fma_f32 v[112:113], v[200:201], v[232:233], v[112:113] op_sel:[0,0,0] op_sel_hi:[1,0,1] neg_lo:[0,1,0] neg_hi:[0,1,0]
  v_pk_fma_f32 v[114:115], v[202:203], v[232:233], v[114:115] op_sel:[0,0,0] op_sel_hi:[1,0,1] neg_lo:[0,1,0] neg_hi:[0,1,0]
  v_pk_fma_f32 v[116:117], v[200:201], v[232:233], v[116:117] op_sel:[0,1,0] op_sel_hi:[1,1,1] neg_lo:[0,1,0] neg_hi:[0,1,0]
  v_pk_mul_f32 v[112:113], v[112:113], v[234:235] op_sel:[0,0] op_sel_hi:[1,0]
  v_pk_fma_f32 v[120:121], v[204:205], v[232:233], v[120:121] op_sel:[0,0,0] op_sel_hi:[1,0,1] neg_lo:[0,1,0] neg_hi:[0,1,0]
  v_pk_fma_f32 v[122:123], v[206:207], v[232:233], v[122:123] op_sel:[0,0,0] op_sel_hi:[1,0,1] neg_lo:[0,1,0] neg_hi:[0,1,0]
  v_pk_fma_f32 v[118:119], v[202:203], v[232:233], v[118:119] op_sel:[0,1,0] op_sel_hi:[1,1,1] neg_lo:[0,1,0] neg_hi:[0,1,0]
  v_pk_mul_f32 v[114:115], v[114:115], v[234:235] op_sel:[0,0] op_sel_hi:[1,0]
  v_pk_mul_f32 v[116:117], v[116:117], v[234:235] op_sel:[0,1] op_sel_hi:[1,1]
  v_cvt_pk_bf16_f32 v112, v112, v113
  v_pk_fma_f32 v[124:125], v[204:205], v[232:233], v[124:125] op_sel:[0,1,0] op_sel_hi:[1,1,1] neg_lo:[0,1,0] neg_hi:[0,1,0]
  v_pk_fma_f32 v[126:127], v[206:207], v[232:233], v[126:127] op_sel:[0,1,0] op_sel_hi:[1,1,1] neg_lo:[0,1,0] neg_hi:[0,1,0]
  v_pk_mul_f32 v[120:121], v[120:121], v[234:235] op_sel:[0,0] op_sel_hi:[1,0]
  v_pk_mul_f32 v[122:123], v[122:123], v[234:235] op_sel:[0,0] op_sel_hi:[1,0]
  v_pk_mul_f32 v[118:119], v[118:119], v[234:235] op_sel:[0,1] op_sel_hi:[1,1]
  v_cvt_pk_bf16_f32 v113, v114, v115
  v_cvt_pk_bf16_f32 v116, v116, v117
  v_pk_mul_f32 v[124:125], v[124:125], v[234:235] op_sel:[0,1] op_sel_hi:[1,1]
  v_pk_mul_f32 v[126:127], v[126:127], v[234:235] op_sel:[0,1] op_sel_hi:[1,1]
  v_cvt_pk_bf16_f32 v114, v120, v121
  v_cvt_pk_bf16_f32 v115, v122, v123
  v_cvt_pk_bf16_f32 v117, v118, v119
  v_cvt_pk_bf16_f32 v118, v124, v125
  v_cvt_pk_bf16_f32 v119, v126, v127
  v_pk_max_i16 v112, v112, v8
  v_pk_max_i16 v113, v113, v8
  v_pk_max_i16 v114, v114, v8
  v_pk_max_i16 v115, v115, v8
  s_add_u32 s55, s55, 4096
  v_pk_max_i16 v116, v116, v8
  v_pk_max_i16 v117, v117, v8
  v_pk_max_i16 v118, v118, v8
  v_pk_max_i16 v119, v119, v8
  buffer_store_dwordx4 v[112:115], v7, s[16:19], s55 offen offset:0 sc0 sc1
  buffer_store_dwordx4 v[116:119], v7, s[16:19], s55 offen offset:1024 sc0 sc1
  s_add_u32 s55, s55, 4096
  s_branch L2_c
L2_c:
  s_mov_b32 s8, s4
  s_and_b32 s9, s5, 0xffff
  s_mov_b32 s10, 2621440
  s_mov_b32 s11, 0x20000
  s_mov_b32 s12, s84
  s_and_b32 s13, s85, 0xffff
  s_mov_b32 s14, 2621440
  s_mov_b32 s15, 0x20000
  v_mul_u32_u24 v2, 6554, v0
  v_lshrrev_b32 v2, 16, v2
  v_mul_u32_u24 v3, 10, v2
  v_sub_u32 v3, v0, v3
  s_lshl_b32 s27, s86, 6
  s_lshl_b32 s28, s24, 4
  s_add_u32 s27, s27, s28
  s_mul_i32 s27, s27, 1280
  s_mul_i32 s28, s87, 160
  s_add_u32 s27, s27, s28
  v_mul_u32_u24 v4, 1280, v2
  v_lshl_add_u32 v4, v3, 4, v4
  v_add_u32 v4, s27, v4
  v_mov_b32 v5, 1073741824
  v_cmp_gt_u32 vcc, 60, v0
  s_nop 1
  v_cndmask_b32 v10, v5, v4, vcc
  v_add_u32 v4, 7680, v4
  v_cndmask_b32 v11, v5, v4, vcc
  v_add_u32 v4, 7680, v4
  v_cmp_gt_u32 vcc, 40, v0
  s_nop 1
  v_cndmask_b32 v12, v5, v4, vcc
  s_mul_i32 s55, s24, 5376
  s_add_u32 s55, s55, 92160
  v_mul_u32_u24 v13, 336, v2
  v_lshl_add_u32 v13, v3, 5, v13
  v_add_u32 v13, s55, v13
  v_lshlrev_b32 v6, 4, v0
  s_lshl_b32 s27, s24, 10
  v_add_u32 v1, s27, v6
  s_mov_b32 s31, 0
  s_mov_b32 s52, 18432
  s_mov_b32 s53, 4294893568
  s_mov_b32 s30, 0
  s_cmp_eq_u32 s3, 0
  s_cbranch_scc1 L2_c_q
  s_waitcnt vmcnt(0)
  s_barrier
L2_c_q:
  v_mov_b32 v16, 0
  v_mov_b32 v17, 0
  v_mov_b32 v18, 0
  v_mov_b32 v19, 0
  v_mov_b32 v20, 0
  v_mov_b32 v21, 0
  v_mov_b32 v22, 0
  v_mov_b32 v23, 0
  v_mov_b32 v24, 0
  v_mov_b32 v25, 0
  v_mov_b32 v26, 0
  v_mov_b32 v27, 0
  v_mov_b32 v28, 0
  v_mov_b32 v29, 0
  v_mov_b32 v30, 0
  v_mov_b32 v31, 0
  v_mov_b32 v32, 0
  v_mov_b32 v33, 0
  v_mov_b32 v34, 0
  v_mov_b32 v35, 0
  buffer_load_dwordx4 v[96:99], v10, s[8:11], 0 offen
  buffer_load_dwordx4 v[100:103], v11, s[8:11], 0 offen
  buffer_load_dwordx4 v[104:107], v12, s[8:11], 0 offen
  s_barrier
  s_cmp_eq_u32 s3, 0
  s_cbranch_scc0 L2_nost_103
  s_bitcmp1_b32 s26, 0
  s_cbranch_scc0 L_even_104
  v_mov_b32 v232, v212
  v_mov_b32 v234, v212
  v_mov_b32 v233, v213
  v_mov_b32 v235, v213
  v_permlane16_swap_b32 v232, v234
  s_nop 0
  v_permlane16_swap_b32 v233, v235
  v_mov_b32 v236, v222
  v_mov_b32 v238, v222
  v_mov_b32 v237, v223
  v_mov_b32 v239, v223
  v_permlane16_swap_b32 v236, v238
  s_nop 0
  v_permlane16_swap_b32 v237, v239
  s_add_u32 s27, s83, 0
  s_mov_b32 exec_lo, 0xffff0000
  s_mov_b32 exec_hi, 0xffff0000
  buffer_store_dwordx4 v[232:235], v7, s[16:19], s27 offen sc0 sc1
  s_mov_b64 exec, -1
  s_add_u32 s27, s27, 4096
  buffer_store_dwordx4 v[214:217], v7, s[16:19], s27 offen sc0 sc1
  s_add_u32 s27, s27, 4096
  buffer_store_dwordx4 v[218:221], v7, s[16:19], s27 offen sc0 sc1
  s_add_u32 s27, s83, 1024
  s_mov_b32 exec_lo, 0xffff0000
  s_mov_b32 exec_hi, 0xffff0000
  buffer_store_dwordx4 v[236:239], v7, s[16:19], s27 offen sc0 sc1
  s_mov_b64 exec, -1
  s_add_u32 s27, s27, 4096
  buffer_store_dwordx4 v[224:227], v7, s[16:19], s27 offen sc0 sc1
  s_add_u32 s27, s27, 4096
  buffer_store_dwordx4 v[228:231], v7, s[16:19], s27 offen sc0 sc1
  s_branch L_done_105
L_even_104:
  v_mov_b32 v232, v220
  v_mov_b32 v234, v220
  v_mov_b32 v233, v221
  v_mov_b32 v235, v221
  v_permlane16_swap_b32 v232, v234
  s_nop 0
  v_permlane16_swap_b32 v233, v235
  v_mov_b32 v236, v230
  v_mov_b32 v238, v230
  v_mov_b32 v237, v231
  v_mov_b32 v239, v231
  v_permlane16_swap_b32 v236, v238
  s_nop 0
  v_permlane16_swap_b32 v237, v239
  s_add_u32 s27, s83, 0
  buffer_store_dwordx4 v[212:215], v7, s[16:19], s27 offen sc0 sc1
  s_add_u32 s27, s27, 4096
  buffer_store_dwordx4 v[216:219], v7, s[16:19], s27 offen sc0 sc1
  s_add_u32 s27, s27, 4096
  s_mov_b32 exec_lo, 0x0000ffff
  s_mov_b32 exec_hi, 0x0000ffff
  buffer_store_dwordx4 v[232:235], v7, s[16:19], s27 offen sc0 sc1
  s_mov_b64 exec, -1
  s_add_u32 s27, s83, 1024
  buffer_store_dwordx4 v[222:225], v7, s[16:19], s27 offen sc0 sc1
  s_add_u32 s27, s27, 4096
  buffer_store_dwordx4 v[226:229], v7, s[16:19], s27 offen sc0 sc1
  s_add_u32 s27, s27, 4096
  s_mov_b32 exec_lo, 0x0000ffff
  s_mov_b32 exec_hi, 0x0000ffff
  buffer_store_dwordx4 v[236:239], v7, s[16:19], s27 offen sc0 sc1
  s_mov_b64 exec, -1
L_done_105:
L2_nost_103:
  ds_read_b128 v[40:43], v1 offset:0
  ds_read_b128 v[44:47], v6 offset:8192
  ds_read_b128 v[48:51], v6 offset:9216
  ds_read_b128 v[52:55], v6 offset:10240
  ds_read_b128 v[56:59], v6 offset:11264
  ds_read_b128 v[60:63], v6 offset:12288
L2_c_loop:
  s_waitcnt lgkmcnt(4)
  v_mfma_f32_16x16x32_bf16 v[16:19], v[44:47], v[40:43], v[16:19]
  ds_read_b128 v[64:67], v1 offset:4096
  ds_read_b128 v[68:71], v6 offset:13312
  s_waitcnt lgkmcnt(5)
  v_mfma_f32_16x16x32_bf16 v[20:23], v[48:51], v[40:43], v[20:23]
  ds_read_b128 v[72:75], v6 offset:14336
  s_waitcnt lgkmcnt(5)
  v_mfma_f32_16x16x32_bf16 v[24:27], v[52:55], v[40:43], v[24:27]
  ds_read_b128 v[76:79], v6 offset:15360
  s_waitcnt lgkmcnt(5)
  v_mfma_f32_16x16x32_bf16 v[28:31], v[56:59], v[40:43], v[28:31]
  ds_read_b128 v[80:83], v6 offset:16384
  s_waitcnt lgkmcnt(5)
  v_mfma_f32_16x16x32_bf16 v[32:35], v[60:63], v[40:43], v[32:35]
  ds_read_b128 v[84:87], v6 offset:17408
  s_waitcnt lgkmcnt(4)
  v_mfma_f32_16x16x32_bf16 v[16:19], v[68:71], v[64:67], v[16:19]
  s_add_u32 s31, s31, 1
  s_cmp_eq_u32 s31, 5
  s_cselect_b32 s32, s53, s52
  s_cselect_b32 s31, 0, s31
  v_add_u32 v1, s32, v1
  v_add_u32 v6, s32, v6
  ds_read_b128 v[40:43], v1 offset:0
  ds_read_b128 v[44:47], v6 offset:8192
  s_waitcnt lgkmcnt(5)
  v_mfma_f32_16x16x32_bf16 v[20:23], v[72:75], v[64:67], v[20:23]
  ds_read_b128 v[48:51], v6 offset:9216
  s_waitcnt lgkmcnt(5)
  v_mfma_f32_16x16x32_bf16 v[24:27], v[76:79], v[64:67], v[24:27]
  ds_read_b128 v[52:55], v6 offset:10240
  s_waitcnt lgkmcnt(5)
  v_mfma_f32_16x16x32_bf16 v[28:31], v[80:83], v[64:67], v[28:31]
  ds_read_b128 v[56:59], v6 offset:11264
  s_waitcnt lgkmcnt(5)
  v_mfma_f32_16x16x32_bf16 v[32:35], v[84:87], v[64:67], v[32:35]
  ds_read_b128 v[60:63], v6 offset:12288
  s_cmp_eq_u32 s30, 3
  s_cbranch_scc0 L2_nw_106
  s_waitcnt vmcnt(0)
L2_nw_106:
  s_barrier
  s_add_u32 s30, s30, 1
  s_cmp_lt_u32 s30, 37
  s_cbranch_scc1 L2_c_loop
  s_waitcnt lgkmcnt(0)
  v_and_b32 v2, 15, v0
  v_lshrrev_b32 v3, 4, v0
  v_mul_u32_u24 v2, 336, v2
  v_lshl_add_u32 v2, v3, 4, v2
  v_add_u32 v2, s55, v2
  s_nop 7
  ds_write_b128 v2, v[16:19] offset:0
  ds_write_b128 v2, v[20:23] offset:64
  ds_write_b128 v2, v[24:27] offset:128
  ds_write_b128 v2, v[28:31] offset:192
  ds_write_b128 v2, v[32:35] offset:256
  s_waitcnt lgkmcnt(0)
  ds_read_b128 v[40:43], v13 offset:0
  ds_read_b128 v[44:47], v13 offset:16
  ds_read_b128 v[48:51], v13 offset:2016
  ds_read_b128 v[52:55], v13 offset:2032
  ds_read_b128 v[56:59], v13 offset:4032
  ds_read_b128 v[60:63], v13 offset:4048
  s_waitcnt vmcnt(0) lgkmcnt(0)
  v_lshlrev_b32 v4, 16, v96
  v_and_b32 v5, 0xffff0000, v96
  v_add_f32 v4, v4, v40
  v_add_f32 v5, v5, v41
  v_cvt_pk_bf16_f32 v96, v4, v5
  v_lshlrev_b32 v4, 16, v97
  v_and_b32 v5, 0xffff0000, v97
  v_add_f32 v4, v4, v42
  v_add_f32 v5, v5, v43
  v_cvt_pk_bf16_f32 v97, v4, v5
  v_lshlrev_b32 v4, 16, v98
  v_and_b32 v5, 0xffff0000, v98
  v_add_f32 v4, v4, v44
  v_add_f32 v5, v5, v45
  v_cvt_pk_bf16_f32 v98, v4, v5
  v_lshlrev_b32 v4, 16, v99
  v_and_b32 v5, 0xffff0000, v99
  v_add_f32 v4, v4, v46
  v_add_f32 v5, v5, v47
  v_cvt_pk_bf16_f32 v99, v4, v5
  buffer_store_dwordx4 v[96:99], v10, s[12:15], 0 offen
  v_lshlrev_b32 v4, 16, v100
  v_and_b32 v5, 0xffff0000, v100
  v_add_f32 v4, v4, v48
  v_add_f32 v5, v5, v49
  v_cvt_pk_bf16_f32 v100, v4, v5
  v_lshlrev_b32 v4, 16, v101
  v_and_b32 v5, 0xffff0000, v101
  v_add_f32 v4, v4, v50
  v_add_f32 v5, v5, v51
  v_cvt_pk_bf16_f32 v101, v4, v5
  v_lshlrev_b32 v4, 16, v102
  v_and_b32 v5, 0xffff0000, v102
  v_add_f32 v4, v4, v52
  v_add_f32 v5, v5, v53
  v_cvt_pk_bf16_f32 v102, v4, v5
  v_lshlrev_b32 v4, 16, v103
  v_and_b32 v5, 0xffff0000, v103
  v_add_f32 v4, v4, v54
  v_add_f32 v5, v5, v55
  v_cvt_pk_bf16_f32 v103, v4, v5
  buffer_store_dwordx4 v[100:103], v11, s[12:15], 0 offen
  v_lshlrev_b32 v4, 16, v104
  v_and_b32 v5, 0xffff0000, v104
  v_add_f32 v4, v4, v56
  v_add_f32 v5, v5, v57
  v_cvt_pk_bf16_f32 v104, v4, v5
  v_lshlrev_b32 v4, 16, v105
  v_and_b32 v5, 0xffff0000, v105
  v_add_f32 v4, v4, v58
  v_add_f32 v5, v5, v59
  v_cvt_pk_bf16_f32 v105, v4, v5
  v_lshlrev_b32 v4, 16, v106
  v_and_b32 v5, 0xffff0000, v106
  v_add_f32 v4, v4, v60
  v_add_f32 v5, v5, v61
  v_cvt_pk_bf16_f32 v106, v4, v5
  v_lshlrev_b32 v4, 16, v107
  v_and_b32 v5, 0xffff0000, v107
  v_add_f32 v4, v4, v62
  v_add_f32 v5, v5, v63
  v_cvt_pk_bf16_f32 v107, v4, v5
  buffer_store_dwordx4 v[104:107], v12, s[12:15], 0 offen
  s_endpgm
L1_exit:
  s_endpgm
L_text_end:
.section .rodata,"a"
.p2align 6
.amdhsa_kernel parallel_sum__sliding_local_dilated__dense_activation_relu__prompt_kernel
  .amdhsa_next_free_vgpr 256
  .amdhsa_next_free_sgpr 102
  .amdhsa_accum_offset 256
  .amdhsa_group_segment_fixed_size 0
  .amdhsa_kernarg_size 72
  .amdhsa_user_sgpr_count 2
  .amdhsa_user_sgpr_kernarg_segment_ptr 1
  .amdhsa_system_sgpr_workgroup_id_x 1
  .amdhsa_float_denorm_mode_32 3
.end_amdhsa_kernel
```
